```python
import torch

def _softmax(x, axis=-1):
    return torch.softmax(x, dim=axis)
def _gelu(x):
    return torch.nn.functional.gelu(x, approximate="tanh")
def _silu(x):
    return torch.nn.functional.silu(x)
def _sigmoid(x):
    return torch.sigmoid(x)
def _layernorm(x, axis=-1, eps=1e-5):
    m = x.mean(dim=axis, keepdim=True)
    v = x.var(dim=axis, keepdim=True, unbiased=False)
    return (x - m) / torch.sqrt(v + eps)
def _scatter_add(tgt, idx, src, axis=0):
    return tgt.clone().index_add_(axis, idx, src)
def _segment_sum(src, seg, n):
    out = torch.zeros((n,) + src.shape[1:], dtype=src.dtype)
    return out.index_add_(0, seg, src)
def _pad(x, pw):
    flat = tuple(v for pair in reversed(pw) for v in pair)
    return torch.nn.functional.pad(x, flat)

kernel_name = 'interleave_layers__linear_attn_block__glu_gated_bilinear__prompt'

def setup_inputs():

    _w = (lambda a: (lambda t: t.to(torch.bfloat16) if t.is_floating_point() else t)(torch.as_tensor(a)))
    def _A_setup():
        B, S, D = 1, 2048, 640
        return {
            "x": _w((lambda *s: torch.randn(*s, dtype=torch.bfloat16) * 0.05)(B, S, D)),
            "wqkv": _w((lambda *s: torch.randn(*s, dtype=torch.bfloat16) * 0.05)(D, 3 * D)),
            "wo": _w((lambda *s: torch.randn(*s, dtype=torch.bfloat16) * 0.05)(D, D)),
        }
    _A_in = _A_setup()

    def _B_setup():
        B, S, D, F = 1, 2048, 640, 1728
        return {
            "x": _w((lambda *s: torch.randn(*s, dtype=torch.bfloat16) * 0.05)(B, S, D)),
            "w_gate": _w((lambda *s: torch.randn(*s, dtype=torch.bfloat16) * 0.8)(D, F) * (D ** -0.5)),
            "w_up": _w((lambda *s: torch.randn(*s, dtype=torch.bfloat16) * 0.8)(D, F) * (D ** -0.5)),
            "w_down": _w((lambda *s: torch.randn(*s, dtype=torch.bfloat16) * 0.8)(F, D) * (F ** -0.5)),
        }
    _B_in = _B_setup()

    return {
        "A_x": _A_in["x"],
        "A_wqkv": _A_in["wqkv"],
        "A_wo": _A_in["wo"],
        "B_x": _B_in["x"],
        "B_w_gate": _B_in["w_gate"],
        "B_w_up": _B_in["w_up"],
        "B_w_down": _B_in["w_down"],
    }

def reference(A_x, A_wqkv, A_wo, B_x, B_w_gate, B_w_up, B_w_down):
    def _A_ref(x, wqkv, wo):
        B, S, D = x.shape
        H = 32; Dh = D // H
        qkv = (lambda x, *d: x.permute(*d))((x @ wqkv).reshape(B, S, 3, H, Dh), 2, 0, 3, 1, 4)
        q, k, v = qkv[0], qkv[1], qkv[2]
        phi = lambda t: torch.where(t > 0, t + 1, torch.exp(t)) + 1e-6
        pq, pk = phi(q), phi(k)
        kv = torch.einsum("bhsd,bhse->bhde", pk, v)
        z = torch.einsum("bhsd->bhd", pk)
        num = torch.einsum("bhqd,bhde->bhqe", pq, kv)
        den = torch.einsum("bhqd,bhd->bhq", pq, z)[..., None] + 1e-6
        o = num / den
        return (lambda x, *d: x.permute(*d))(o, 0, 2, 1, 3).reshape(B, S, D) @ wo

    def _B_ref(x, w_gate, w_up, w_down):
        g = torch.einsum("bsd,df->bsf", x, w_gate)
        u = torch.einsum("bsd,df->bsf", x, w_up)
        h = g * u
        return torch.einsum("bsf,fd->bsd", h, w_down)

    x = A_x
    x = x + _A_ref(_layernorm(x, axis=-1), A_wqkv, A_wo)
    x = x + _B_ref(_layernorm(x, axis=-1), B_w_gate, B_w_up, B_w_down)
    x = x + _A_ref(_layernorm(x, axis=-1), A_wqkv, A_wo)
    x = x + _B_ref(_layernorm(x, axis=-1), B_w_gate, B_w_up, B_w_down)
    return x
```

```asm
; @launch grid=(256,1,1) block=(256,1,1) lds=163840
.amdgcn_target "amdgcn-amd-amdhsa--gfx950"
.text
.globl interleave_layers__linear_attn_block__glu_gated_bilinear__prompt_kernel
.p2align 8
.type interleave_layers__linear_attn_block__glu_gated_bilinear__prompt_kernel,@function
interleave_layers__linear_attn_block__glu_gated_bilinear__prompt_kernel:
  s_cmp_ge_u32 s2, 256
  s_cbranch_scc1 L_end
  s_load_dwordx2 s[4:5], s[0:1], 72
  s_load_dwordx2 s[8:9], s[0:1], 56
  s_load_dwordx2 s[12:13], s[0:1], 64
  s_load_dwordx16 s[28:43], s[0:1], 0
  s_mov_b32 s6, 268435456
  s_mov_b32 s7, 0x20000
  s_mov_b32 s10, 2621440
  s_mov_b32 s11, 0x20000
  v_lshrrev_b32 v1, 6, v0
  s_nop 0
  v_readfirstlane_b32 s18, v1
  v_and_b32 v1, 63, v0
  v_lshlrev_b32 v2, 4, v1
  v_and_b32 v3, 15, v1
  v_lshrrev_b32 v4, 4, v1
  s_mov_b32 s23, 1065369472
  v_mov_b32 v5, 0
  s_mov_b32 s14, 0
  s_mov_b32 s15, 0
  s_mov_b32 s19, 41280512
  s_or_b32 s24, s2, s18
  s_waitcnt lgkmcnt(0)
  s_cmp_lg_u32 s24, 0
  s_cbranch_scc1 L_n0
  buffer_load_dwordx2 v[20:21], v5, s[4:7], s19 offen sc1
L_n0:
  s_cmp_ge_u32 s2, 96
  s_cbranch_scc1 L_nopf
  s_getpc_b64 s[64:65]
L_pc:
  s_lshr_b32 s19, s2, 3
  s_lshl_b32 s19, s19, 12
  v_lshlrev_b32 v6, 4, v0
  v_add_u32 v6, s19, v6
  v_min_u32 v6, L_end-L_pc-12, v6
  global_load_dwordx4 v[48:51], v6, s[64:65]
L_nopf:
  s_mov_b32 s47, 0x20000
  s_mov_b32 s51, 0x20000
  v_bfe_u32 v115, v1, 2, 2
  v_and_b32 v114, 3, v1
  s_and_b32 s57, s18, 1
  s_mov_b32 s44, s28
  s_mov_b32 s45, s29
  s_mov_b32 s46, 2621440
  s_mov_b32 s48, s28
  s_mov_b32 s49, s29
  s_mov_b32 s50, 0
  v_lshrrev_b32 v117, 3, v1
  s_lshl_b32 s19, s18, 3
  v_add_u32 v117, s19, v117
  v_and_b32 v118, 7, v1
  s_cmp_ge_u32 s2, 248
  s_cbranch_scc1 L_p0_Bissue
  s_cmp_ge_u32 s2, 120
  s_cbranch_scc1 L_p0_Xissue
  s_lshr_b32 s73, s2, 2
  s_and_b32 s74, s2, 3
  s_mov_b32 s44, s30
  s_mov_b32 s45, s31
  s_mov_b32 s46, 2457600
  v_mul_u32_u24 v112, 3840, v117
  v_lshl_add_u32 v112, v118, 4, v112
  s_mul_i32 s53, s74, 614400
  s_lshl_b32 s19, s73, 7
  s_add_u32 s53, s53, s19
  s_lshl_b32 s19, s18, 10
  s_add_u32 m0, s19, 0
  s_add_u32 s20, s53, 0
  buffer_load_dwordx4 v112, s[44:47], s20 offen nt lds
  s_add_u32 m0, s19, 4096
  s_add_u32 s20, s53, 122880
  buffer_load_dwordx4 v112, s[44:47], s20 offen nt lds
  s_add_u32 m0, s19, 8192
  s_add_u32 s20, s53, 245760
  buffer_load_dwordx4 v112, s[44:47], s20 offen nt lds
  s_add_u32 m0, s19, 12288
  s_add_u32 s20, s53, 368640
  buffer_load_dwordx4 v112, s[44:47], s20 offen nt lds
  s_add_u32 m0, s19, 16384
  s_add_u32 s20, s53, 491520
  buffer_load_dwordx4 v112, s[44:47], s20 offen nt lds
  s_branch L_p0_Bissue
L_p0_Xissue:
  s_sub_u32 s73, s2, 120
  v_mul_u32_u24 v112, 1280, v3
  v_lshl_add_u32 v112, v4, 4, v112
  s_mul_i32 s75, s73, 20480
  s_mul_i32 s19, s18, 320
  s_add_u32 s19, s19, s75
  buffer_load_dwordx4 v[136:139], v112, s[44:47], s19 offen offset:0 nt
  buffer_load_dwordx4 v[140:143], v112, s[44:47], s19 offen offset:64 nt
  buffer_load_dwordx4 v[144:147], v112, s[44:47], s19 offen offset:128 nt
  buffer_load_dwordx4 v[148:151], v112, s[44:47], s19 offen offset:192 nt
  buffer_load_dwordx4 v[152:155], v112, s[44:47], s19 offen offset:256 nt
L_p0_Bissue:
  s_sub_u32 s60, 255, s2
  s_mov_b32 s66, 0
  s_mov_b32 s52, 0
  s_mov_b32 s53, 0
  s_mov_b32 s68, 3
  s_lshl_b32 s69, s18, 5
  s_cmp_ge_u32 s60, 228
  s_cbranch_scc1 L_p0_strip
  s_cmp_ge_u32 s60, 108
  s_cbranch_scc1 L_p0_DO
  s_and_b32 s72, s60, 1
  s_bfe_u32 s70, s60, 0x10001
  s_lshr_b32 s71, s60, 2
  s_mov_b32 s66, 1
  s_cmp_eq_u32 s72, 0
  s_cselect_b32 s48, s36, s38
  s_cselect_b32 s49, s37, s39
  s_mov_b32 s50, 2211840
  s_mov_b32 s52, 3456
  s_mul_i32 s53, s70, 1105920
  s_lshl_b32 s19, s71, 7
  s_add_u32 s53, s53, s19
  s_branch L_p0_strip
L_p0_DO:
  s_sub_u32 s71, s60, 108
  s_mul_i32 s70, s71, 103
  s_lshr_b32 s70, s70, 10
  s_mul_i32 s19, s70, 10
  s_sub_u32 s71, s71, s19
  s_lshl_b32 s54, s71, 1
  s_lshr_b32 s19, s18, 1
  s_add_u32 s54, s54, s19
  s_mul_i32 s55, s54, 13
  s_lshr_b32 s55, s55, 6
  s_mul_i32 s19, s55, 5
  s_sub_u32 s56, s54, s19
  s_cmp_gt_u32 s56, 2
  s_cselect_b32 s58, 1, 0
  s_cselect_b32 s19, 3, 0
  s_sub_u32 s19, s56, s19
  s_lshl_b32 s19, s19, 1
  s_add_u32 s59, s19, s57
  s_cmp_eq_u32 s56, 2
  s_cselect_b32 s58, s57, s58
  s_cselect_b32 s59, 4, s59
  s_cselect_b32 s68, 3, 4
  s_cselect_b32 s69, 32, 8
  s_mul_i32 s69, s69, s57
  s_lshl_b32 s55, s55, 1
  s_add_u32 s58, s58, s55
  s_lshr_b32 s19, s18, 1
  s_lshl_b32 s19, s19, 6
  s_add_u32 s69, s69, s19
  s_lshl_b32 s59, s59, 10
  s_mov_b32 s52, 1280
  s_lshl_b32 s71, s71, 7
  s_cmp_ge_u32 s70, 8
  s_cbranch_scc1 L_p0_O
  s_mov_b32 s48, s40
  s_mov_b32 s49, s41
  s_add_u32 s19, s70, 1
  s_mul_i32 s19, s19, 286720
  s_min_u32 s50, s19, 2211840
  s_mul_i32 s53, s70, 286720
  s_add_u32 s53, s53, s71
  s_mov_b32 s66, 2
  s_mul_i32 s67, s58, 276480
  s_add_u32 s67, s67, s59
  s_add_u32 s67, s67, 8242176
  s_branch L_p0_strip
L_p0_O:
  s_sub_u32 s70, s70, 8
  s_mov_b32 s48, s32
  s_mov_b32 s49, s33
  s_add_u32 s19, s70, 1
  s_mul_i32 s50, s19, 204800
  s_mul_i32 s53, s70, 204800
  s_add_u32 s53, s53, s71
  s_mov_b32 s66, 3
  s_mul_i32 s67, s58, 102400
  s_add_u32 s67, s67, s59
  s_mul_i32 s19, s70, 25600
  s_add_u32 s67, s67, s19
  s_add_u32 s67, s67, 2752512
L_p0_strip:
  v_mul_lo_u32 v112, v117, s52
  v_lshl_add_u32 v112, v118, 4, v112
  s_lshl_b32 s19, s18, 10
  s_lshl_b32 s20, s52, 5
  s_add_u32 m0, s19, 20480
  s_nop 0
  buffer_load_dwordx4 v112, s[48:51], s53 offen nt lds
  s_add_u32 m0, s19, 24576
  s_add_u32 s53, s53, s20
  buffer_load_dwordx4 v112, s[48:51], s53 offen nt lds
  s_add_u32 m0, s19, 28672
  s_add_u32 s53, s53, s20
  buffer_load_dwordx4 v112, s[48:51], s53 offen nt lds
  s_add_u32 m0, s19, 32768
  s_add_u32 s53, s53, s20
  buffer_load_dwordx4 v112, s[48:51], s53 offen nt lds
  s_add_u32 m0, s19, 36864
  s_add_u32 s53, s53, s20
  buffer_load_dwordx4 v112, s[48:51], s53 offen nt lds
  s_add_u32 m0, s19, 40960
  s_add_u32 s53, s53, s20
  buffer_load_dwordx4 v112, s[48:51], s53 offen nt lds
  s_add_u32 m0, s19, 45056
  s_add_u32 s53, s53, s20
  buffer_load_dwordx4 v112, s[48:51], s53 offen nt lds
  s_add_u32 m0, s19, 49152
  s_add_u32 s53, s53, s20
  buffer_load_dwordx4 v112, s[48:51], s53 offen nt lds
  s_add_u32 m0, s19, 53248
  s_add_u32 s53, s53, s20
  buffer_load_dwordx4 v112, s[48:51], s53 offen nt lds
  s_add_u32 m0, s19, 57344
  s_add_u32 s53, s53, s20
  buffer_load_dwordx4 v112, s[48:51], s53 offen nt lds
  s_or_b32 s24, s2, s18
  s_cmp_lg_u32 s24, 0
  s_cbranch_scc1 L_n1
  s_waitcnt vmcnt(16)
  v_readfirstlane_b32 s14, v20
  v_readfirstlane_b32 s15, v21
  s_nop 0
  s_add_u32 s14, s14, 1
  s_max_u32 s14, s14, 1
  s_add_u32 s15, s15, 0x9e3779b9
  s_mov_b32 s19, 41280512
  v_mov_b32 v20, s14
  v_mov_b32 v21, s15
  s_mov_b64 exec, 1
  buffer_store_dwordx2 v[20:21], v5, s[4:7], s19 offen sc1
  s_mov_b64 exec, -1
  s_mov_b64 exec, 1
  global_store_dwordx2 v5, v[20:21], s[12:13] sc1
  s_mov_b64 exec, -1
L_n1:
  s_mov_b32 s34, 0xffff
  s_mov_b32 s35, 0xffff
  s_mov_b32 s32, 0
  s_mov_b32 s33, 0xffff
  s_mov_b32 s36, 0
  s_mov_b32 s16, 0x358637bd
  s_mov_b32 s17, 0x358637bd
  s_and_b32 s19, s2, 7
  s_lshr_b32 s38, s19, 2
  s_lshl_b32 s38, s38, 2
  s_lshr_b32 s20, s2, 6
  s_add_u32 s38, s38, s20
  s_and_b32 s19, s19, 3
  s_lshl_b32 s37, s19, 3
  s_bfe_u32 s19, s2, 0x30003
  s_add_u32 s37, s37, s19
  s_lshr_b32 s39, s37, 4
  s_lshl_b32 s39, s39, 2
  s_and_b32 s19, s37, 3
  s_add_u32 s39, s39, s19
  s_bfe_u32 s60, s37, 0x20002
  s_mul_i32 s40, s18, 1024
  s_mul_i32 s41, s18, 2048
  s_mul_i32 s42, s18, 4096
  s_mul_i32 s43, s18, 7168
  s_lshl_b32 s59, s38, 2
  s_add_u32 s51, s59, s18
  s_lshl_b32 s51, s51, 1
  s_add_u32 s52, s59, s60
  s_lshl_b32 s52, s52, 1
  s_lshl_b32 s55, s51, 7
  s_add_u32 s55, s55, 41128960
  s_lshl_b32 s56, s52, 7
  s_add_u32 s56, s56, 41128960
  s_mul_i32 s19, s37, 86016
  s_add_u32 s19, s19, 0
  s_add_u32 s44, s19, s42
  s_add_u32 s45, s19, s40
  s_mul_i32 s19, s37, 150528
  s_add_u32 s19, s19, 3571712
  s_add_u32 s47, s19, s43
  s_add_u32 s48, s19, s41
  s_mul_i32 s19, s39, 102400
  s_mul_i32 s20, s18, 25600
  s_add_u32 s19, s19, s20
  s_add_u32 s46, s19, 2752512
  s_mul_i32 s61, s18, 14
  s_cmp_eq_u32 s18, 3
  s_cselect_b32 s61, 41, s61
  s_cmp_ge_u32 s18, 2
  s_cselect_b32 s62, 2146435072, 0
  s_mul_i32 s19, s39, 276480
  s_mul_i32 s20, s61, 5120
  s_add_u32 s19, s19, s20
  s_add_u32 s49, s19, 8242176
  s_add_u32 s50, s49, s62
  s_lshl_b32 s61, s61, 10
  s_and_b32 s19, s18, 1
  s_add_u32 s19, s19, s52
  s_mul_i32 s20, s19, 20480
  s_lshr_b32 s19, s39, 1
  s_mul_i32 s19, s19, 5120
  s_add_u32 s19, s19, s20
  s_and_b32 s20, s39, 1
  s_mul_i32 s53, s20, 3072
  s_add_u32 s53, s53, s19
  s_lshl_b32 s54, s20, 9
  s_add_u32 s54, s54, s19
  s_add_u32 s54, s54, 2048
  v_lshlrev_b32 v8, 3, v1
  v_lshlrev_b32 v9, 3, v3
  v_lshl_add_u32 v10, v4, 8, v9
  v_mov_b32 v16, v10
  v_lshrrev_b32 v11, 1, v4
  v_lshl_add_u32 v11, v11, 4, v3
  v_lshlrev_b32 v11, 4, v11
  v_and_b32 v6, 1, v4
  v_lshl_add_u32 v11, v6, 3, v11
  v_add_u32 v12, 65536, v2
  v_add_u32 v13, 131072, v2
  v_add_u32 v14, 20480, v2
  v_add_u32 v15, 55296, v2
  v_mov_b32 v7, 2146435072
  v_cmp_gt_u32 vcc, 2, v4
  s_nop 1
  v_cndmask_b32 v17, v7, v2, vcc
  v_cmp_eq_u32 vcc, 2, v4
  s_nop 1
  v_cndmask_b32 v18, v7, v9, vcc
  v_lshlrev_b32 v24, 2, v1
  s_lshl_b32 s19, s18, 9
  v_add_u32 v24, s19, v24
  v_add_u32 v25, 256, v24
  v_mov_b32 v26, v24
  v_mov_b32 v27, v25
  s_cmp_lt_u32 s18, 2
  s_cbranch_scc1 L_kvc
  v_and_b32 v6, 3, v1
  v_lshlrev_b32 v6, 2, v6
  v_bfe_u32 v7, v1, 2, 2
  v_lshl_add_u32 v7, v7, 4, v6
  v_lshl_add_u32 v24, v4, 8, v7
  v_add_u32 v24, 1088, v24
  v_lshlrev_b32 v25, 2, v1
  v_add_u32 v25, 2048, v25
  v_mov_b32 v26, v24
  v_mov_b32 v27, v25
  s_cmp_eq_u32 s18, 2
  s_cbranch_scc1 L_kvc
  v_lshrrev_b32 v24, 2, v1
  v_lshl_add_u32 v24, v24, 8, v6
  v_add_u32 v24, 1216, v24
  v_add_u32 v7, 3136, v7
  v_cmp_lt_u32 vcc, 15, v1
  s_nop 1
  v_cndmask_b32 v24, v24, v7, vcc
  v_add_u32 v6, 3264, v6
  v_cmp_lt_u32 vcc, 31, v1
  s_nop 1
  v_cndmask_b32 v24, v24, v6, vcc
  v_mov_b32 v27, 2146435072
  v_cmp_lt_u32 vcc, 35, v1
  s_nop 1
  v_cndmask_b32 v26, v24, v27, vcc
L_kvc:
  v_and_b32 v6, 3, v1
  v_bfe_u32 v7, v1, 2, 1
  v_lshl_add_u32 v28, v7, 3, v6
  v_add_u32 v29, 4, v28
  v_mov_b32 v30, 76
  v_add_u32 v6, 68, v6
  v_cmp_lt_u32 vcc, 7, v3
  s_nop 1
  v_cndmask_b32 v28, v28, v6, vcc
  v_cndmask_b32 v29, v29, v30, vcc
  v_cmp_lt_u32 vcc, 11, v3
  s_nop 1
  v_cndmask_b32 v28, v28, v30, vcc
  v_mov_b32 v7, 2146435072
  v_cmp_eq_u32 vcc, 2, v4
  v_lshlrev_b32 v28, 4, v28
  v_add_u32 v6, 2048, v28
  v_cndmask_b32 v31, v7, v6, vcc
  v_lshl_add_u32 v28, v4, 8, v28
  v_lshlrev_b32 v29, 4, v29
  v_add_u32 v6, 2048, v29
  v_cndmask_b32 v32, v7, v6, vcc
  v_lshl_add_u32 v29, v4, 8, v29
  v_lshlrev_b32 v30, 4, v30
  v_add_u32 v6, 2048, v30
  v_cndmask_b32 v33, v7, v6, vcc
  v_lshl_add_u32 v30, v4, 8, v30
  v_cmp_gt_u32 s[28:29], 4, v3
  v_cmp_lt_u32 s[30:31], 11, v3
  v_lshlrev_b32 v6, 4, v3
  v_lshl_add_u32 v34, v4, 7, v6
  v_add_u32 v6, 512, v6
  s_cmp_eq_u32 s37, 30
  s_cselect_b32 s19, 2146435072, 0
  v_add_u32 v6, s19, v6
  v_cmp_eq_u32 vcc, 1, v4
  s_nop 1
  v_cndmask_b32 v35, v34, v7, vcc
  v_cndmask_b32 v34, v34, v6, vcc
  v_cmp_eq_u32 vcc, 3, v4
  s_nop 1
  v_cndmask_b32 v34, v34, v7, vcc
  v_cndmask_b32 v35, v35, v6, vcc
  v_bfe_u32 v6, v1, 2, 1
  v_mul_u32_u24 v6, 19, v6
  v_lshrrev_b32 v7, 3, v1
  v_mul_u32_u24 v36, 640, v7
  v_add_u32 v6, v6, v36
  s_mul_i32 s19, s37, 20
  v_add_u32 v6, s19, v6
  v_lshrrev_b32 v6, 6, v6
  v_and_b32 v36, 3, v1
  v_lshl_add_u32 v6, v6, 2, v36
  v_lshlrev_b32 v6, 3, v6
  v_add_u32 v36, 41276416, v6
  s_lshl_b32 s20, s38, 6
  s_add_u32 s20, s20, 41277248
  v_add_u32 v6, s20, v8
  v_cmp_lt_u32 vcc, 23, v1
  s_nop 1
  v_cndmask_b32 v36, v36, v6, vcc
  v_add_u32 v6, 448, v6
  v_cmp_lt_u32 vcc, 31, v1
  s_nop 1
  v_cndmask_b32 v36, v36, v6, vcc
  v_mov_b32 v120, s23
  v_mov_b32 v132, 0
  v_mov_b32 v121, s23
  v_mov_b32 v133, 0
  v_mov_b32 v122, s23
  v_mov_b32 v134, 0
  v_mov_b32 v123, s23
  v_mov_b32 v135, 0
  s_cmp_ge_u32 s2, 248
  s_cbranch_scc1 L_p0_Aflag
  s_cmp_ge_u32 s2, 120
  s_cbranch_scc1 L_p0_Xfin
  s_mul_i32 s76, s73, 13
  s_lshr_b32 s76, s76, 7
  s_mul_i32 s19, s76, 10
  s_sub_u32 s19, s73, s19
  s_lshl_b32 s19, s19, 2
  s_add_u32 s19, s19, s18
  s_lshl_b32 s19, s19, 4
  v_add_u32 v117, s19, v3
  v_mul_u32_u24 v116, 205, v117
  v_lshrrev_b32 v116, 12, v116
  v_mul_u32_u24 v118, 20, v116
  v_sub_u32 v117, v117, v118
  s_cmp_eq_u32 s76, 0
  s_cselect_b32 s19, 192, 0
  s_cselect_b32 s20, 8, 0
  s_cmp_eq_u32 s76, 2
  s_cselect_b32 s19, 64, s19
  s_cselect_b32 s20, 4, s20
  s_add_u32 s20, s20, 112
  v_add_u32 v112, s19, v117
  v_add_u32 v113, s20, v117
  v_cmp_lt_u32 vcc, 15, v117
  s_nop 1
  v_cndmask_b32 v112, v112, v113, vcc
  v_mul_u32_u24 v116, 86016, v116
  v_lshl_add_u32 v118, v112, 4, v116
  v_lshl_add_u32 v118, v4, 8, v118
  v_lshl_add_u32 v117, v4, 3, v115
  v_lshlrev_b32 v117, 7, v117
  v_lshl_add_u32 v117, v114, 3, v117
  s_lshl_b32 s19, s18, 5
  v_add_u32 v117, s19, v117
  s_lshl_b32 s77, s2, 3
  s_add_u32 s77, s77, 41276416
  s_mul_i32 s75, s74, 20480
  s_add_u32 s75, s75, 0
  s_mov_b32 s20, 81920
  s_waitcnt vmcnt(10)
  s_barrier
  ds_read_b64_tr_b16 v[136:137], v117 offset:0
  ds_read_b64_tr_b16 v[138:139], v117 offset:512
  ds_read_b64_tr_b16 v[140:141], v117 offset:4096
  ds_read_b64_tr_b16 v[142:143], v117 offset:4608
  ds_read_b64_tr_b16 v[144:145], v117 offset:8192
  ds_read_b64_tr_b16 v[146:147], v117 offset:8704
  ds_read_b64_tr_b16 v[148:149], v117 offset:12288
  ds_read_b64_tr_b16 v[150:151], v117 offset:12800
  ds_read_b64_tr_b16 v[152:153], v117 offset:16384
  ds_read_b64_tr_b16 v[154:155], v117 offset:16896
  s_waitcnt lgkmcnt(0)
  buffer_store_dwordx4 v[136:139], v118, s[4:7], s75 offen sc1
  s_add_u32 s75, s75, 4096
  v_mfma_f32_16x16x32_bf16 v[124:127], v[120:123], v[136:139], 0
  buffer_store_dwordx4 v[140:143], v118, s[4:7], s75 offen sc1
  s_add_u32 s75, s75, 4096
  v_mfma_f32_16x16x32_bf16 v[124:127], v[120:123], v[140:143], v[124:127]
  buffer_store_dwordx4 v[144:147], v118, s[4:7], s75 offen sc1
  s_add_u32 s75, s75, 4096
  v_mfma_f32_16x16x32_bf16 v[124:127], v[120:123], v[144:147], v[124:127]
  buffer_store_dwordx4 v[148:151], v118, s[4:7], s75 offen sc1
  s_add_u32 s75, s75, 4096
  v_mfma_f32_16x16x32_bf16 v[124:127], v[120:123], v[148:151], v[124:127]
  buffer_store_dwordx4 v[152:155], v118, s[4:7], s75 offen sc1
  s_add_u32 s75, s75, 4096
  v_mfma_f32_16x16x32_bf16 v[124:127], v[120:123], v[152:155], v[124:127]
  s_nop 7
  v_cvt_pk_bf16_f32 v116, v124, v124
  v_lshlrev_b32 v116, 16, v116
  v_sub_f32 v129, v124, v116
  v_cvt_pk_bf16_f32 v128, v116, v129
  v_mov_b32 v130, 0
  v_mov_b32 v131, 0
  v_mov_b32 v129, v128
  v_cmp_eq_u32 vcc, s74, v4
  s_nop 0
  s_and_saveexec_b64 s[78:79], vcc
  buffer_store_dwordx4 v[128:131], v118, s[4:7], s20 offen sc1
  s_mov_b64 exec, -1
  s_branch L_p0_Aflag
L_p0_Xfin:
  s_mul_i32 s19, s18, 5120
  s_add_u32 s75, s75, s19
  s_add_u32 s75, s75, 10458112
  s_add_u32 s20, s75, 4096
  s_lshl_b32 s76, s73, 10
  s_add_u32 s76, s76, 40342528
  s_lshl_b32 s19, s18, 7
  s_add_u32 s76, s76, s19
  s_lshl_b32 s77, s73, 3
  s_add_u32 s77, s77, 41277440
  s_mov_b64 exec, 0xff
  buffer_store_dwordx4 v[132:135], v2, s[4:7], s76 offen offset:512 sc1
  s_mov_b64 exec, -1
  s_waitcnt vmcnt(11)
  buffer_store_dwordx4 v[136:139], v2, s[4:7], s75 offen offset:0 sc1
  buffer_store_dwordx4 v[140:143], v2, s[4:7], s75 offen offset:1024 sc1
  buffer_store_dwordx4 v[144:147], v2, s[4:7], s75 offen offset:2048 sc1
  buffer_store_dwordx4 v[148:151], v2, s[4:7], s75 offen offset:3072 sc1
  buffer_store_dwordx4 v[152:155], v2, s[4:7], s20 offen offset:0 sc1
  v_mov_b32 v124, 0
  v_mov_b32 v125, 0
  v_dot2c_f32_bf16 v124, s23, v136
  v_dot2c_f32_bf16 v125, v136, v136
  v_dot2c_f32_bf16 v124, s23, v137
  v_dot2c_f32_bf16 v125, v137, v137
  v_dot2c_f32_bf16 v124, s23, v138
  v_dot2c_f32_bf16 v125, v138, v138
  v_dot2c_f32_bf16 v124, s23, v139
  v_dot2c_f32_bf16 v125, v139, v139
  v_dot2c_f32_bf16 v124, s23, v140
  v_dot2c_f32_bf16 v125, v140, v140
  v_dot2c_f32_bf16 v124, s23, v141
  v_dot2c_f32_bf16 v125, v141, v141
  v_dot2c_f32_bf16 v124, s23, v142
  v_dot2c_f32_bf16 v125, v142, v142
  v_dot2c_f32_bf16 v124, s23, v143
  v_dot2c_f32_bf16 v125, v143, v143
  v_dot2c_f32_bf16 v124, s23, v144
  v_dot2c_f32_bf16 v125, v144, v144
  v_dot2c_f32_bf16 v124, s23, v145
  v_dot2c_f32_bf16 v125, v145, v145
  v_dot2c_f32_bf16 v124, s23, v146
  v_dot2c_f32_bf16 v125, v146, v146
  v_dot2c_f32_bf16 v124, s23, v147
  v_dot2c_f32_bf16 v125, v147, v147
  v_dot2c_f32_bf16 v124, s23, v148
  v_dot2c_f32_bf16 v125, v148, v148
  v_dot2c_f32_bf16 v124, s23, v149
  v_dot2c_f32_bf16 v125, v149, v149
  v_dot2c_f32_bf16 v124, s23, v150
  v_dot2c_f32_bf16 v125, v150, v150
  v_dot2c_f32_bf16 v124, s23, v151
  v_dot2c_f32_bf16 v125, v151, v151
  v_dot2c_f32_bf16 v124, s23, v152
  v_dot2c_f32_bf16 v125, v152, v152
  v_dot2c_f32_bf16 v124, s23, v153
  v_dot2c_f32_bf16 v125, v153, v153
  v_dot2c_f32_bf16 v124, s23, v154
  v_dot2c_f32_bf16 v125, v154, v154
  v_dot2c_f32_bf16 v124, s23, v155
  v_dot2c_f32_bf16 v125, v155, v155
  s_nop 2
  v_permlane32_swap_b32 v124, v125
  v_add_f32 v124, v124, v125
  v_mov_b32 v126, v124
  s_nop 1
  v_permlane16_swap_b32 v124, v126
  v_add_f32 v124, v124, v126
  v_mov_b32 v125, v124
  s_nop 1
  v_permlane32_swap_b32 v124, v125
  s_mov_b64 exec, 0xffff
  buffer_store_dwordx2 v[124:125], v9, s[4:7], s76 offen sc1
  s_mov_b64 exec, -1
L_p0_Aflag:
  global_load_dwordx2 v[20:21], v5, s[12:13] sc1
  s_waitcnt vmcnt(0)
  s_barrier
  s_cmp_lg_u32 s14, 0
  s_cbranch_scc1 L_nd
  s_mov_b32 s24, 0
  s_branch L_nc
L_np:
  global_load_dwordx2 v[20:21], v5, s[12:13] sc1
  s_add_u32 s24, s24, 1
  s_waitcnt vmcnt(0)
L_nc:
  v_readfirstlane_b32 s14, v20
  v_readfirstlane_b32 s15, v21
  s_nop 0
  s_cmp_lg_u32 s14, 0
  s_cbranch_scc1 L_nd
  s_sleep 1
  s_cmp_lt_u32 s24, 100000
  s_cbranch_scc1 L_np
L_nd:
  s_cmp_ge_u32 s2, 248
  s_cbranch_scc1 L_p0_nf
  s_cmp_lg_u32 s18, 0
  s_cbranch_scc1 L_p0_nf
  v_mov_b32 v20, s14
  v_mov_b32 v21, s15
  s_mov_b64 exec, 1
  buffer_store_dwordx2 v[20:21], v5, s[4:7], s77 offen sc1
  s_mov_b64 exec, -1
L_p0_nf:
  v_lshlrev_b32 v113, s68, v114
  v_add_u32 v113, s69, v113
  v_add_u32 v113, 20480, v113
  s_lshl_b32 s19, s2, 2
  s_add_u32 s19, s19, s18
  s_lshl_b32 s19, s19, 8
  s_add_u32 s19, s19, 40866816
  s_mov_b64 exec, 0xffff
  buffer_store_dwordx4 v[132:135], v2, s[4:7], s19 offen sc1
  s_mov_b64 exec, -1
  v_lshl_add_u32 v112, v4, 3, v115
  v_lshl_add_u32 v112, v112, 7, v113
  s_cmp_eq_u32 s66, 0
  s_cbranch_scc1 L_p0_end
  s_cmp_eq_u32 s66, 2
  s_cbranch_scc1 L_p0_D2
  s_cmp_eq_u32 s66, 3
  s_cbranch_scc1 L_p0_O2
  ds_read_b64_tr_b16 v[136:137], v112 offset:0
  ds_read_b64_tr_b16 v[138:139], v112 offset:512
  ds_read_b64_tr_b16 v[140:141], v112 offset:4096
  ds_read_b64_tr_b16 v[142:143], v112 offset:4608
  ds_read_b64_tr_b16 v[144:145], v112 offset:8192
  ds_read_b64_tr_b16 v[146:147], v112 offset:8704
  ds_read_b64_tr_b16 v[148:149], v112 offset:12288
  ds_read_b64_tr_b16 v[150:151], v112 offset:12800
  ds_read_b64_tr_b16 v[152:153], v112 offset:16384
  ds_read_b64_tr_b16 v[154:155], v112 offset:16896
  ds_read_b64_tr_b16 v[156:157], v112 offset:20480
  ds_read_b64_tr_b16 v[158:159], v112 offset:20992
  ds_read_b64_tr_b16 v[160:161], v112 offset:24576
  ds_read_b64_tr_b16 v[162:163], v112 offset:25088
  ds_read_b64_tr_b16 v[164:165], v112 offset:28672
  ds_read_b64_tr_b16 v[166:167], v112 offset:29184
  ds_read_b64_tr_b16 v[168:169], v112 offset:32768
  ds_read_b64_tr_b16 v[170:171], v112 offset:33280
  ds_read_b64_tr_b16 v[172:173], v112 offset:36864
  ds_read_b64_tr_b16 v[174:175], v112 offset:37376
  s_lshl_b32 s19, s71, 2
  s_add_u32 s19, s19, s18
  s_lshl_b32 s19, s19, 4
  v_add_u32 v117, s19, v3
  v_mul_u32_u24 v116, 2341, v117
  v_lshrrev_b32 v116, 17, v116
  v_mul_u32_u24 v118, 56, v116
  v_sub_u32 v117, v117, v118
  v_lshrrev_b32 v112, 3, v117
  v_lshlrev_b32 v112, 2, v112
  v_and_b32 v113, 3, v117
  v_add_u32 v112, v112, v113
  v_bfe_u32 v113, v117, 2, 1
  v_lshl_add_u32 v112, v113, 7, v112
  v_add_u32 v113, 224, v117
  v_cmp_lt_u32 vcc, 31, v117
  s_nop 1
  v_cndmask_b32 v112, v112, v113, vcc
  s_lshl_b32 s19, s72, 6
  v_add_u32 v112, s19, v112
  s_lshl_b32 s19, s72, 3
  s_add_u32 s19, s19, 336
  v_add_u32 v113, s19, v117
  v_cmp_lt_u32 vcc, 47, v117
  s_nop 1
  v_cndmask_b32 v112, v112, v113, vcc
  v_mul_u32_u24 v116, 150528, v116
  v_lshl_add_u32 v118, v112, 4, v116
  v_lshl_add_u32 v118, v4, 8, v118
  s_mul_i32 s67, s70, 71680
  s_add_u32 s67, s67, 3571712
  s_mov_b32 s20, 3715072
  s_waitcnt lgkmcnt(0)
  buffer_store_dwordx4 v[136:139], v118, s[4:7], s67 offen sc1
  s_add_u32 s67, s67, 7168
  v_mfma_f32_16x16x32_bf16 v[124:127], v[120:123], v[136:139], 0
  buffer_store_dwordx4 v[140:143], v118, s[4:7], s67 offen sc1
  s_add_u32 s67, s67, 7168
  v_mfma_f32_16x16x32_bf16 v[124:127], v[120:123], v[140:143], v[124:127]
  buffer_store_dwordx4 v[144:147], v118, s[4:7], s67 offen sc1
  s_add_u32 s67, s67, 7168
  v_mfma_f32_16x16x32_bf16 v[124:127], v[120:123], v[144:147], v[124:127]
  buffer_store_dwordx4 v[148:151], v118, s[4:7], s67 offen sc1
  s_add_u32 s67, s67, 7168
  v_mfma_f32_16x16x32_bf16 v[124:127], v[120:123], v[148:151], v[124:127]
  buffer_store_dwordx4 v[152:155], v118, s[4:7], s67 offen sc1
  s_add_u32 s67, s67, 7168
  v_mfma_f32_16x16x32_bf16 v[124:127], v[120:123], v[152:155], v[124:127]
  buffer_store_dwordx4 v[156:159], v118, s[4:7], s67 offen sc1
  s_add_u32 s67, s67, 7168
  v_mfma_f32_16x16x32_bf16 v[124:127], v[120:123], v[156:159], v[124:127]
  buffer_store_dwordx4 v[160:163], v118, s[4:7], s67 offen sc1
  s_add_u32 s67, s67, 7168
  v_mfma_f32_16x16x32_bf16 v[124:127], v[120:123], v[160:163], v[124:127]
  buffer_store_dwordx4 v[164:167], v118, s[4:7], s67 offen sc1
  s_add_u32 s67, s67, 7168
  v_mfma_f32_16x16x32_bf16 v[124:127], v[120:123], v[164:167], v[124:127]
  buffer_store_dwordx4 v[168:171], v118, s[4:7], s67 offen sc1
  s_add_u32 s67, s67, 7168
  v_mfma_f32_16x16x32_bf16 v[124:127], v[120:123], v[168:171], v[124:127]
  buffer_store_dwordx4 v[172:175], v118, s[4:7], s67 offen sc1
  s_add_u32 s67, s67, 7168
  v_mfma_f32_16x16x32_bf16 v[124:127], v[120:123], v[172:175], v[124:127]
  s_nop 7
  v_cvt_pk_bf16_f32 v116, v124, v124
  v_lshlrev_b32 v116, 16, v116
  v_sub_f32 v129, v124, v116
  v_cvt_pk_bf16_f32 v128, v116, v129
  v_mov_b32 v130, 0
  v_mov_b32 v131, 0
  v_cmp_eq_u32 vcc, s70, v4
  s_nop 1
  v_cndmask_b32 v128, 0, v128, vcc
  v_mov_b32 v129, v128
  v_and_b32 v116, 1, v4
  v_cmp_eq_u32 vcc, s70, v116
  s_nop 0
  s_and_saveexec_b64 s[78:79], vcc
  buffer_store_dwordx4 v[128:131], v118, s[4:7], s20 offen sc1
  s_mov_b64 exec, -1
  s_branch L_p0_end
L_p0_D2:
  ds_read_b64_tr_b16 v[136:137], v112 offset:0
  ds_read_b64_tr_b16 v[138:139], v112 offset:512
  ds_read_b64_tr_b16 v[140:141], v112 offset:7168
  ds_read_b64_tr_b16 v[142:143], v112 offset:7680
  ds_read_b64_tr_b16 v[144:145], v112 offset:14336
  ds_read_b64_tr_b16 v[146:147], v112 offset:14848
  ds_read_b64_tr_b16 v[148:149], v112 offset:21504
  ds_read_b64_tr_b16 v[150:151], v112 offset:22016
  v_add_u32 v116, 0, v4
  v_mul_u32_u24 v117, 11, v116
  v_lshrrev_b32 v117, 5, v117
  v_mul_u32_u24 v117, 32, v117
  v_lshl_add_u32 v117, v116, 3, v117
  v_add_u32 v117, v117, v115
  v_lshl_add_u32 v117, v117, 7, v113
  ds_read_b64_tr_b16 v[152:153], v117 offset:4096
  ds_read_b64_tr_b16 v[154:155], v117 offset:4608
  v_add_u32 v116, 4, v4
  v_mul_u32_u24 v117, 11, v116
  v_lshrrev_b32 v117, 5, v117
  v_mul_u32_u24 v117, 32, v117
  v_lshl_add_u32 v117, v116, 3, v117
  v_add_u32 v117, v117, v115
  v_lshl_add_u32 v117, v117, 7, v113
  ds_read_b64_tr_b16 v[156:157], v117 offset:4096
  ds_read_b64_tr_b16 v[158:159], v117 offset:4608
  v_add_u32 v116, 8, v4
  v_mul_u32_u24 v117, 11, v116
  v_lshrrev_b32 v117, 5, v117
  v_mul_u32_u24 v117, 32, v117
  v_lshl_add_u32 v117, v116, 3, v117
  v_add_u32 v117, v117, v115
  v_lshl_add_u32 v117, v117, 7, v113
  ds_read_b64_tr_b16 v[160:161], v117 offset:4096
  ds_read_b64_tr_b16 v[162:163], v117 offset:4608
  s_mul_i32 s19, s70, 20480
  s_add_u32 s19, s19, s67
  s_mul_i32 s20, s70, 15360
  s_add_u32 s20, s20, s67
  s_add_u32 s20, s20, 158720
  s_waitcnt lgkmcnt(0)
  buffer_store_dwordx4 v[136:139], v2, s[4:7], s19 offen sc1
  s_add_u32 s19, s19, 5120
  buffer_store_dwordx4 v[140:143], v2, s[4:7], s19 offen sc1
  s_add_u32 s19, s19, 5120
  buffer_store_dwordx4 v[144:147], v2, s[4:7], s19 offen sc1
  s_add_u32 s19, s19, 5120
  s_cmp_eq_u32 s70, 7
  s_cselect_b32 s19, 2146435072, s19
  buffer_store_dwordx4 v[148:151], v2, s[4:7], s19 offen sc1
  s_add_u32 s19, s19, 5120
  buffer_store_dwordx4 v[152:155], v2, s[4:7], s20 offen sc1
  s_add_u32 s20, s20, 5120
  buffer_store_dwordx4 v[156:159], v2, s[4:7], s20 offen sc1
  s_add_u32 s20, s20, 5120
  s_cmp_eq_u32 s70, 7
  s_cselect_b32 s20, 2146435072, s20
  buffer_store_dwordx4 v[160:163], v2, s[4:7], s20 offen sc1
  s_add_u32 s20, s20, 5120
  s_branch L_p0_end
L_p0_O2:
  v_lshrrev_b32 v116, 1, v4
  v_mul_u32_u24 v116, 20, v116
  v_and_b32 v112, 1, v4
  v_lshl_add_u32 v112, v112, 3, v116
  v_add_u32 v112, v112, v115
  v_lshl_add_u32 v112, v112, 7, v113
  ds_read_b64_tr_b16 v[136:137], v112 offset:0
  ds_read_b64_tr_b16 v[138:139], v112 offset:512
  ds_read_b64_tr_b16 v[140:141], v112 offset:5120
  ds_read_b64_tr_b16 v[142:143], v112 offset:5632
  ds_read_b64_tr_b16 v[144:145], v112 offset:10240
  ds_read_b64_tr_b16 v[146:147], v112 offset:10752
  ds_read_b64_tr_b16 v[148:149], v112 offset:15360
  ds_read_b64_tr_b16 v[150:151], v112 offset:15872
  v_mul_u32_u24 v116, 40, v4
  v_add_u32 v116, v116, v115
  v_lshl_add_u32 v116, v116, 7, v113
  ds_read_b64_tr_b16 v[152:153], v116 offset:2048
  ds_read_b64_tr_b16 v[154:155], v116 offset:4608
  s_waitcnt lgkmcnt(0)
  buffer_store_dwordx4 v[136:139], v2, s[4:7], s67 offen sc1
  s_add_u32 s67, s67, 5120
  buffer_store_dwordx4 v[140:143], v2, s[4:7], s67 offen sc1
  s_add_u32 s67, s67, 5120
  buffer_store_dwordx4 v[144:147], v2, s[4:7], s67 offen sc1
  s_add_u32 s67, s67, 5120
  buffer_store_dwordx4 v[148:151], v2, s[4:7], s67 offen sc1
  s_add_u32 s67, s67, 5120
  buffer_store_dwordx4 v[152:155], v2, s[4:7], s67 offen sc1
  s_add_u32 s67, s67, 5120
L_p0_end:
  s_cmp_lg_u32 s18, 0
  s_cbranch_scc1 L_goA
  s_mov_b32 s24, 0
  s_mov_b32 exec_hi, 0xff
L_pollA:
  buffer_load_dwordx2 v[20:21], v36, s[4:7], 0 offen sc1
  s_add_u32 s24, s24, 1
  s_waitcnt vmcnt(0)
  v_cmp_ne_u64 vcc, s[14:15], v[20:21]
  s_nop 0
  s_cmp_eq_u64 vcc, 0
  s_cbranch_scc1 L_pdA
  s_sleep 1
  s_cmp_lt_u32 s24, 100000
  s_cbranch_scc1 L_pollA
L_pdA:
  s_mov_b64 exec, -1
L_goA:
  s_waitcnt vmcnt(0)
  s_barrier
  s_cmp_lg_u32 s18, 0
  s_cbranch_scc1 L_nfb
  s_lshl_b32 s19, s2, 3
  s_add_u32 s19, s19, 41278464
  v_mov_b32 v20, s14
  v_mov_b32 v21, s15
  s_mov_b64 exec, 1
  buffer_store_dwordx2 v[20:21], v5, s[4:7], s19 offen sc1
  s_mov_b64 exec, -1
L_nfb:
  s_mul_i32 s58, s51, 20480
  s_add_u32 s58, s58, 10458112
  s_mov_b32 s36, -1
  s_add_u32 m0, s42, 0
  s_add_u32 s21, s44, 0
  buffer_load_dwordx4 v2, s[4:7], s21 offen offset:0 sc1 lds
  s_add_u32 m0, s42, 0
  s_add_u32 s21, s44, 0
  buffer_load_dwordx4 v2, s[4:7], s21 offen offset:1024 sc1 lds
  s_add_u32 m0, s42, 0
  s_add_u32 s21, s44, 0
  buffer_load_dwordx4 v2, s[4:7], s21 offen offset:2048 sc1 lds
  s_add_u32 m0, s42, 0
  s_add_u32 s21, s44, 0
  buffer_load_dwordx4 v2, s[4:7], s21 offen offset:3072 sc1 lds
  s_lshl_b32 s59, s51, 10
  s_mul_i32 s19, s36, 262144
  s_add_u32 s19, s19, 40604672
  s_add_u32 s19, s19, s59
  buffer_load_dwordx2 v[40:41], v10, s[4:7], s19 offen offset:0 sc1
  buffer_load_dwordx2 v[42:43], v10, s[4:7], s19 offen offset:128 sc1
  buffer_load_dwordx2 v[44:45], v10, s[4:7], s19 offen offset:1024 sc1
  buffer_load_dwordx2 v[46:47], v10, s[4:7], s19 offen offset:1152 sc1
  s_add_u32 s22, s58, 0
  buffer_load_dwordx4 v[48:51], v2, s[4:7], s22 offen offset:0 sc1
  s_add_u32 s22, s58, 0
  buffer_load_dwordx4 v[52:55], v14, s[4:7], s22 offen offset:0 sc1
  s_add_u32 s22, s58, 0
  buffer_load_dwordx4 v[56:59], v2, s[4:7], s22 offen offset:1024 sc1
  s_add_u32 s22, s58, 0
  buffer_load_dwordx4 v[60:63], v14, s[4:7], s22 offen offset:1024 sc1
  s_add_u32 m0, s42, 16384
  s_add_u32 s21, s44, 16384
  buffer_load_dwordx4 v2, s[4:7], s21 offen offset:0 sc1 lds
  s_add_u32 m0, s42, 16384
  s_add_u32 s21, s44, 16384
  buffer_load_dwordx4 v2, s[4:7], s21 offen offset:1024 sc1 lds
  s_add_u32 m0, s42, 16384
  s_add_u32 s21, s44, 16384
  buffer_load_dwordx4 v2, s[4:7], s21 offen offset:2048 sc1 lds
  s_add_u32 m0, s42, 16384
  s_add_u32 s21, s44, 16384
  buffer_load_dwordx4 v2, s[4:7], s21 offen offset:3072 sc1 lds
  s_add_u32 s22, s58, 0
  buffer_load_dwordx4 v[64:67], v2, s[4:7], s22 offen offset:2048 sc1
  s_add_u32 s22, s58, 0
  buffer_load_dwordx4 v[68:71], v14, s[4:7], s22 offen offset:2048 sc1
  s_add_u32 s22, s58, 0
  buffer_load_dwordx4 v[72:75], v2, s[4:7], s22 offen offset:3072 sc1
  s_add_u32 s22, s58, 0
  buffer_load_dwordx4 v[76:79], v14, s[4:7], s22 offen offset:3072 sc1
  s_add_u32 s22, s58, 4096
  buffer_load_dwordx4 v[80:83], v2, s[4:7], s22 offen offset:0 sc1
  s_add_u32 s22, s58, 4096
  buffer_load_dwordx4 v[84:87], v14, s[4:7], s22 offen offset:0 sc1
  s_mov_b32 s36, 0
L_loop:
  s_mul_i32 s59, s51, 20480
  s_mul_i32 s57, s36, 5242880
  s_add_u32 s57, s57, 11768832
  s_add_u32 s57, s57, s59
  s_add_u32 s22, s58, 4096
  buffer_load_dwordx4 v[88:91], v2, s[4:7], s22 offen offset:1024 sc1
  buffer_load_dwordx4 v[92:95], v14, s[4:7], s22 offen offset:1024 sc1
  buffer_load_dwordx4 v[96:99], v2, s[4:7], s22 offen offset:2048 sc1
  buffer_load_dwordx4 v[100:103], v14, s[4:7], s22 offen offset:2048 sc1
  buffer_load_dwordx4 v[104:107], v2, s[4:7], s22 offen offset:3072 sc1
  buffer_load_dwordx4 v[108:111], v14, s[4:7], s22 offen offset:3072 sc1
  s_cmp_lg_u32 s36, 0
  s_cbranch_scc1 L_l0s0
  s_waitcnt vmcnt(24)
  s_barrier
L_l0s0:
  ds_read_b128 a[160:163], v2 offset:0
  ds_read_b128 a[164:167], v2 offset:1024
  ds_read_b128 a[168:171], v2 offset:2048
  ds_read_b128 a[172:175], v2 offset:3072
  s_waitcnt lgkmcnt(0)
  s_waitcnt vmcnt(18)
  s_cmp_eq_u32 s36, 0
  s_cbranch_scc1 L_l0x0
  s_waitcnt vmcnt(14)
L_l0x0:
  s_cmp_lg_u32 s36, 0
  s_cbranch_scc1 L_l0w0
  s_add_u32 m0, s42, 32768
  s_add_u32 s21, s44, 32768
  buffer_load_dwordx4 v2, s[4:7], s21 offen offset:0 sc1 lds
  buffer_load_dwordx4 v2, s[4:7], s21 offen offset:1024 sc1 lds
L_l0w0:
  v_mfma_f32_16x16x32_bf16 v[112:115], v[48:51], a[160:163], 0
  ds_read_b128 a[176:179], v2 offset:4096
  v_mfma_f32_16x16x32_bf16 v[116:119], v[52:55], a[160:163], 0
  ds_read_b128 a[180:183], v2 offset:5120
  v_mfma_f32_16x16x32_bf16 v[120:123], v[48:51], a[164:167], 0
  v_mfma_f32_16x16x32_bf16 v[124:127], v[52:55], a[164:167], 0
  ds_read_b128 a[184:187], v2 offset:6144
  v_mfma_f32_16x16x32_bf16 v[128:131], v[48:51], a[168:171], 0
  ds_read_b128 a[188:191], v2 offset:7168
  v_mfma_f32_16x16x32_bf16 v[132:135], v[52:55], a[168:171], 0
  v_mfma_f32_16x16x32_bf16 v[168:171], a[168:171], v[48:51], 0
  v_mfma_f32_16x16x32_bf16 v[172:175], a[168:171], v[52:55], 0
  v_mfma_f32_16x16x32_bf16 v[160:163], a[172:175], v[48:51], 0
  v_mfma_f32_16x16x32_bf16 v[164:167], a[172:175], v[52:55], 0
  s_waitcnt lgkmcnt(0)
  s_waitcnt vmcnt(18)
  s_cmp_eq_u32 s36, 0
  s_cbranch_scc1 L_l0x1
  s_waitcnt vmcnt(12)
L_l0x1:
  s_cmp_lg_u32 s36, 0
  s_cbranch_scc1 L_l0w1
  s_add_u32 m0, s42, 32768
  s_add_u32 s21, s44, 32768
  buffer_load_dwordx4 v2, s[4:7], s21 offen offset:2048 sc1 lds
  buffer_load_dwordx4 v2, s[4:7], s21 offen offset:3072 sc1 lds
L_l0w1:
  v_mfma_f32_16x16x32_bf16 v[112:115], v[56:59], a[176:179], v[112:115]
  ds_read_b128 a[160:163], v2 offset:8192
  v_add_f32 v40, v40, v42
  v_mfma_f32_16x16x32_bf16 v[116:119], v[60:63], a[176:179], v[116:119]
  ds_read_b128 a[164:167], v2 offset:9216
  v_add_f32 v41, v41, v43
  v_mfma_f32_16x16x32_bf16 v[120:123], v[56:59], a[180:183], v[120:123]
  s_add_u32 s22, s58, 8192
  buffer_load_dwordx4 v[48:51], v2, s[4:7], s22 offen offset:0 sc1
  v_mov_b32 v6, v40
  v_mfma_f32_16x16x32_bf16 v[124:127], v[60:63], a[180:183], v[124:127]
  ds_read_b128 a[168:171], v2 offset:10240
  v_mfma_f32_16x16x32_bf16 v[128:131], v[56:59], a[184:187], v[128:131]
  ds_read_b128 a[172:175], v2 offset:11264
  v_permlane32_swap_b32 v40, v6
  v_mfma_f32_16x16x32_bf16 v[132:135], v[60:63], a[184:187], v[132:135]
  v_add_f32 v40, v40, v6
  v_mfma_f32_16x16x32_bf16 v[168:171], a[184:187], v[56:59], v[168:171]
  v_mfma_f32_16x16x32_bf16 v[172:175], a[184:187], v[60:63], v[172:175]
  buffer_load_dwordx4 v[52:55], v14, s[4:7], s22 offen offset:0 sc1
  v_mov_b32 v6, v40
  v_mfma_f32_16x16x32_bf16 v[160:163], a[188:191], v[56:59], v[160:163]
  s_nop 0
  v_permlane16_swap_b32 v40, v6
  v_mfma_f32_16x16x32_bf16 v[164:167], a[188:191], v[60:63], v[164:167]
  s_waitcnt lgkmcnt(0)
  s_waitcnt vmcnt(16)
  s_cmp_eq_u32 s36, 0
  s_cbranch_scc1 L_l0x2
  s_waitcnt vmcnt(12)
L_l0x2:
  s_cmp_lg_u32 s36, 0
  s_cbranch_scc1 L_l0w2
  s_add_u32 m0, s42, 49152
  s_add_u32 s21, s44, 49152
  buffer_load_dwordx4 v2, s[4:7], s21 offen offset:0 sc1 lds
  buffer_load_dwordx4 v2, s[4:7], s21 offen offset:1024 sc1 lds
L_l0w2:
  v_mfma_f32_16x16x32_bf16 v[112:115], v[64:67], a[160:163], v[112:115]
  ds_read_b128 a[176:179], v2 offset:12288
  v_add_f32 v40, v40, v6
  v_mfma_f32_16x16x32_bf16 v[116:119], v[68:71], a[160:163], v[116:119]
  ds_read_b128 a[180:183], v2 offset:13312
  v_mov_b32 v6, v41
  v_mfma_f32_16x16x32_bf16 v[120:123], v[64:67], a[164:167], v[120:123]
  buffer_load_dwordx4 v[56:59], v2, s[4:7], s22 offen offset:1024 sc1
  v_permlane32_swap_b32 v41, v6
  v_mfma_f32_16x16x32_bf16 v[124:127], v[68:71], a[164:167], v[124:127]
  ds_read_b128 a[184:187], v2 offset:14336
  v_add_f32 v41, v41, v6
  v_mfma_f32_16x16x32_bf16 v[128:131], v[64:67], a[168:171], v[128:131]
  ds_read_b128 a[188:191], v2 offset:15360
  v_mfma_f32_16x16x32_bf16 v[132:135], v[68:71], a[168:171], v[132:135]
  v_mov_b32 v6, v41
  v_mfma_f32_16x16x32_bf16 v[168:171], a[168:171], v[64:67], v[168:171]
  s_nop 0
  v_permlane16_swap_b32 v41, v6
  v_mfma_f32_16x16x32_bf16 v[172:175], a[168:171], v[68:71], v[172:175]
  buffer_load_dwordx4 v[60:63], v14, s[4:7], s22 offen offset:1024 sc1
  v_add_f32 v41, v41, v6
  v_mfma_f32_16x16x32_bf16 v[160:163], a[172:175], v[64:67], v[160:163]
  v_mul_f32 v40, 0xbacccccd, v40
  v_mfma_f32_16x16x32_bf16 v[164:167], a[172:175], v[68:71], v[164:167]
  s_waitcnt lgkmcnt(0)
  s_waitcnt vmcnt(18)
  s_cmp_eq_u32 s36, 0
  s_cbranch_scc1 L_l0x3
  s_waitcnt vmcnt(12)
L_l0x3:
  s_cmp_lg_u32 s36, 0
  s_cbranch_scc1 L_l0w3
  s_add_u32 m0, s42, 49152
  s_add_u32 s21, s44, 49152
  buffer_load_dwordx4 v2, s[4:7], s21 offen offset:2048 sc1 lds
  buffer_load_dwordx4 v2, s[4:7], s21 offen offset:3072 sc1 lds
L_l0w3:
  v_mfma_f32_16x16x32_bf16 v[112:115], v[72:75], a[176:179], v[112:115]
  s_cmp_lg_u32 s36, 0
  s_cbranch_scc1 L_l0s4
  s_waitcnt vmcnt(24)
  s_barrier
L_l0s4:
  ds_read_b128 a[160:163], v2 offset:16384
  v_mul_f32 v41, 0x3acccccd, v41
  v_mfma_f32_16x16x32_bf16 v[116:119], v[76:79], a[176:179], v[116:119]
  ds_read_b128 a[164:167], v2 offset:17408
  v_fma_f32 v41, -v40, v40, v41
  v_mfma_f32_16x16x32_bf16 v[120:123], v[72:75], a[180:183], v[120:123]
  buffer_load_dwordx4 v[64:67], v2, s[4:7], s22 offen offset:2048 sc1
  v_max_f32 v41, 0, v41
  v_mfma_f32_16x16x32_bf16 v[124:127], v[76:79], a[180:183], v[124:127]
  ds_read_b128 a[168:171], v2 offset:18432
  v_mfma_f32_16x16x32_bf16 v[128:131], v[72:75], a[184:187], v[128:131]
  ds_read_b128 a[172:175], v2 offset:19456
  v_add_f32 v41, 0x3727c5ac, v41
  v_mfma_f32_16x16x32_bf16 v[132:135], v[76:79], a[184:187], v[132:135]
  v_rsq_f32 v224, v41
  v_mfma_f32_16x16x32_bf16 v[168:171], a[184:187], v[72:75], v[168:171]
  v_mfma_f32_16x16x32_bf16 v[172:175], a[184:187], v[76:79], v[172:175]
  buffer_load_dwordx4 v[68:71], v14, s[4:7], s22 offen offset:2048 sc1
  v_cvt_pk_bf16_f32 v228, v40, v40
  v_mfma_f32_16x16x32_bf16 v[160:163], a[188:191], v[72:75], v[160:163]
  v_lshlrev_b32 v6, 16, v228
  v_mfma_f32_16x16x32_bf16 v[164:167], a[188:191], v[76:79], v[164:167]
  s_waitcnt lgkmcnt(0)
  s_waitcnt vmcnt(20)
  s_cmp_eq_u32 s36, 0
  s_cbranch_scc1 L_l0x4
  s_waitcnt vmcnt(12)
L_l0x4:
  s_cmp_lg_u32 s36, 0
  s_cbranch_scc1 L_l0w4
  s_add_u32 m0, s42, 65536
  s_add_u32 s21, s44, 65536
  buffer_load_dwordx4 v2, s[4:7], s21 offen offset:0 sc1 lds
  buffer_load_dwordx4 v2, s[4:7], s21 offen offset:1024 sc1 lds
L_l0w4:
  v_mfma_f32_16x16x32_bf16 v[112:115], v[80:83], a[160:163], v[112:115]
  ds_read_b128 a[176:179], v2 offset:20480
  v_sub_f32 v6, v40, v6
  v_mfma_f32_16x16x32_bf16 v[116:119], v[84:87], a[160:163], v[116:119]
  ds_read_b128 a[180:183], v2 offset:21504
  v_cvt_pk_bf16_f32 v229, v6, v6
  v_mfma_f32_16x16x32_bf16 v[120:123], v[80:83], a[164:167], v[120:123]
  buffer_load_dwordx4 v[72:75], v2, s[4:7], s22 offen offset:3072 sc1
  v_mov_b32 v230, 0
  v_mfma_f32_16x16x32_bf16 v[124:127], v[84:87], a[164:167], v[124:127]
  ds_read_b128 a[184:187], v2 offset:22528
  v_mov_b32 v231, 0
  v_mfma_f32_16x16x32_bf16 v[128:131], v[80:83], a[168:171], v[128:131]
  ds_read_b128 a[188:191], v2 offset:23552
  v_mfma_f32_16x16x32_bf16 v[132:135], v[84:87], a[168:171], v[132:135]
  v_add_f32 v44, v44, v46
  v_mfma_f32_16x16x32_bf16 v[168:171], a[168:171], v[80:83], v[168:171]
  v_add_f32 v45, v45, v47
  v_mfma_f32_16x16x32_bf16 v[172:175], a[168:171], v[84:87], v[172:175]
  buffer_load_dwordx4 v[76:79], v14, s[4:7], s22 offen offset:3072 sc1
  v_mov_b32 v6, v44
  v_mfma_f32_16x16x32_bf16 v[160:163], a[172:175], v[80:83], v[160:163]
  s_nop 0
  v_permlane32_swap_b32 v44, v6
  v_mfma_f32_16x16x32_bf16 v[164:167], a[172:175], v[84:87], v[164:167]
  s_waitcnt lgkmcnt(0)
  s_waitcnt vmcnt(12)
  s_cmp_lg_u32 s36, 0
  s_cbranch_scc1 L_l0w5
  s_add_u32 m0, s42, 65536
  s_add_u32 s21, s44, 65536
  buffer_load_dwordx4 v2, s[4:7], s21 offen offset:2048 sc1 lds
  buffer_load_dwordx4 v2, s[4:7], s21 offen offset:3072 sc1 lds
L_l0w5:
  v_mfma_f32_16x16x32_bf16 v[112:115], v[88:91], a[176:179], v[112:115]
  ds_read_b128 a[160:163], v2 offset:24576
  v_add_f32 v44, v44, v6
  v_mfma_f32_16x16x32_bf16 v[116:119], v[92:95], a[176:179], v[116:119]
  ds_read_b128 a[164:167], v2 offset:25600
  v_mov_b32 v6, v44
  v_mfma_f32_16x16x32_bf16 v[120:123], v[88:91], a[180:183], v[120:123]
  s_add_u32 s22, s58, 12288
  buffer_load_dwordx4 v[80:83], v2, s[4:7], s22 offen offset:0 sc1
  v_permlane16_swap_b32 v44, v6
  v_mfma_f32_16x16x32_bf16 v[124:127], v[92:95], a[180:183], v[124:127]
  ds_read_b128 a[168:171], v2 offset:26624
  v_add_f32 v44, v44, v6
  v_mfma_f32_16x16x32_bf16 v[128:131], v[88:91], a[184:187], v[128:131]
  ds_read_b128 a[172:175], v2 offset:27648
  v_mfma_f32_16x16x32_bf16 v[132:135], v[92:95], a[184:187], v[132:135]
  v_mov_b32 v6, v45
  v_mfma_f32_16x16x32_bf16 v[168:171], a[184:187], v[88:91], v[168:171]
  s_nop 0
  v_permlane32_swap_b32 v45, v6
  v_mfma_f32_16x16x32_bf16 v[172:175], a[184:187], v[92:95], v[172:175]
  buffer_load_dwordx4 v[84:87], v14, s[4:7], s22 offen offset:0 sc1
  v_add_f32 v45, v45, v6
  v_mfma_f32_16x16x32_bf16 v[160:163], a[188:191], v[88:91], v[160:163]
  v_mov_b32 v6, v45
  v_mfma_f32_16x16x32_bf16 v[164:167], a[188:191], v[92:95], v[164:167]
  s_waitcnt lgkmcnt(0)
  s_waitcnt vmcnt(12)
  s_cmp_lg_u32 s36, 0
  s_cbranch_scc1 L_l0w6
  s_add_u32 m0, s40, 81920
  s_add_u32 s21, s45, 81920
  buffer_load_dwordx4 v2, s[4:7], s21 offen offset:0 sc1 lds
L_l0w6:
  v_mfma_f32_16x16x32_bf16 v[112:115], v[96:99], a[160:163], v[112:115]
  ds_read_b128 a[176:179], v2 offset:28672
  v_permlane16_swap_b32 v45, v6
  v_mfma_f32_16x16x32_bf16 v[116:119], v[100:103], a[160:163], v[116:119]
  ds_read_b128 a[180:183], v2 offset:29696
  v_add_f32 v45, v45, v6
  v_mfma_f32_16x16x32_bf16 v[120:123], v[96:99], a[164:167], v[120:123]
  buffer_load_dwordx4 v[88:91], v2, s[4:7], s22 offen offset:1024 sc1
  v_mul_f32 v44, 0xbacccccd, v44
  v_mfma_f32_16x16x32_bf16 v[124:127], v[100:103], a[164:167], v[124:127]
  ds_read_b128 a[184:187], v2 offset:30720
  v_mfma_f32_16x16x32_bf16 v[128:131], v[96:99], a[168:171], v[128:131]
  ds_read_b128 a[188:191], v2 offset:31744
  v_mul_f32 v45, 0x3acccccd, v45
  v_mfma_f32_16x16x32_bf16 v[132:135], v[100:103], a[168:171], v[132:135]
  v_fma_f32 v45, -v44, v44, v45
  v_mfma_f32_16x16x32_bf16 v[168:171], a[168:171], v[96:99], v[168:171]
  v_mfma_f32_16x16x32_bf16 v[172:175], a[168:171], v[100:103], v[172:175]
  buffer_load_dwordx4 v[92:95], v14, s[4:7], s22 offen offset:1024 sc1
  v_max_f32 v45, 0, v45
  v_mfma_f32_16x16x32_bf16 v[160:163], a[172:175], v[96:99], v[160:163]
  v_add_f32 v45, 0x3727c5ac, v45
  v_mfma_f32_16x16x32_bf16 v[164:167], a[172:175], v[100:103], v[164:167]
  s_waitcnt lgkmcnt(0)
  s_waitcnt vmcnt(12)
  v_mfma_f32_16x16x32_bf16 v[112:115], v[104:107], a[176:179], v[112:115]
  s_cmp_lg_u32 s36, 0
  s_cbranch_scc1 L_l0s8
  s_waitcnt vmcnt(21)
  s_barrier
L_l0s8:
  s_cmp_lg_u32 s36, 0
  s_cbranch_scc1 L_cbe
  s_cmp_lg_u32 s18, 0
  s_cbranch_scc1 L_cb
  s_mov_b32 s19, 41278464
  s_mov_b32 s24, 0
L_cbp:
  buffer_load_dwordx2 v[136:137], v8, s[4:7], s19 offen offset:0 sc1
  buffer_load_dwordx2 v[138:139], v8, s[4:7], s19 offen offset:512 sc1
  buffer_load_dwordx2 v[140:141], v8, s[4:7], s19 offen offset:1024 sc1
  buffer_load_dwordx2 v[142:143], v8, s[4:7], s19 offen offset:1536 sc1
  s_add_u32 s24, s24, 1
  s_waitcnt vmcnt(0)
  v_xor_b32 v138, v136, v138
  v_xor_b32 v139, v137, v139
  v_xor_b32 v140, v136, v140
  v_xor_b32 v141, v137, v141
  v_xor_b32 v142, v136, v142
  v_xor_b32 v143, v137, v143
  v_or3_b32 v138, v138, v139, v140
  v_or3_b32 v141, v141, v142, v143
  v_or_b32 v138, v138, v141
  v_xor_b32 v136, s14, v136
  v_xor_b32 v137, s15, v137
  v_or3_b32 v136, v136, v137, v138
  v_cmp_ne_u32 vcc, 0, v136
  s_nop 0
  s_cmp_eq_u64 vcc, 0
  s_cbranch_scc1 L_cb
  s_sleep 1
  s_cmp_lt_u32 s24, 100000
  s_cbranch_scc1 L_cbp
L_cb:
  s_barrier
L_cbe:
  ds_read_b128 a[160:163], v2 offset:32768
  v_rsq_f32 v225, v45
  v_mfma_f32_16x16x32_bf16 v[116:119], v[108:111], a[176:179], v[116:119]
  ds_read_b128 a[164:167], v2 offset:33792
  v_cvt_pk_bf16_f32 v232, v44, v44
  v_mfma_f32_16x16x32_bf16 v[120:123], v[104:107], a[180:183], v[120:123]
  buffer_load_dwordx4 v[96:99], v2, s[4:7], s22 offen offset:2048 sc1
  v_lshlrev_b32 v6, 16, v232
  v_mfma_f32_16x16x32_bf16 v[124:127], v[108:111], a[180:183], v[124:127]
  ds_read_b128 a[168:171], v2 offset:34816
  v_sub_f32 v6, v44, v6
  v_mfma_f32_16x16x32_bf16 v[128:131], v[104:107], a[184:187], v[128:131]
  ds_read_b128 a[172:175], v2 offset:35840
  v_mfma_f32_16x16x32_bf16 v[132:135], v[108:111], a[184:187], v[132:135]
  v_cvt_pk_bf16_f32 v233, v6, v6
  v_mfma_f32_16x16x32_bf16 v[168:171], a[184:187], v[104:107], v[168:171]
  v_mov_b32 v234, 0
  v_mfma_f32_16x16x32_bf16 v[172:175], a[184:187], v[108:111], v[172:175]
  buffer_load_dwordx4 v[100:103], v14, s[4:7], s22 offen offset:2048 sc1
  v_mov_b32 v235, 0
  v_mfma_f32_16x16x32_bf16 v[160:163], a[188:191], v[104:107], v[160:163]
  v_lshlrev_b32 v6, 4, v4
  v_mfma_f32_16x16x32_bf16 v[164:167], a[188:191], v[108:111], v[164:167]
  s_waitcnt lgkmcnt(0)
  s_waitcnt vmcnt(12)
  v_mfma_f32_16x16x32_bf16 v[112:115], v[48:51], a[160:163], v[112:115]
  ds_read_b128 a[176:179], v2 offset:36864
  ds_bpermute_b32 v208, v6, v224 offset:0
  v_mfma_f32_16x16x32_bf16 v[116:119], v[52:55], a[160:163], v[116:119]
  ds_read_b128 a[180:183], v2 offset:37888
  ds_bpermute_b32 v209, v6, v224 offset:4
  v_mfma_f32_16x16x32_bf16 v[120:123], v[48:51], a[164:167], v[120:123]
  buffer_load_dwordx4 v[104:107], v2, s[4:7], s22 offen offset:3072 sc1
  ds_bpermute_b32 v210, v6, v224 offset:8
  v_mfma_f32_16x16x32_bf16 v[124:127], v[52:55], a[164:167], v[124:127]
  ds_read_b128 a[184:187], v2 offset:38912
  ds_bpermute_b32 v211, v6, v224 offset:12
  v_mfma_f32_16x16x32_bf16 v[128:131], v[48:51], a[168:171], v[128:131]
  ds_read_b128 a[188:191], v2 offset:39936
  v_mfma_f32_16x16x32_bf16 v[132:135], v[52:55], a[168:171], v[132:135]
  ds_bpermute_b32 v212, v6, v225 offset:0
  v_mfma_f32_16x16x32_bf16 v[168:171], a[168:171], v[48:51], v[168:171]
  ds_bpermute_b32 v213, v6, v225 offset:4
  v_mfma_f32_16x16x32_bf16 v[172:175], a[168:171], v[52:55], v[172:175]
  buffer_load_dwordx4 v[108:111], v14, s[4:7], s22 offen offset:3072 sc1
  ds_bpermute_b32 v214, v6, v225 offset:8
  v_mfma_f32_16x16x32_bf16 v[160:163], a[172:175], v[48:51], v[160:163]
  ds_bpermute_b32 v215, v6, v225 offset:12
  v_mfma_f32_16x16x32_bf16 v[164:167], a[172:175], v[52:55], v[164:167]
  s_waitcnt lgkmcnt(0)
  s_waitcnt vmcnt(12)
  s_mul_i32 s19, s36, 65536
  s_add_u32 s19, s19, -8192
  s_add_u32 s19, s19, s55
  buffer_load_dwordx2 v[22:23], v8, s[4:7], s19 offen sc1
  v_mfma_f32_16x16x32_bf16 v[112:115], v[56:59], a[176:179], v[112:115]
  ds_read_b128 a[160:163], v2 offset:40960
  v_mfma_f32_16x16x32_bf16 v[116:119], v[60:63], a[176:179], v[116:119]
  ds_read_b128 a[164:167], v2 offset:41984
  v_mfma_f32_16x16x32_bf16 v[120:123], v[56:59], a[180:183], v[120:123]
  s_add_u32 s22, s58, 16384
  buffer_load_dwordx4 v[48:51], v2, s[4:7], s22 offen offset:0 sc1
  v_mfma_f32_16x16x32_bf16 v[124:127], v[60:63], a[180:183], v[124:127]
  ds_read_b128 a[168:171], v2 offset:43008
  v_mfma_f32_16x16x32_bf16 v[128:131], v[56:59], a[184:187], v[128:131]
  ds_read_b128 a[172:175], v2 offset:44032
  v_mfma_f32_16x16x32_bf16 v[132:135], v[60:63], a[184:187], v[132:135]
  v_mfma_f32_16x16x32_bf16 v[168:171], a[184:187], v[56:59], v[168:171]
  v_mfma_f32_16x16x32_bf16 v[172:175], a[184:187], v[60:63], v[172:175]
  buffer_load_dwordx4 v[52:55], v14, s[4:7], s22 offen offset:0 sc1
  v_mfma_f32_16x16x32_bf16 v[160:163], a[188:191], v[56:59], v[160:163]
  v_mfma_f32_16x16x32_bf16 v[164:167], a[188:191], v[60:63], v[164:167]
  s_waitcnt lgkmcnt(0)
  s_waitcnt vmcnt(13)
  v_mfma_f32_16x16x32_bf16 v[112:115], v[64:67], a[160:163], v[112:115]
  ds_read_b128 a[176:179], v2 offset:45056
  v_mfma_f32_16x16x32_bf16 v[116:119], v[68:71], a[160:163], v[116:119]
  ds_read_b128 a[180:183], v2 offset:46080
  v_mfma_f32_16x16x32_bf16 v[120:123], v[64:67], a[164:167], v[120:123]
  buffer_load_dwordx4 v[56:59], v2, s[4:7], s22 offen offset:1024 sc1
  v_mfma_f32_16x16x32_bf16 v[124:127], v[68:71], a[164:167], v[124:127]
  ds_read_b128 a[184:187], v2 offset:47104
  v_mfma_f32_16x16x32_bf16 v[128:131], v[64:67], a[168:171], v[128:131]
  ds_read_b128 a[188:191], v2 offset:48128
  v_mfma_f32_16x16x32_bf16 v[132:135], v[68:71], a[168:171], v[132:135]
  v_mfma_f32_16x16x32_bf16 v[168:171], a[168:171], v[64:67], v[168:171]
  v_mfma_f32_16x16x32_bf16 v[172:175], a[168:171], v[68:71], v[172:175]
  buffer_load_dwordx4 v[60:63], v14, s[4:7], s22 offen offset:1024 sc1
  v_mfma_f32_16x16x32_bf16 v[160:163], a[172:175], v[64:67], v[160:163]
  v_mfma_f32_16x16x32_bf16 v[164:167], a[172:175], v[68:71], v[164:167]
  s_waitcnt lgkmcnt(0)
  s_waitcnt vmcnt(13)
  v_mfma_f32_16x16x32_bf16 v[112:115], v[72:75], a[176:179], v[112:115]
  s_cmp_lg_u32 s36, 0
  s_cbranch_scc1 L_l0s12
  s_waitcnt vmcnt(22)
  s_barrier
L_l0s12:
  ds_read_b128 a[160:163], v2 offset:49152
  v_mfma_f32_16x16x32_bf16 v[116:119], v[76:79], a[176:179], v[116:119]
  ds_read_b128 a[164:167], v2 offset:50176
  v_mfma_f32_16x16x32_bf16 v[120:123], v[72:75], a[180:183], v[120:123]
  buffer_load_dwordx4 v[64:67], v2, s[4:7], s22 offen offset:2048 sc1
  v_mfma_f32_16x16x32_bf16 v[124:127], v[76:79], a[180:183], v[124:127]
  ds_read_b128 a[168:171], v2 offset:51200
  v_mfma_f32_16x16x32_bf16 v[128:131], v[72:75], a[184:187], v[128:131]
  ds_read_b128 a[172:175], v2 offset:52224
  v_mfma_f32_16x16x32_bf16 v[132:135], v[76:79], a[184:187], v[132:135]
  v_mfma_f32_16x16x32_bf16 v[168:171], a[184:187], v[72:75], v[168:171]
  v_mfma_f32_16x16x32_bf16 v[172:175], a[184:187], v[76:79], v[172:175]
  buffer_load_dwordx4 v[68:71], v14, s[4:7], s22 offen offset:2048 sc1
  v_mfma_f32_16x16x32_bf16 v[160:163], a[188:191], v[72:75], v[160:163]
  v_mfma_f32_16x16x32_bf16 v[164:167], a[188:191], v[76:79], v[164:167]
  s_waitcnt lgkmcnt(0)
  s_waitcnt vmcnt(13)
  v_mfma_f32_16x16x32_bf16 v[112:115], v[80:83], a[160:163], v[112:115]
  ds_read_b128 a[176:179], v2 offset:53248
  v_mfma_f32_16x16x32_bf16 v[116:119], v[84:87], a[160:163], v[116:119]
  ds_read_b128 a[180:183], v2 offset:54272
  v_mfma_f32_16x16x32_bf16 v[120:123], v[80:83], a[164:167], v[120:123]
  buffer_load_dwordx4 v[72:75], v2, s[4:7], s22 offen offset:3072 sc1
  v_mfma_f32_16x16x32_bf16 v[124:127], v[84:87], a[164:167], v[124:127]
  ds_read_b128 a[184:187], v2 offset:55296
  v_mfma_f32_16x16x32_bf16 v[128:131], v[80:83], a[168:171], v[128:131]
  ds_read_b128 a[188:191], v2 offset:56320
  v_mfma_f32_16x16x32_bf16 v[132:135], v[84:87], a[168:171], v[132:135]
  v_mfma_f32_16x16x32_bf16 v[168:171], a[168:171], v[80:83], v[168:171]
  v_mfma_f32_16x16x32_bf16 v[172:175], a[168:171], v[84:87], v[172:175]
  buffer_load_dwordx4 v[76:79], v14, s[4:7], s22 offen offset:3072 sc1
  v_mfma_f32_16x16x32_bf16 v[160:163], a[172:175], v[80:83], v[160:163]
  v_mfma_f32_16x16x32_bf16 v[164:167], a[172:175], v[84:87], v[164:167]
  s_waitcnt lgkmcnt(0)
  s_waitcnt vmcnt(13)
  v_mfma_f32_16x16x32_bf16 v[112:115], v[88:91], a[176:179], v[112:115]
  ds_read_b128 a[160:163], v2 offset:57344
  v_mfma_f32_16x16x32_bf16 v[116:119], v[92:95], a[176:179], v[116:119]
  ds_read_b128 a[164:167], v2 offset:58368
  v_mfma_f32_16x16x32_bf16 v[120:123], v[88:91], a[180:183], v[120:123]
  v_mfma_f32_16x16x32_bf16 v[124:127], v[92:95], a[180:183], v[124:127]
  ds_read_b128 a[168:171], v2 offset:59392
  v_mfma_f32_16x16x32_bf16 v[128:131], v[88:91], a[184:187], v[128:131]
  ds_read_b128 a[172:175], v2 offset:60416
  v_mfma_f32_16x16x32_bf16 v[132:135], v[92:95], a[184:187], v[132:135]
  v_mfma_f32_16x16x32_bf16 v[168:171], a[184:187], v[88:91], v[168:171]
  v_mfma_f32_16x16x32_bf16 v[172:175], a[184:187], v[92:95], v[172:175]
  v_mfma_f32_16x16x32_bf16 v[160:163], a[188:191], v[88:91], v[160:163]
  v_mfma_f32_16x16x32_bf16 v[164:167], a[188:191], v[92:95], v[164:167]
  s_waitcnt lgkmcnt(0)
  s_waitcnt vmcnt(11)
  s_cmp_eq_u32 s36, 0
  s_cbranch_scc1 L_ok0
  s_waitcnt vmcnt(8)
  s_mov_b32 s24, 0
L_ct0:
  v_cmp_ne_u64 vcc, s[14:15], v[22:23]
  s_nop 0
  s_and_b32 s20, vcc_lo, 0xffff
  s_cbranch_scc0 L_ok0
  s_mul_i32 s19, s36, 65536
  s_add_u32 s19, s19, -8192
  s_add_u32 s19, s19, s55
  buffer_load_dwordx2 v[22:23], v8, s[4:7], s19 offen sc1
  s_add_u32 s24, s24, 1
  s_waitcnt vmcnt(0)
  s_cmp_lt_u32 s24, 100000
  s_cbranch_scc1 L_ct0
L_ok0:
  v_mfma_f32_16x16x32_bf16 v[112:115], v[96:99], a[160:163], v[112:115]
  ds_read_b128 a[176:179], v2 offset:61440
  v_mfma_f32_16x16x32_bf16 v[116:119], v[100:103], a[160:163], v[116:119]
  ds_read_b128 a[180:183], v2 offset:62464
  v_mfma_f32_16x16x32_bf16 v[120:123], v[96:99], a[164:167], v[120:123]
  s_lshl_b32 s59, s51, 10
  s_mul_i32 s19, s36, 262144
  s_add_u32 s19, s19, 40408064
  s_add_u32 s19, s19, s59
  buffer_load_dwordx2 v[40:41], v10, s[4:7], s19 offen offset:0 sc1
  buffer_load_dwordx2 v[42:43], v10, s[4:7], s19 offen offset:128 sc1
  buffer_load_dwordx2 v[44:45], v10, s[4:7], s19 offen offset:1024 sc1
  buffer_load_dwordx2 v[46:47], v10, s[4:7], s19 offen offset:1152 sc1
  v_mfma_f32_16x16x32_bf16 v[124:127], v[100:103], a[164:167], v[124:127]
  ds_read_b128 a[184:187], v2 offset:63488
  v_mfma_f32_16x16x32_bf16 v[128:131], v[96:99], a[168:171], v[128:131]
  ds_read_b128 a[188:191], v2 offset:64512
  v_mfma_f32_16x16x32_bf16 v[132:135], v[100:103], a[168:171], v[132:135]
  v_mfma_f32_16x16x32_bf16 v[168:171], a[168:171], v[96:99], v[168:171]
  v_mfma_f32_16x16x32_bf16 v[172:175], a[168:171], v[100:103], v[172:175]
  s_add_u32 s22, s57, 0
  buffer_load_dwordx4 a[0:3], v2, s[4:7], s22 offen offset:0 sc1
  v_mfma_f32_16x16x32_bf16 v[160:163], a[172:175], v[96:99], v[160:163]
  v_mfma_f32_16x16x32_bf16 v[164:167], a[172:175], v[100:103], v[164:167]
  s_waitcnt lgkmcnt(0)
  s_waitcnt vmcnt(14)
  v_mfma_f32_16x16x32_bf16 v[112:115], v[104:107], a[176:179], v[112:115]
  s_cmp_lg_u32 s36, 0
  s_cbranch_scc1 L_l0s16
  s_waitcnt vmcnt(23)
  s_barrier
L_l0s16:
  ds_read_b128 a[160:163], v12 offset:0
  v_mfma_f32_16x16x32_bf16 v[116:119], v[108:111], a[176:179], v[116:119]
  ds_read_b128 a[164:167], v12 offset:1024
  v_mfma_f32_16x16x32_bf16 v[120:123], v[104:107], a[180:183], v[120:123]
  buffer_load_dwordx4 a[80:83], v14, s[4:7], s22 offen offset:0 sc1
  v_mfma_f32_16x16x32_bf16 v[124:127], v[108:111], a[180:183], v[124:127]
  ds_read_b128 a[168:171], v12 offset:2048
  v_mfma_f32_16x16x32_bf16 v[128:131], v[104:107], a[184:187], v[128:131]
  ds_read_b128 a[172:175], v12 offset:3072
  v_mfma_f32_16x16x32_bf16 v[132:135], v[108:111], a[184:187], v[132:135]
  v_mfma_f32_16x16x32_bf16 v[168:171], a[184:187], v[104:107], v[168:171]
  v_mfma_f32_16x16x32_bf16 v[172:175], a[184:187], v[108:111], v[172:175]
  buffer_load_dwordx4 a[4:7], v2, s[4:7], s22 offen offset:1024 sc1
  v_mfma_f32_16x16x32_bf16 v[160:163], a[188:191], v[104:107], v[160:163]
  v_mfma_f32_16x16x32_bf16 v[164:167], a[188:191], v[108:111], v[164:167]
  s_waitcnt lgkmcnt(0)
  s_waitcnt vmcnt(13)
  v_mfma_f32_16x16x32_bf16 v[112:115], v[48:51], a[160:163], v[112:115]
  ds_read_b128 a[176:179], v12 offset:4096
  v_mfma_f32_16x16x32_bf16 v[116:119], v[52:55], a[160:163], v[116:119]
  ds_read_b128 a[180:183], v12 offset:5120
  v_mfma_f32_16x16x32_bf16 v[120:123], v[48:51], a[164:167], v[120:123]
  buffer_load_dwordx4 a[84:87], v14, s[4:7], s22 offen offset:1024 sc1
  v_mfma_f32_16x16x32_bf16 v[124:127], v[52:55], a[164:167], v[124:127]
  ds_read_b128 a[184:187], v12 offset:6144
  v_mfma_f32_16x16x32_bf16 v[128:131], v[48:51], a[168:171], v[128:131]
  ds_read_b128 a[188:191], v12 offset:7168
  v_mfma_f32_16x16x32_bf16 v[132:135], v[52:55], a[168:171], v[132:135]
  v_mfma_f32_16x16x32_bf16 v[168:171], a[168:171], v[48:51], v[168:171]
  v_mfma_f32_16x16x32_bf16 v[172:175], a[168:171], v[52:55], v[172:175]
  buffer_load_dwordx4 a[8:11], v2, s[4:7], s22 offen offset:2048 sc1
  v_mfma_f32_16x16x32_bf16 v[160:163], a[172:175], v[48:51], v[160:163]
  v_mfma_f32_16x16x32_bf16 v[164:167], a[172:175], v[52:55], v[164:167]
  s_waitcnt lgkmcnt(0)
  s_waitcnt vmcnt(13)
  v_mfma_f32_16x16x32_bf16 v[112:115], v[56:59], a[176:179], v[112:115]
  ds_read_b128 a[160:163], v12 offset:8192
  v_mfma_f32_16x16x32_bf16 v[116:119], v[60:63], a[176:179], v[116:119]
  ds_read_b128 a[164:167], v12 offset:9216
  v_mfma_f32_16x16x32_bf16 v[120:123], v[56:59], a[180:183], v[120:123]
  buffer_load_dwordx4 a[88:91], v14, s[4:7], s22 offen offset:2048 sc1
  v_mfma_f32_16x16x32_bf16 v[124:127], v[60:63], a[180:183], v[124:127]
  ds_read_b128 a[168:171], v12 offset:10240
  v_mfma_f32_16x16x32_bf16 v[128:131], v[56:59], a[184:187], v[128:131]
  ds_read_b128 a[172:175], v12 offset:11264
  v_mfma_f32_16x16x32_bf16 v[132:135], v[60:63], a[184:187], v[132:135]
  v_mfma_f32_16x16x32_bf16 v[168:171], a[184:187], v[56:59], v[168:171]
  v_mfma_f32_16x16x32_bf16 v[172:175], a[184:187], v[60:63], v[172:175]
  buffer_load_dwordx4 a[12:15], v2, s[4:7], s22 offen offset:3072 sc1
  v_mfma_f32_16x16x32_bf16 v[160:163], a[188:191], v[56:59], v[160:163]
  v_mfma_f32_16x16x32_bf16 v[164:167], a[188:191], v[60:63], v[164:167]
  s_waitcnt lgkmcnt(0)
  s_waitcnt vmcnt(13)
  v_mfma_f32_16x16x32_bf16 v[112:115], v[64:67], a[160:163], v[112:115]
  ds_read_b128 a[176:179], v12 offset:12288
  v_mfma_f32_16x16x32_bf16 v[116:119], v[68:71], a[160:163], v[116:119]
  ds_read_b128 a[180:183], v12 offset:13312
  v_mfma_f32_16x16x32_bf16 v[120:123], v[64:67], a[164:167], v[120:123]
  buffer_load_dwordx4 a[92:95], v14, s[4:7], s22 offen offset:3072 sc1
  v_mfma_f32_16x16x32_bf16 v[124:127], v[68:71], a[164:167], v[124:127]
  ds_read_b128 a[184:187], v12 offset:14336
  v_mfma_f32_16x16x32_bf16 v[128:131], v[64:67], a[168:171], v[128:131]
  ds_read_b128 a[188:191], v12 offset:15360
  v_mfma_f32_16x16x32_bf16 v[132:135], v[68:71], a[168:171], v[132:135]
  v_mfma_f32_16x16x32_bf16 v[168:171], a[168:171], v[64:67], v[168:171]
  v_mfma_f32_16x16x32_bf16 v[172:175], a[168:171], v[68:71], v[172:175]
  s_add_u32 s22, s57, 4096
  buffer_load_dwordx4 a[16:19], v2, s[4:7], s22 offen offset:0 sc1
  v_mfma_f32_16x16x32_bf16 v[160:163], a[172:175], v[64:67], v[160:163]
  v_mfma_f32_16x16x32_bf16 v[164:167], a[172:175], v[68:71], v[164:167]
  s_waitcnt lgkmcnt(0)
  s_waitcnt vmcnt(13)
  v_mfma_f32_16x16x32_bf16 v[112:115], v[72:75], a[176:179], v[112:115]
  s_cmp_lg_u32 s36, 0
  s_cbranch_scc1 L_l0s20
  s_waitcnt vmcnt(28)
  s_barrier
L_l0s20:
  ds_read_b128 a[160:163], v12 offset:16384
  v_mfma_f32_16x16x32_bf16 v[116:119], v[76:79], a[176:179], v[116:119]
  ds_read_b128 a[164:167], v12 offset:17408
  v_mfma_f32_16x16x32_bf16 v[120:123], v[72:75], a[180:183], v[120:123]
  buffer_load_dwordx4 a[96:99], v14, s[4:7], s22 offen offset:0 sc1
  v_mfma_f32_16x16x32_bf16 v[124:127], v[76:79], a[180:183], v[124:127]
  ds_read_b128 a[168:171], v12 offset:18432
  v_mfma_f32_16x16x32_bf16 v[128:131], v[72:75], a[184:187], v[128:131]
  ds_read_b128 a[172:175], v12 offset:19456
  v_mfma_f32_16x16x32_bf16 v[132:135], v[76:79], a[184:187], v[132:135]
  v_mfma_f32_16x16x32_bf16 v[168:171], a[184:187], v[72:75], v[168:171]
  v_mfma_f32_16x16x32_bf16 v[172:175], a[184:187], v[76:79], v[172:175]
  buffer_load_dwordx4 a[20:23], v2, s[4:7], s22 offen offset:1024 sc1
  v_mfma_f32_16x16x32_bf16 v[160:163], a[188:191], v[72:75], v[160:163]
  v_mfma_f32_16x16x32_bf16 v[164:167], a[188:191], v[76:79], v[164:167]
  s_waitcnt lgkmcnt(0)
  v_mfma_f32_16x16x32_bf16 v[112:115], v[228:231], a[160:163], v[112:115]
  ds_read_b128 a[176:179], v2 offset:0
  v_mfma_f32_16x16x32_bf16 v[116:119], v[232:235], a[160:163], v[116:119]
  v_mfma_f32_16x16x32_bf16 v[120:123], v[228:231], a[164:167], v[120:123]
  ds_read_b128 a[180:183], v2 offset:1024
  buffer_load_dwordx4 a[100:103], v14, s[4:7], s22 offen offset:1024 sc1
  v_mfma_f32_16x16x32_bf16 v[124:127], v[232:235], a[164:167], v[124:127]
  v_mfma_f32_16x16x32_bf16 v[128:131], v[228:231], a[168:171], v[128:131]
  ds_read_b128 a[184:187], v2 offset:2048
  v_mfma_f32_16x16x32_bf16 v[132:135], v[232:235], a[168:171], v[132:135]
  v_mfma_f32_16x16x32_bf16 v[168:171], a[168:171], v[228:231], v[168:171]
  v_mfma_f32_16x16x32_bf16 v[172:175], a[168:171], v[232:235], v[172:175]
  buffer_load_dwordx4 a[24:27], v2, s[4:7], s22 offen offset:2048 sc1
  v_mfma_f32_16x16x32_bf16 v[160:163], a[172:175], v[228:231], v[160:163]
  v_mfma_f32_16x16x32_bf16 v[164:167], a[172:175], v[232:235], v[164:167]
  s_waitcnt lgkmcnt(0)
  s_waitcnt vmcnt(11)
  v_mfma_f32_16x16x32_bf16 v[136:139], a[0:3], a[176:179], 0
  ds_read_b128 a[160:163], v2 offset:4096
  v_mov_b32 v92, s23
  v_fma_f32 v84, v112, v208, s16
  v_mfma_f32_16x16x32_bf16 v[140:143], a[80:83], a[176:179], 0
  ds_read_b128 a[164:167], v2 offset:5120
  v_fma_f32 v85, v113, v209, s16
  v_fma_f32 v86, v114, v210, s16
  v_mfma_f32_16x16x32_bf16 v[144:147], a[0:3], a[180:183], 0
  buffer_load_dwordx4 a[104:107], v14, s[4:7], s22 offen offset:2048 sc1
  v_fma_f32 v87, v115, v211, s16
  v_mfma_f32_16x16x32_bf16 v[148:151], a[80:83], a[180:183], 0
  ds_read_b128 a[168:171], v2 offset:6144
  v_mul_f32 v76, 0x3fb8aa3b, v84
  v_mul_f32 v77, 0x3fb8aa3b, v85
  v_mfma_f32_16x16x32_bf16 v[152:155], a[0:3], a[184:187], 0
  v_mul_f32 v78, 0x3fb8aa3b, v86
  v_mul_f32 v79, 0x3fb8aa3b, v87
  v_mfma_f32_16x16x32_bf16 v[156:159], a[80:83], a[184:187], 0
  v_exp_f32 v76, v76 clamp
  v_mfma_f32_16x16x32_bf16 v[184:187], a[184:187], a[0:3], 0
  buffer_load_dwordx4 a[28:31], v2, s[4:7], s22 offen offset:3072 sc1
  v_max_f32 v84, s16, v84
  v_exp_f32 v77, v77 clamp
  v_mfma_f32_16x16x32_bf16 v[188:191], a[184:187], a[80:83], 0
  v_max_f32 v85, s16, v85
  s_waitcnt lgkmcnt(0)
  s_waitcnt vmcnt(11)
  v_mfma_f32_16x16x32_bf16 v[136:139], a[4:7], a[160:163], v[136:139]
  ds_read_b128 a[176:179], v2 offset:8192
  v_exp_f32 v78, v78 clamp
  v_max_f32 v86, s16, v86
  v_mfma_f32_16x16x32_bf16 v[140:143], a[84:87], a[160:163], v[140:143]
  ds_read_b128 a[180:183], v2 offset:9216
  v_exp_f32 v79, v79 clamp
  v_max_f32 v87, s16, v87
  v_mfma_f32_16x16x32_bf16 v[144:147], a[4:7], a[164:167], v[144:147]
  buffer_load_dwordx4 a[108:111], v14, s[4:7], s22 offen offset:3072 sc1
  v_add_f32 v112, v84, v76
  v_add_f32 v113, v85, v77
  v_mfma_f32_16x16x32_bf16 v[148:151], a[84:87], a[164:167], v[148:151]
  ds_read_b128 a[184:187], v2 offset:10240
  v_add_f32 v114, v86, v78
  v_mfma_f32_16x16x32_bf16 v[152:155], a[4:7], a[168:171], v[152:155]
  v_add_f32 v115, v87, v79
  v_cvt_pk_bf16_f32 v48, v112, v113
  v_mfma_f32_16x16x32_bf16 v[156:159], a[84:87], a[168:171], v[156:159]
  v_cvt_pk_bf16_f32 v49, v114, v115
  v_fma_f32 v84, v116, v212, s16
  v_mfma_f32_16x16x32_bf16 v[184:187], a[168:171], a[4:7], v[184:187]
  s_add_u32 s22, s57, 8192
  buffer_load_dwordx4 a[32:35], v2, s[4:7], s22 offen offset:0 sc1
  v_fma_f32 v85, v117, v213, s16
  v_fma_f32 v86, v118, v214, s16
  v_mfma_f32_16x16x32_bf16 v[188:191], a[168:171], a[84:87], v[188:191]
  v_fma_f32 v87, v119, v215, s16
  s_waitcnt lgkmcnt(0)
  s_waitcnt vmcnt(11)
  v_mfma_f32_16x16x32_bf16 v[136:139], a[8:11], a[176:179], v[136:139]
  ds_read_b128 a[160:163], v2 offset:12288
  v_mul_f32 v76, 0x3fb8aa3b, v84
  v_mul_f32 v77, 0x3fb8aa3b, v85
  v_mfma_f32_16x16x32_bf16 v[140:143], a[88:91], a[176:179], v[140:143]
  ds_read_b128 a[164:167], v2 offset:13312
  v_mul_f32 v78, 0x3fb8aa3b, v86
  v_mul_f32 v79, 0x3fb8aa3b, v87
  v_mfma_f32_16x16x32_bf16 v[144:147], a[8:11], a[180:183], v[144:147]
  buffer_load_dwordx4 a[112:115], v14, s[4:7], s22 offen offset:0 sc1
  v_exp_f32 v76, v76 clamp
  v_max_f32 v84, s16, v84
  v_mfma_f32_16x16x32_bf16 v[148:151], a[88:91], a[180:183], v[148:151]
  ds_read_b128 a[168:171], v2 offset:14336
  v_exp_f32 v77, v77 clamp
  v_mfma_f32_16x16x32_bf16 v[152:155], a[8:11], a[184:187], v[152:155]
  v_max_f32 v85, s16, v85
  v_exp_f32 v78, v78 clamp
  v_mfma_f32_16x16x32_bf16 v[156:159], a[88:91], a[184:187], v[156:159]
  v_max_f32 v86, s16, v86
  v_exp_f32 v79, v79 clamp
  v_mfma_f32_16x16x32_bf16 v[184:187], a[184:187], a[8:11], v[184:187]
  buffer_load_dwordx4 a[36:39], v2, s[4:7], s22 offen offset:1024 sc1
  v_max_f32 v87, s16, v87
  v_add_f32 v116, v84, v76
  v_mfma_f32_16x16x32_bf16 v[188:191], a[184:187], a[88:91], v[188:191]
  v_add_f32 v117, v85, v77
  s_waitcnt lgkmcnt(0)
  s_waitcnt vmcnt(11)
  v_mfma_f32_16x16x32_bf16 v[136:139], a[12:15], a[160:163], v[136:139]
  ds_read_b128 a[176:179], v2 offset:16384
  v_add_f32 v118, v86, v78
  v_add_f32 v119, v87, v79
  v_mfma_f32_16x16x32_bf16 v[140:143], a[92:95], a[160:163], v[140:143]
  ds_read_b128 a[180:183], v2 offset:17408
  v_cvt_pk_bf16_f32 v50, v116, v117
  v_cvt_pk_bf16_f32 v51, v118, v119
  v_mfma_f32_16x16x32_bf16 v[144:147], a[12:15], a[164:167], v[144:147]
  buffer_load_dwordx4 a[116:119], v14, s[4:7], s22 offen offset:1024 sc1
  v_mul_f32 v120, v120, v208
  v_mul_f32 v121, v121, v209
  v_mfma_f32_16x16x32_bf16 v[148:151], a[92:95], a[164:167], v[148:151]
  ds_read_b128 a[184:187], v2 offset:18432
  v_mul_f32 v122, v122, v210
  v_mfma_f32_16x16x32_bf16 v[152:155], a[12:15], a[168:171], v[152:155]
  v_mul_f32 v123, v123, v211
  v_cvt_pk_bf16_f32 v52, v120, v121
  v_mfma_f32_16x16x32_bf16 v[156:159], a[92:95], a[168:171], v[156:159]
  v_cvt_pk_bf16_f32 v53, v122, v123
  v_mul_f32 v124, v124, v212
  v_mfma_f32_16x16x32_bf16 v[184:187], a[168:171], a[12:15], v[184:187]
  buffer_load_dwordx4 a[40:43], v2, s[4:7], s22 offen offset:2048 sc1
  v_mul_f32 v125, v125, v213
  v_mul_f32 v126, v126, v214
  v_mfma_f32_16x16x32_bf16 v[188:191], a[168:171], a[92:95], v[188:191]
  v_mul_f32 v127, v127, v215
  s_waitcnt lgkmcnt(0)
  s_waitcnt vmcnt(11)
  v_mfma_f32_16x16x32_bf16 v[136:139], a[16:19], a[176:179], v[136:139]
  ds_read_b128 a[160:163], v2 offset:20480
  v_cvt_pk_bf16_f32 v54, v124, v125
  v_cvt_pk_bf16_f32 v55, v126, v127
  v_mfma_f32_16x16x32_bf16 v[140:143], a[96:99], a[176:179], v[140:143]
  ds_read_b128 a[164:167], v2 offset:21504
  v_fma_f32 v84, v128, v208, s16
  v_fma_f32 v85, v129, v209, s16
  v_mfma_f32_16x16x32_bf16 v[144:147], a[16:19], a[180:183], v[144:147]
  buffer_load_dwordx4 a[120:123], v14, s[4:7], s22 offen offset:2048 sc1
  v_fma_f32 v86, v130, v210, s16
  v_fma_f32 v87, v131, v211, s16
  v_mfma_f32_16x16x32_bf16 v[148:151], a[96:99], a[180:183], v[148:151]
  ds_read_b128 a[168:171], v2 offset:22528
  v_mul_f32 v76, 0x3fb8aa3b, v84
  v_mfma_f32_16x16x32_bf16 v[152:155], a[16:19], a[184:187], v[152:155]
  v_mul_f32 v77, 0x3fb8aa3b, v85
  v_mul_f32 v78, 0x3fb8aa3b, v86
  v_mfma_f32_16x16x32_bf16 v[156:159], a[96:99], a[184:187], v[156:159]
  v_mul_f32 v79, 0x3fb8aa3b, v87
  v_exp_f32 v76, v76 clamp
  v_mfma_f32_16x16x32_bf16 v[184:187], a[184:187], a[16:19], v[184:187]
  buffer_load_dwordx4 a[44:47], v2, s[4:7], s22 offen offset:3072 sc1
  v_max_f32 v84, s16, v84
  v_exp_f32 v77, v77 clamp
  v_mfma_f32_16x16x32_bf16 v[188:191], a[184:187], a[96:99], v[188:191]
  v_max_f32 v85, s16, v85
  s_waitcnt lgkmcnt(0)
  s_waitcnt vmcnt(11)
  v_mfma_f32_16x16x32_bf16 v[136:139], a[20:23], a[160:163], v[136:139]
  ds_read_b128 a[176:179], v2 offset:24576
  v_exp_f32 v78, v78 clamp
  v_max_f32 v86, s16, v86
  v_mfma_f32_16x16x32_bf16 v[140:143], a[100:103], a[160:163], v[140:143]
  ds_read_b128 a[180:183], v2 offset:25600
  v_exp_f32 v79, v79 clamp
  v_max_f32 v87, s16, v87
  v_mfma_f32_16x16x32_bf16 v[144:147], a[20:23], a[164:167], v[144:147]
  buffer_load_dwordx4 a[124:127], v14, s[4:7], s22 offen offset:3072 sc1
  v_add_f32 v80, v84, v76
  v_add_f32 v81, v85, v77
  v_mfma_f32_16x16x32_bf16 v[148:151], a[100:103], a[164:167], v[148:151]
  ds_read_b128 a[184:187], v2 offset:26624
  v_add_f32 v82, v86, v78
  v_mfma_f32_16x16x32_bf16 v[152:155], a[20:23], a[168:171], v[152:155]
  v_add_f32 v83, v87, v79
  v_mul_f32 v128, v128, v208
  v_mfma_f32_16x16x32_bf16 v[156:159], a[100:103], a[168:171], v[156:159]
  v_mul_f32 v129, v129, v209
  v_mul_f32 v130, v130, v210
  v_mfma_f32_16x16x32_bf16 v[184:187], a[168:171], a[20:23], v[184:187]
  s_add_u32 s22, s57, 12288
  buffer_load_dwordx4 a[48:51], v2, s[4:7], s22 offen offset:0 sc1
  v_mul_f32 v131, v131, v211
  v_cndmask_b32 v128, v128, v80, s[28:29]
  v_mfma_f32_16x16x32_bf16 v[188:191], a[168:171], a[100:103], v[188:191]
  v_cndmask_b32 v129, v129, v81, s[28:29]
  s_waitcnt lgkmcnt(0)
  s_waitcnt vmcnt(11)
  v_mfma_f32_16x16x32_bf16 v[136:139], a[24:27], a[176:179], v[136:139]
  ds_read_b128 a[160:163], v2 offset:28672
  v_cndmask_b32 v130, v130, v82, s[28:29]
  v_cndmask_b32 v131, v131, v83, s[28:29]
  v_mfma_f32_16x16x32_bf16 v[140:143], a[104:107], a[176:179], v[140:143]
  ds_read_b128 a[164:167], v2 offset:29696
  v_cvt_pk_bf16_f32 v56, v128, v129
  v_cvt_pk_bf16_f32 v57, v130, v131
  v_mfma_f32_16x16x32_bf16 v[144:147], a[24:27], a[180:183], v[144:147]
  buffer_load_dwordx4 a[128:131], v14, s[4:7], s22 offen offset:0 sc1
  v_cndmask_b32 v56, v56, v92, s[30:31]
  v_cndmask_b32 v57, v57, v92, s[30:31]
  v_mfma_f32_16x16x32_bf16 v[148:151], a[104:107], a[180:183], v[148:151]
  ds_read_b128 a[168:171], v2 offset:30720
  v_fma_f32 v84, v132, v212, s16
  v_mfma_f32_16x16x32_bf16 v[152:155], a[24:27], a[184:187], v[152:155]
  v_fma_f32 v85, v133, v213, s16
  v_fma_f32 v86, v134, v214, s16
  v_mfma_f32_16x16x32_bf16 v[156:159], a[104:107], a[184:187], v[156:159]
  v_fma_f32 v87, v135, v215, s16
  v_mul_f32 v76, 0x3fb8aa3b, v84
  v_mfma_f32_16x16x32_bf16 v[184:187], a[184:187], a[24:27], v[184:187]
  buffer_load_dwordx4 a[52:55], v2, s[4:7], s22 offen offset:1024 sc1
  v_mul_f32 v77, 0x3fb8aa3b, v85
  v_mul_f32 v78, 0x3fb8aa3b, v86
  v_mfma_f32_16x16x32_bf16 v[188:191], a[184:187], a[104:107], v[188:191]
  v_mul_f32 v79, 0x3fb8aa3b, v87
  s_waitcnt lgkmcnt(0)
  s_waitcnt vmcnt(11)
  v_mfma_f32_16x16x32_bf16 v[136:139], a[28:31], a[160:163], v[136:139]
  ds_read_b128 a[176:179], v2 offset:32768
  v_exp_f32 v76, v76 clamp
  v_max_f32 v84, s16, v84
  v_mfma_f32_16x16x32_bf16 v[140:143], a[108:111], a[160:163], v[140:143]
  ds_read_b128 a[180:183], v2 offset:33792
  v_exp_f32 v77, v77 clamp
  v_max_f32 v85, s16, v85
  v_mfma_f32_16x16x32_bf16 v[144:147], a[28:31], a[164:167], v[144:147]
  buffer_load_dwordx4 a[132:135], v14, s[4:7], s22 offen offset:1024 sc1
  v_exp_f32 v78, v78 clamp
  v_max_f32 v86, s16, v86
  v_mfma_f32_16x16x32_bf16 v[148:151], a[108:111], a[164:167], v[148:151]
  ds_read_b128 a[184:187], v2 offset:34816
  v_exp_f32 v79, v79 clamp
  v_mfma_f32_16x16x32_bf16 v[152:155], a[28:31], a[168:171], v[152:155]
  v_max_f32 v87, s16, v87
  v_add_f32 v80, v84, v76
  v_mfma_f32_16x16x32_bf16 v[156:159], a[108:111], a[168:171], v[156:159]
  v_add_f32 v81, v85, v77
  v_add_f32 v82, v86, v78
  v_mfma_f32_16x16x32_bf16 v[184:187], a[168:171], a[28:31], v[184:187]
  buffer_load_dwordx4 a[56:59], v2, s[4:7], s22 offen offset:2048 sc1
  v_add_f32 v83, v87, v79
  v_mul_f32 v132, v132, v212
  v_mfma_f32_16x16x32_bf16 v[188:191], a[168:171], a[108:111], v[188:191]
  v_mul_f32 v133, v133, v213
  s_waitcnt lgkmcnt(0)
  s_waitcnt vmcnt(11)
  v_mfma_f32_16x16x32_bf16 v[136:139], a[32:35], a[176:179], v[136:139]
  ds_read_b128 a[160:163], v2 offset:36864
  v_mul_f32 v134, v134, v214
  v_mul_f32 v135, v135, v215
  v_mfma_f32_16x16x32_bf16 v[140:143], a[112:115], a[176:179], v[140:143]
  ds_read_b128 a[164:167], v2 offset:37888
  v_cndmask_b32 v132, v132, v80, s[28:29]
  v_cndmask_b32 v133, v133, v81, s[28:29]
  v_mfma_f32_16x16x32_bf16 v[144:147], a[32:35], a[180:183], v[144:147]
  buffer_load_dwordx4 a[136:139], v14, s[4:7], s22 offen offset:2048 sc1
  v_cndmask_b32 v134, v134, v82, s[28:29]
  v_cndmask_b32 v135, v135, v83, s[28:29]
  v_mfma_f32_16x16x32_bf16 v[148:151], a[112:115], a[180:183], v[148:151]
  ds_read_b128 a[168:171], v2 offset:38912
  v_cvt_pk_bf16_f32 v58, v132, v133
  v_mfma_f32_16x16x32_bf16 v[152:155], a[32:35], a[184:187], v[152:155]
  v_cvt_pk_bf16_f32 v59, v134, v135
  v_cndmask_b32 v58, v58, v92, s[30:31]
  v_mfma_f32_16x16x32_bf16 v[156:159], a[112:115], a[184:187], v[156:159]
  v_cndmask_b32 v59, v59, v92, s[30:31]
  v_mfma_f32_16x16x32_bf16 v[60:63], v[48:51], v[52:55], 0
  v_mfma_f32_16x16x32_bf16 v[184:187], a[184:187], a[32:35], v[184:187]
  buffer_load_dwordx4 a[60:63], v2, s[4:7], s22 offen offset:3072 sc1
  v_mfma_f32_16x16x32_bf16 v[64:67], v[48:51], v[56:59], 0
  v_mfma_f32_16x16x32_bf16 v[68:71], v[56:59], v[52:55], 0
  v_mfma_f32_16x16x32_bf16 v[188:191], a[184:187], a[112:115], v[188:191]
  v_mfma_f32_16x16x32_bf16 v[72:75], v[56:59], v[56:59], 0
  s_waitcnt lgkmcnt(0)
  s_waitcnt vmcnt(11)
  s_waitcnt vmcnt(31)
  v_mfma_f32_16x16x32_bf16 v[136:139], a[36:39], a[160:163], v[136:139]
  ds_read_b128 a[176:179], v2 offset:40960
  v_add_f32 v40, v40, v42
  v_add_f32 v41, v41, v43
  v_mfma_f32_16x16x32_bf16 v[140:143], a[116:119], a[160:163], v[140:143]
  ds_read_b128 a[180:183], v2 offset:41984
  v_mov_b32 v6, v40
  v_mfma_f32_16x16x32_bf16 v[144:147], a[36:39], a[164:167], v[144:147]
  buffer_load_dwordx4 a[140:143], v14, s[4:7], s22 offen offset:3072 sc1
  v_permlane32_swap_b32 v40, v6
  v_add_f32 v40, v40, v6
  v_mfma_f32_16x16x32_bf16 v[148:151], a[116:119], a[164:167], v[148:151]
  ds_read_b128 a[184:187], v2 offset:43008
  v_mov_b32 v6, v40
  v_mfma_f32_16x16x32_bf16 v[152:155], a[36:39], a[168:171], v[152:155]
  s_nop 0
  v_permlane16_swap_b32 v40, v6
  v_add_f32 v40, v40, v6
  v_mfma_f32_16x16x32_bf16 v[156:159], a[116:119], a[168:171], v[156:159]
  v_mov_b32 v6, v41
  v_mfma_f32_16x16x32_bf16 v[184:187], a[168:171], a[36:39], v[184:187]
  s_add_u32 s22, s57, 16384
  buffer_load_dwordx4 a[64:67], v2, s[4:7], s22 offen offset:0 sc1
  v_permlane32_swap_b32 v41, v6
  v_add_f32 v41, v41, v6
  v_mfma_f32_16x16x32_bf16 v[188:191], a[168:171], a[116:119], v[188:191]
  v_mov_b32 v6, v41
  s_waitcnt lgkmcnt(0)
  s_waitcnt vmcnt(11)
  v_mfma_f32_16x16x32_bf16 v[136:139], a[40:43], a[176:179], v[136:139]
  ds_read_b128 a[160:163], v2 offset:45056
  v_permlane16_swap_b32 v41, v6
  v_add_f32 v41, v41, v6
  v_mfma_f32_16x16x32_bf16 v[140:143], a[120:123], a[176:179], v[140:143]
  ds_read_b128 a[164:167], v2 offset:46080
  v_mul_f32 v40, 0xbacccccd, v40
  v_mfma_f32_16x16x32_bf16 v[144:147], a[40:43], a[180:183], v[144:147]
  buffer_load_dwordx4 a[144:147], v14, s[4:7], s22 offen offset:0 sc1
  v_mul_f32 v41, 0x3acccccd, v41
  v_fma_f32 v41, -v40, v40, v41
  v_mfma_f32_16x16x32_bf16 v[148:151], a[120:123], a[180:183], v[148:151]
  ds_read_b128 a[168:171], v2 offset:47104
  v_max_f32 v41, 0, v41
  v_mfma_f32_16x16x32_bf16 v[152:155], a[40:43], a[184:187], v[152:155]
  v_add_f32 v41, 0x3727c5ac, v41
  v_rsq_f32 v226, v41
  v_mfma_f32_16x16x32_bf16 v[156:159], a[120:123], a[184:187], v[156:159]
  v_cvt_pk_bf16_f32 v236, v40, v40
  v_mfma_f32_16x16x32_bf16 v[184:187], a[184:187], a[40:43], v[184:187]
  buffer_load_dwordx4 a[68:71], v2, s[4:7], s22 offen offset:1024 sc1
  v_lshlrev_b32 v6, 16, v236
  v_sub_f32 v6, v40, v6
  v_mfma_f32_16x16x32_bf16 v[188:191], a[184:187], a[120:123], v[188:191]
  v_cvt_pk_bf16_f32 v237, v6, v6
  s_waitcnt lgkmcnt(0)
  s_waitcnt vmcnt(11)
  v_mfma_f32_16x16x32_bf16 v[136:139], a[44:47], a[160:163], v[136:139]
  ds_read_b128 a[176:179], v2 offset:49152
  v_mov_b32 v238, 0
  v_mov_b32 v239, 0
  v_mfma_f32_16x16x32_bf16 v[140:143], a[124:127], a[160:163], v[140:143]
  ds_read_b128 a[180:183], v2 offset:50176
  v_add_f32 v44, v44, v46
  v_mfma_f32_16x16x32_bf16 v[144:147], a[44:47], a[164:167], v[144:147]
  buffer_load_dwordx4 a[148:151], v14, s[4:7], s22 offen offset:1024 sc1
  v_add_f32 v45, v45, v47
  v_mov_b32 v6, v44
  v_mfma_f32_16x16x32_bf16 v[148:151], a[124:127], a[164:167], v[148:151]
  ds_read_b128 a[184:187], v2 offset:51200
  v_permlane32_swap_b32 v44, v6
  v_mfma_f32_16x16x32_bf16 v[152:155], a[44:47], a[168:171], v[152:155]
  v_add_f32 v44, v44, v6
  v_mov_b32 v6, v44
  v_mfma_f32_16x16x32_bf16 v[156:159], a[124:127], a[168:171], v[156:159]
  s_nop 0
  v_permlane16_swap_b32 v44, v6
  v_mfma_f32_16x16x32_bf16 v[184:187], a[168:171], a[44:47], v[184:187]
  buffer_load_dwordx4 a[72:75], v2, s[4:7], s22 offen offset:2048 sc1
  v_add_f32 v44, v44, v6
  v_mov_b32 v6, v45
  v_mfma_f32_16x16x32_bf16 v[188:191], a[168:171], a[124:127], v[188:191]
  s_nop 0
  v_permlane32_swap_b32 v45, v6
  s_waitcnt lgkmcnt(0)
  s_waitcnt vmcnt(11)
  v_mfma_f32_16x16x32_bf16 v[136:139], a[48:51], a[176:179], v[136:139]
  ds_read_b128 a[160:163], v2 offset:53248
  v_add_f32 v45, v45, v6
  v_mov_b32 v6, v45
  v_mfma_f32_16x16x32_bf16 v[140:143], a[128:131], a[176:179], v[140:143]
  ds_read_b128 a[164:167], v2 offset:54272
  v_permlane16_swap_b32 v45, v6
  v_mfma_f32_16x16x32_bf16 v[144:147], a[48:51], a[180:183], v[144:147]
  buffer_load_dwordx4 a[152:155], v14, s[4:7], s22 offen offset:2048 sc1
  v_add_f32 v45, v45, v6
  v_mul_f32 v44, 0xbacccccd, v44
  v_mfma_f32_16x16x32_bf16 v[148:151], a[128:131], a[180:183], v[148:151]
  ds_read_b128 a[168:171], v2 offset:55296
  v_mul_f32 v45, 0x3acccccd, v45
  v_mfma_f32_16x16x32_bf16 v[152:155], a[48:51], a[184:187], v[152:155]
  v_fma_f32 v45, -v44, v44, v45
  v_max_f32 v45, 0, v45
  v_mfma_f32_16x16x32_bf16 v[156:159], a[128:131], a[184:187], v[156:159]
  v_add_f32 v45, 0x3727c5ac, v45
  v_mfma_f32_16x16x32_bf16 v[184:187], a[184:187], a[48:51], v[184:187]
  buffer_load_dwordx4 a[76:79], v2, s[4:7], s22 offen offset:3072 sc1
  v_rsq_f32 v227, v45
  v_cvt_pk_bf16_f32 v240, v44, v44
  v_mfma_f32_16x16x32_bf16 v[188:191], a[184:187], a[128:131], v[188:191]
  v_lshlrev_b32 v6, 16, v240
  s_waitcnt lgkmcnt(0)
  s_waitcnt vmcnt(11)
  v_mfma_f32_16x16x32_bf16 v[136:139], a[52:55], a[160:163], v[136:139]
  ds_read_b128 a[176:179], v2 offset:57344
  v_sub_f32 v6, v44, v6
  v_cvt_pk_bf16_f32 v241, v6, v6
  v_mfma_f32_16x16x32_bf16 v[140:143], a[132:135], a[160:163], v[140:143]
  ds_read_b128 a[180:183], v2 offset:58368
  v_mov_b32 v242, 0
  v_mov_b32 v243, 0
  v_mfma_f32_16x16x32_bf16 v[144:147], a[52:55], a[164:167], v[144:147]
  v_lshlrev_b32 v6, 4, v4
  v_mfma_f32_16x16x32_bf16 v[148:151], a[132:135], a[164:167], v[148:151]
  ds_read_b128 a[184:187], v2 offset:59392
  ds_bpermute_b32 v216, v6, v226 offset:0
  ds_bpermute_b32 v217, v6, v226 offset:4
  v_mfma_f32_16x16x32_bf16 v[152:155], a[52:55], a[168:171], v[152:155]
  buffer_load_dwordx4 a[156:159], v14, s[4:7], s22 offen offset:3072 sc1
  ds_bpermute_b32 v218, v6, v226 offset:8
  ds_bpermute_b32 v219, v6, v226 offset:12
  v_mfma_f32_16x16x32_bf16 v[156:159], a[132:135], a[168:171], v[156:159]
  ds_bpermute_b32 v220, v6, v227 offset:0
  v_mfma_f32_16x16x32_bf16 v[184:187], a[168:171], a[52:55], v[184:187]
  ds_bpermute_b32 v221, v6, v227 offset:4
  ds_bpermute_b32 v222, v6, v227 offset:8
  v_mfma_f32_16x16x32_bf16 v[188:191], a[168:171], a[132:135], v[188:191]
  ds_bpermute_b32 v223, v6, v227 offset:12
  s_waitcnt lgkmcnt(0)
  s_waitcnt vmcnt(10)
  v_mfma_f32_16x16x32_bf16 v[136:139], a[56:59], a[176:179], v[136:139]
  ds_read_b128 a[160:163], v2 offset:61440
  v_fma_f32 v84, v160, v224, s16
  v_fma_f32 v85, v161, v224, s16
  v_mfma_f32_16x16x32_bf16 v[140:143], a[136:139], a[176:179], v[140:143]
  ds_read_b128 a[164:167], v2 offset:62464
  v_fma_f32 v86, v162, v224, s16
  v_fma_f32 v87, v163, v224, s16
  v_mfma_f32_16x16x32_bf16 v[144:147], a[56:59], a[180:183], v[144:147]
  v_mul_f32 v76, 0x3fb8aa3b, v84
  v_mfma_f32_16x16x32_bf16 v[148:151], a[136:139], a[180:183], v[148:151]
  ds_read_b128 a[168:171], v2 offset:63488
  v_mul_f32 v77, 0x3fb8aa3b, v85
  v_mul_f32 v78, 0x3fb8aa3b, v86
  v_mfma_f32_16x16x32_bf16 v[152:155], a[56:59], a[184:187], v[152:155]
  v_mul_f32 v79, 0x3fb8aa3b, v87
  v_exp_f32 v76, v76 clamp
  v_mfma_f32_16x16x32_bf16 v[156:159], a[136:139], a[184:187], v[156:159]
  v_max_f32 v84, s16, v84
  v_mfma_f32_16x16x32_bf16 v[184:187], a[184:187], a[56:59], v[184:187]
  v_exp_f32 v77, v77 clamp
  v_max_f32 v85, s16, v85
  v_mfma_f32_16x16x32_bf16 v[188:191], a[184:187], a[136:139], v[188:191]
  v_exp_f32 v78, v78 clamp
  s_waitcnt lgkmcnt(0)
  s_waitcnt vmcnt(8)
  v_mfma_f32_16x16x32_bf16 v[136:139], a[60:63], a[160:163], v[136:139]
  ds_read_b128 a[176:179], v12 offset:0
  v_max_f32 v86, s16, v86
  v_exp_f32 v79, v79 clamp
  v_mfma_f32_16x16x32_bf16 v[140:143], a[140:143], a[160:163], v[140:143]
  ds_read_b128 a[180:183], v12 offset:1024
  v_max_f32 v87, s16, v87
  v_add_f32 v160, v84, v76
  v_mfma_f32_16x16x32_bf16 v[144:147], a[60:63], a[164:167], v[144:147]
  v_add_f32 v161, v85, v77
  v_mfma_f32_16x16x32_bf16 v[148:151], a[140:143], a[164:167], v[148:151]
  ds_read_b128 a[184:187], v12 offset:2048
  v_add_f32 v162, v86, v78
  v_add_f32 v163, v87, v79
  v_mfma_f32_16x16x32_bf16 v[152:155], a[60:63], a[168:171], v[152:155]
  v_cvt_pk_bf16_f32 v192, v160, v161
  v_cvt_pk_bf16_f32 v193, v162, v163
  v_mfma_f32_16x16x32_bf16 v[156:159], a[140:143], a[168:171], v[156:159]
  v_fma_f32 v84, v168, v224, s16
  v_mfma_f32_16x16x32_bf16 v[184:187], a[168:171], a[60:63], v[184:187]
  v_fma_f32 v85, v169, v224, s16
  v_fma_f32 v86, v170, v224, s16
  v_mfma_f32_16x16x32_bf16 v[188:191], a[168:171], a[140:143], v[188:191]
  v_fma_f32 v87, v171, v224, s16
  s_waitcnt lgkmcnt(0)
  s_waitcnt vmcnt(6)
  v_mfma_f32_16x16x32_bf16 v[136:139], a[64:67], a[176:179], v[136:139]
  ds_read_b128 a[160:163], v12 offset:4096
  v_mul_f32 v76, 0x3fb8aa3b, v84
  v_mul_f32 v77, 0x3fb8aa3b, v85
  v_mfma_f32_16x16x32_bf16 v[140:143], a[144:147], a[176:179], v[140:143]
  ds_read_b128 a[164:167], v12 offset:5120
  v_mul_f32 v78, 0x3fb8aa3b, v86
  v_mul_f32 v79, 0x3fb8aa3b, v87
  v_mfma_f32_16x16x32_bf16 v[144:147], a[64:67], a[180:183], v[144:147]
  s_add_u32 s21, s46, 0
  buffer_load_dwordx4 a[192:195], v2, s[4:7], s21 offen offset:0 sc1
  v_exp_f32 v76, v76 clamp
  v_mfma_f32_16x16x32_bf16 v[148:151], a[144:147], a[180:183], v[148:151]
  ds_read_b128 a[168:171], v12 offset:6144
  v_max_f32 v84, s16, v84
  v_exp_f32 v77, v77 clamp
  v_mfma_f32_16x16x32_bf16 v[152:155], a[64:67], a[184:187], v[152:155]
  v_max_f32 v85, s16, v85
  v_exp_f32 v78, v78 clamp
  v_mfma_f32_16x16x32_bf16 v[156:159], a[144:147], a[184:187], v[156:159]
  v_max_f32 v86, s16, v86
  v_mfma_f32_16x16x32_bf16 v[184:187], a[184:187], a[64:67], v[184:187]
  buffer_load_dwordx4 a[196:199], v2, s[4:7], s21 offen offset:1024 sc1
  v_exp_f32 v79, v79 clamp
  v_max_f32 v87, s16, v87
  v_mfma_f32_16x16x32_bf16 v[188:191], a[184:187], a[144:147], v[188:191]
  v_add_f32 v168, v84, v76
  s_waitcnt lgkmcnt(0)
  s_waitcnt vmcnt(6)
  v_mfma_f32_16x16x32_bf16 v[136:139], a[68:71], a[160:163], v[136:139]
  ds_read_b128 a[176:179], v12 offset:8192
  v_add_f32 v169, v85, v77
  v_add_f32 v170, v86, v78
  v_mfma_f32_16x16x32_bf16 v[140:143], a[148:151], a[160:163], v[140:143]
  ds_read_b128 a[180:183], v12 offset:9216
  v_add_f32 v171, v87, v79
  v_cvt_pk_bf16_f32 v194, v168, v169
  v_mfma_f32_16x16x32_bf16 v[144:147], a[68:71], a[164:167], v[144:147]
  buffer_load_dwordx4 a[200:203], v2, s[4:7], s21 offen offset:2048 sc1
  v_cndmask_b32 v194, 0, v194, s[32:33]
  v_mfma_f32_16x16x32_bf16 v[148:151], a[148:151], a[164:167], v[148:151]
  ds_read_b128 a[184:187], v12 offset:10240
  v_cvt_pk_bf16_f32 v195, v170, v171
  v_cndmask_b32 v195, 0, v195, s[32:33]
  v_mfma_f32_16x16x32_bf16 v[152:155], a[68:71], a[168:171], v[152:155]
  v_fma_f32 v84, v164, v225, s16
  v_fma_f32 v85, v165, v225, s16
  v_mfma_f32_16x16x32_bf16 v[156:159], a[148:151], a[168:171], v[156:159]
  v_fma_f32 v86, v166, v225, s16
  v_mfma_f32_16x16x32_bf16 v[184:187], a[168:171], a[68:71], v[184:187]
  buffer_load_dwordx4 a[204:207], v2, s[4:7], s21 offen offset:3072 sc1
  v_fma_f32 v87, v167, v225, s16
  v_mul_f32 v76, 0x3fb8aa3b, v84
  v_mfma_f32_16x16x32_bf16 v[188:191], a[168:171], a[148:151], v[188:191]
  v_mul_f32 v77, 0x3fb8aa3b, v85
  s_waitcnt lgkmcnt(0)
  s_waitcnt vmcnt(6)
  v_mfma_f32_16x16x32_bf16 v[136:139], a[72:75], a[176:179], v[136:139]
  ds_read_b128 a[160:163], v12 offset:12288
  v_mul_f32 v78, 0x3fb8aa3b, v86
  v_mul_f32 v79, 0x3fb8aa3b, v87
  v_mfma_f32_16x16x32_bf16 v[140:143], a[152:155], a[176:179], v[140:143]
  ds_read_b128 a[164:167], v12 offset:13312
  v_exp_f32 v76, v76 clamp
  v_max_f32 v84, s16, v84
  v_mfma_f32_16x16x32_bf16 v[144:147], a[72:75], a[180:183], v[144:147]
  s_add_u32 s21, s46, 4096
  buffer_load_dwordx4 a[208:211], v2, s[4:7], s21 offen offset:0 sc1
  v_exp_f32 v77, v77 clamp
  v_mfma_f32_16x16x32_bf16 v[148:151], a[152:155], a[180:183], v[148:151]
  ds_read_b128 a[168:171], v12 offset:14336
  v_max_f32 v85, s16, v85
  v_exp_f32 v78, v78 clamp
  v_mfma_f32_16x16x32_bf16 v[152:155], a[72:75], a[184:187], v[152:155]
  v_max_f32 v86, s16, v86
  v_exp_f32 v79, v79 clamp
  v_mfma_f32_16x16x32_bf16 v[156:159], a[152:155], a[184:187], v[156:159]
  v_max_f32 v87, s16, v87
  v_mfma_f32_16x16x32_bf16 v[184:187], a[184:187], a[72:75], v[184:187]
  buffer_load_dwordx4 a[212:215], v2, s[4:7], s21 offen offset:1024 sc1
  v_add_f32 v164, v84, v76
  v_add_f32 v165, v85, v77
  v_mfma_f32_16x16x32_bf16 v[188:191], a[184:187], a[152:155], v[188:191]
  v_add_f32 v166, v86, v78
  s_waitcnt lgkmcnt(0)
  s_waitcnt vmcnt(6)
  v_mfma_f32_16x16x32_bf16 v[136:139], a[76:79], a[160:163], v[136:139]
  ds_read_b128 a[176:179], v12 offset:16384
  v_add_f32 v167, v87, v79
  v_cvt_pk_bf16_f32 v196, v164, v165
  v_mfma_f32_16x16x32_bf16 v[140:143], a[156:159], a[160:163], v[140:143]
  ds_read_b128 a[180:183], v12 offset:17408
  v_cvt_pk_bf16_f32 v197, v166, v167
  v_fma_f32 v84, v172, v225, s16
  v_mfma_f32_16x16x32_bf16 v[144:147], a[76:79], a[164:167], v[144:147]
  buffer_load_dwordx4 a[216:219], v2, s[4:7], s21 offen offset:2048 sc1
  v_fma_f32 v85, v173, v225, s16
  v_mfma_f32_16x16x32_bf16 v[148:151], a[156:159], a[164:167], v[148:151]
  ds_read_b128 a[184:187], v12 offset:18432
  v_fma_f32 v86, v174, v225, s16
  v_fma_f32 v87, v175, v225, s16
  v_mfma_f32_16x16x32_bf16 v[152:155], a[76:79], a[168:171], v[152:155]
  v_mul_f32 v76, 0x3fb8aa3b, v84
  v_mul_f32 v77, 0x3fb8aa3b, v85
  v_mfma_f32_16x16x32_bf16 v[156:159], a[156:159], a[168:171], v[156:159]
  v_mul_f32 v78, 0x3fb8aa3b, v86
  v_mfma_f32_16x16x32_bf16 v[184:187], a[168:171], a[76:79], v[184:187]
  buffer_load_dwordx4 a[220:223], v2, s[4:7], s21 offen offset:3072 sc1
  v_mul_f32 v79, 0x3fb8aa3b, v87
  v_exp_f32 v76, v76 clamp
  v_mfma_f32_16x16x32_bf16 v[188:191], a[168:171], a[156:159], v[188:191]
  v_max_f32 v84, s16, v84
  s_waitcnt lgkmcnt(0)
  v_mfma_f32_16x16x32_bf16 v[136:139], v[236:239], a[176:179], v[136:139]
  v_exp_f32 v77, v77 clamp
  v_max_f32 v85, s16, v85
  v_mfma_f32_16x16x32_bf16 v[140:143], v[240:243], a[176:179], v[140:143]
  v_exp_f32 v78, v78 clamp
  v_max_f32 v86, s16, v86
  v_mfma_f32_16x16x32_bf16 v[144:147], v[236:239], a[180:183], v[144:147]
  s_add_u32 s21, s46, 8192
  buffer_load_dwordx4 a[224:227], v2, s[4:7], s21 offen offset:0 sc1
  v_exp_f32 v79, v79 clamp
  v_max_f32 v87, s16, v87
  v_mfma_f32_16x16x32_bf16 v[148:151], v[240:243], a[180:183], v[148:151]
  v_add_f32 v172, v84, v76
  v_mfma_f32_16x16x32_bf16 v[152:155], v[236:239], a[184:187], v[152:155]
  v_add_f32 v173, v85, v77
  v_add_f32 v174, v86, v78
  v_mfma_f32_16x16x32_bf16 v[156:159], v[240:243], a[184:187], v[156:159]
  v_add_f32 v175, v87, v79
  v_cvt_pk_bf16_f32 v198, v172, v173
  v_mfma_f32_16x16x32_bf16 v[184:187], a[184:187], v[236:239], v[184:187]
  buffer_load_dwordx4 a[228:231], v2, s[4:7], s21 offen offset:1024 sc1
  v_cndmask_b32 v198, 0, v198, s[32:33]
  v_cvt_pk_bf16_f32 v199, v174, v175
  v_mfma_f32_16x16x32_bf16 v[188:191], a[184:187], v[240:243], v[188:191]
  v_cndmask_b32 v199, 0, v199, s[32:33]
  v_pk_fma_f32 v[84:85], v[136:137], v[216:217], s[16:17]
  v_pk_fma_f32 v[86:87], v[138:139], v[218:219], s[16:17]
  v_mul_f32 v76, 0x3fb8aa3b, v84
  v_mul_f32 v77, 0x3fb8aa3b, v85
  v_mul_f32 v78, 0x3fb8aa3b, v86
  v_mul_f32 v79, 0x3fb8aa3b, v87
  v_exp_f32 v76, v76 clamp
  v_max_f32 v84, s16, v84
  v_exp_f32 v77, v77 clamp
  v_max_f32 v85, s16, v85
  v_exp_f32 v78, v78 clamp
  v_max_f32 v86, s16, v86
  v_exp_f32 v79, v79 clamp
  v_max_f32 v87, s16, v87
  v_pk_add_f32 v[136:137], v[84:85], v[76:77]
  buffer_load_dwordx4 a[232:235], v2, s[4:7], s21 offen offset:2048 sc1
  v_pk_add_f32 v[138:139], v[86:87], v[78:79]
  v_cvt_pk_bf16_f32 v48, v136, v137
  v_cvt_pk_bf16_f32 v49, v138, v139
  v_pk_fma_f32 v[84:85], v[140:141], v[220:221], s[16:17]
  v_pk_fma_f32 v[86:87], v[142:143], v[222:223], s[16:17]
  v_mul_f32 v76, 0x3fb8aa3b, v84
  v_mul_f32 v77, 0x3fb8aa3b, v85
  v_mul_f32 v78, 0x3fb8aa3b, v86
  v_mul_f32 v79, 0x3fb8aa3b, v87
  v_exp_f32 v76, v76 clamp
  v_max_f32 v84, s16, v84
  v_exp_f32 v77, v77 clamp
  v_max_f32 v85, s16, v85
  v_exp_f32 v78, v78 clamp
  buffer_load_dwordx4 a[236:239], v2, s[4:7], s21 offen offset:3072 sc1
  v_max_f32 v86, s16, v86
  v_exp_f32 v79, v79 clamp
  v_max_f32 v87, s16, v87
  v_pk_add_f32 v[140:141], v[84:85], v[76:77]
  v_pk_add_f32 v[142:143], v[86:87], v[78:79]
  v_cvt_pk_bf16_f32 v50, v140, v141
  v_cvt_pk_bf16_f32 v51, v142, v143
  v_pk_mul_f32 v[144:145], v[144:145], v[216:217]
  v_pk_mul_f32 v[146:147], v[146:147], v[218:219]
  v_cvt_pk_bf16_f32 v52, v144, v145
  v_cvt_pk_bf16_f32 v53, v146, v147
  v_pk_mul_f32 v[148:149], v[148:149], v[220:221]
  v_pk_mul_f32 v[150:151], v[150:151], v[222:223]
  v_cvt_pk_bf16_f32 v54, v148, v149
  s_add_u32 s21, s46, 12288
  buffer_load_dwordx4 a[240:243], v2, s[4:7], s21 offen offset:0 sc1
  v_cvt_pk_bf16_f32 v55, v150, v151
  v_pk_fma_f32 v[84:85], v[152:153], v[216:217], s[16:17]
  v_pk_fma_f32 v[86:87], v[154:155], v[218:219], s[16:17]
  v_mul_f32 v76, 0x3fb8aa3b, v84
  v_mul_f32 v77, 0x3fb8aa3b, v85
  v_mul_f32 v78, 0x3fb8aa3b, v86
  v_mul_f32 v79, 0x3fb8aa3b, v87
  v_exp_f32 v76, v76 clamp
  v_max_f32 v84, s16, v84
  v_exp_f32 v77, v77 clamp
  v_max_f32 v85, s16, v85
  v_exp_f32 v78, v78 clamp
  v_max_f32 v86, s16, v86
  v_exp_f32 v79, v79 clamp
  v_max_f32 v87, s16, v87
  buffer_load_dwordx4 a[244:247], v2, s[4:7], s21 offen offset:1024 sc1
  v_pk_add_f32 v[80:81], v[84:85], v[76:77]
  v_pk_add_f32 v[82:83], v[86:87], v[78:79]
  v_pk_mul_f32 v[152:153], v[152:153], v[216:217]
  v_pk_mul_f32 v[154:155], v[154:155], v[218:219]
  v_cndmask_b32 v152, v152, v80, s[28:29]
  v_cndmask_b32 v153, v153, v81, s[28:29]
  v_cndmask_b32 v154, v154, v82, s[28:29]
  v_cndmask_b32 v155, v155, v83, s[28:29]
  v_cvt_pk_bf16_f32 v56, v152, v153
  v_cvt_pk_bf16_f32 v57, v154, v155
  v_cndmask_b32 v56, v56, v92, s[30:31]
  v_cndmask_b32 v57, v57, v92, s[30:31]
  v_pk_fma_f32 v[84:85], v[156:157], v[220:221], s[16:17]
  v_pk_fma_f32 v[86:87], v[158:159], v[222:223], s[16:17]
  buffer_load_dwordx4 a[248:251], v2, s[4:7], s21 offen offset:2048 sc1
  v_mul_f32 v76, 0x3fb8aa3b, v84
  v_mul_f32 v77, 0x3fb8aa3b, v85
  v_mul_f32 v78, 0x3fb8aa3b, v86
  v_mul_f32 v79, 0x3fb8aa3b, v87
  v_exp_f32 v76, v76 clamp
  v_max_f32 v84, s16, v84
  v_exp_f32 v77, v77 clamp
  v_max_f32 v85, s16, v85
  v_exp_f32 v78, v78 clamp
  v_max_f32 v86, s16, v86
  v_exp_f32 v79, v79 clamp
  v_max_f32 v87, s16, v87
  v_pk_add_f32 v[80:81], v[84:85], v[76:77]
  v_pk_add_f32 v[82:83], v[86:87], v[78:79]
  buffer_load_dwordx4 a[252:255], v2, s[4:7], s21 offen offset:3072 sc1
  v_pk_mul_f32 v[156:157], v[156:157], v[220:221]
  v_pk_mul_f32 v[158:159], v[158:159], v[222:223]
  v_cndmask_b32 v156, v156, v80, s[28:29]
  v_cndmask_b32 v157, v157, v81, s[28:29]
  v_cndmask_b32 v158, v158, v82, s[28:29]
  v_cndmask_b32 v159, v159, v83, s[28:29]
  v_cvt_pk_bf16_f32 v58, v156, v157
  v_cvt_pk_bf16_f32 v59, v158, v159
  v_cndmask_b32 v58, v58, v92, s[30:31]
  v_cndmask_b32 v59, v59, v92, s[30:31]
  v_mfma_f32_16x16x32_bf16 v[60:63], v[48:51], v[52:55], v[60:63]
  s_nop 0
  v_mfma_f32_16x16x32_bf16 v[64:67], v[48:51], v[56:59], v[64:67]
  v_mfma_f32_16x16x32_bf16 v[68:71], v[56:59], v[52:55], v[68:71]
  v_mfma_f32_16x16x32_bf16 v[72:75], v[56:59], v[56:59], v[72:75]
  s_add_u32 m0, s43, 86016
  s_add_u32 s21, s47, 0
  buffer_load_dwordx4 v2, s[4:7], s21 offen offset:0 sc1 lds
  s_lshl_b32 s19, s18, 12
  s_add_u32 s19, s19, 147456
  v_add_u32 v93, s19, v2
  v_add_u32 v104, 147456, v24
  v_add_u32 v105, 147456, v25
  s_lshl_b32 s59, s37, 12
  s_mul_i32 s60, s36, 131072
  s_add_u32 s60, s60, 40866816
  s_add_u32 s60, s60, s59
  ds_write_b128 v93, v[60:63] offset:0
  ds_write_b128 v93, v[64:67] offset:1024
  ds_write_b128 v93, v[68:71] offset:2048
  ds_write_b128 v93, v[72:75] offset:3072
  ds_read_b128 a[160:163], v2 offset:3072
  ds_read_b128 a[164:167], v2 offset:7168
  ds_read_b128 a[168:171], v2 offset:11264
  ds_read_b128 a[172:175], v2 offset:15360
  ds_read_b128 a[176:179], v2 offset:19456
  s_waitcnt lgkmcnt(5)
  s_barrier
  ds_read_b32 v96, v104 offset:0
  ds_read_b32 v97, v104 offset:4096
  ds_read_b32 v98, v104 offset:8192
  ds_read_b32 v99, v104 offset:12288
  ds_read_b32 v100, v105 offset:0
  ds_read_b32 v101, v105 offset:4096
  ds_read_b32 v102, v105 offset:8192
  ds_read_b32 v103, v105 offset:12288
  s_waitcnt lgkmcnt(4)
  v_add_f32 v96, v96, v97
  v_add_f32 v98, v98, v99
  v_add_f32 v96, v96, v98
  buffer_atomic_add_f32 v96, v26, s[4:7], s60 offen
  s_waitcnt lgkmcnt(0)
  v_add_f32 v100, v100, v101
  v_add_f32 v102, v102, v103
  v_add_f32 v100, v100, v102
  buffer_atomic_add_f32 v100, v27, s[4:7], s60 offen
  s_waitcnt lgkmcnt(12)
  v_mfma_f32_16x16x32_bf16 v[176:179], a[160:163], a[0:3], 0
  ds_read_b128 a[180:183], v2 offset:23552
  v_fma_f32 v84, v184, v226, s16
  v_mfma_f32_16x16x32_bf16 v[180:183], a[160:163], a[80:83], 0
  v_fma_f32 v85, v185, v226, s16
  buffer_load_dwordx4 v2, s[4:7], s21 offen offset:1024 sc1 lds
  s_waitcnt lgkmcnt(12)
  v_mfma_f32_16x16x32_bf16 v[176:179], a[164:167], a[4:7], v[176:179]
  ds_read_b128 a[184:187], v2 offset:27648
  v_fma_f32 v86, v186, v226, s16
  v_mfma_f32_16x16x32_bf16 v[180:183], a[164:167], a[84:87], v[180:183]
  v_fma_f32 v87, v187, v226, s16
  v_mul_f32 v76, 0x3fb8aa3b, v84
  buffer_load_dwordx4 v2, s[4:7], s21 offen offset:2048 sc1 lds
  s_waitcnt lgkmcnt(12)
  v_mfma_f32_16x16x32_bf16 v[176:179], a[168:171], a[8:11], v[176:179]
  ds_read_b128 a[188:191], v2 offset:31744
  v_mul_f32 v77, 0x3fb8aa3b, v85
  v_mfma_f32_16x16x32_bf16 v[180:183], a[168:171], a[88:91], v[180:183]
  v_mul_f32 v78, 0x3fb8aa3b, v86
  v_mul_f32 v79, 0x3fb8aa3b, v87
  buffer_load_dwordx4 v2, s[4:7], s21 offen offset:3072 sc1 lds
  s_waitcnt lgkmcnt(12)
  v_mfma_f32_16x16x32_bf16 v[176:179], a[172:175], a[12:15], v[176:179]
  ds_read_b128 a[160:163], v2 offset:35840
  v_exp_f32 v76, v76 clamp
  v_mfma_f32_16x16x32_bf16 v[180:183], a[172:175], a[92:95], v[180:183]
  v_max_f32 v84, s16, v84
  s_add_u32 m0, s43, 90112
  s_add_u32 s21, s47, 4096
  buffer_load_dwordx4 v2, s[4:7], s21 offen offset:0 sc1 lds
  s_waitcnt lgkmcnt(12)
  v_mfma_f32_16x16x32_bf16 v[176:179], a[176:179], a[16:19], v[176:179]
  ds_read_b128 a[164:167], v2 offset:39936
  v_exp_f32 v77, v77 clamp
  v_mfma_f32_16x16x32_bf16 v[180:183], a[176:179], a[96:99], v[180:183]
  v_max_f32 v85, s16, v85
  v_exp_f32 v78, v78 clamp
  buffer_load_dwordx4 v2, s[4:7], s21 offen offset:1024 sc1 lds
  s_waitcnt lgkmcnt(4)
  v_mfma_f32_16x16x32_bf16 v[176:179], a[180:183], a[20:23], v[176:179]
  ds_read_b128 a[168:171], v2 offset:44032
  v_max_f32 v86, s16, v86
  v_mfma_f32_16x16x32_bf16 v[180:183], a[180:183], a[100:103], v[180:183]
  v_exp_f32 v79, v79 clamp
  v_max_f32 v87, s16, v87
  buffer_load_dwordx4 v2, s[4:7], s21 offen offset:2048 sc1 lds
  s_waitcnt lgkmcnt(4)
  v_mfma_f32_16x16x32_bf16 v[176:179], a[184:187], a[24:27], v[176:179]
  ds_read_b128 a[172:175], v2 offset:48128
  v_mfma_f32_16x16x32_bf16 v[180:183], a[184:187], a[104:107], v[180:183]
  v_add_f32 v184, v84, v76
  v_add_f32 v185, v85, v77
  s_waitcnt lgkmcnt(4)
  v_mfma_f32_16x16x32_bf16 v[176:179], a[188:191], a[28:31], v[176:179]
  ds_read_b128 a[176:179], v2 offset:52224
  v_add_f32 v186, v86, v78
  v_mfma_f32_16x16x32_bf16 v[180:183], a[188:191], a[108:111], v[180:183]
  v_add_f32 v187, v87, v79
  v_cvt_pk_bf16_f32 v202, v184, v185
  s_waitcnt lgkmcnt(4)
  v_mfma_f32_16x16x32_bf16 v[176:179], a[160:163], a[32:35], v[176:179]
  ds_read_b128 a[180:183], v2 offset:56320
  v_cndmask_b32 v202, 0, v202, s[32:33]
  v_mfma_f32_16x16x32_bf16 v[180:183], a[160:163], a[112:115], v[180:183]
  v_cvt_pk_bf16_f32 v203, v186, v187
  v_cndmask_b32 v203, 0, v203, s[32:33]
  s_waitcnt lgkmcnt(4)
  v_mfma_f32_16x16x32_bf16 v[176:179], a[164:167], a[36:39], v[176:179]
  ds_read_b128 a[184:187], v2 offset:60416
  v_mfma_f32_16x16x32_bf16 v[180:183], a[164:167], a[116:119], v[180:183]
  v_fma_f32 v84, v188, v227, s16
  v_fma_f32 v85, v189, v227, s16
  s_waitcnt lgkmcnt(4)
  v_mfma_f32_16x16x32_bf16 v[176:179], a[168:171], a[40:43], v[176:179]
  ds_read_b128 a[188:191], v2 offset:64512
  v_fma_f32 v86, v190, v227, s16
  v_mfma_f32_16x16x32_bf16 v[180:183], a[168:171], a[120:123], v[180:183]
  v_fma_f32 v87, v191, v227, s16
  v_mul_f32 v76, 0x3fb8aa3b, v84
  s_waitcnt lgkmcnt(4)
  v_mfma_f32_16x16x32_bf16 v[176:179], a[172:175], a[44:47], v[176:179]
  ds_read_b128 a[160:163], v12 offset:3072
  v_mul_f32 v77, 0x3fb8aa3b, v85
  v_mfma_f32_16x16x32_bf16 v[180:183], a[172:175], a[124:127], v[180:183]
  v_mul_f32 v78, 0x3fb8aa3b, v86
  v_mul_f32 v79, 0x3fb8aa3b, v87
  s_waitcnt lgkmcnt(4)
  v_mfma_f32_16x16x32_bf16 v[176:179], a[176:179], a[48:51], v[176:179]
  ds_read_b128 a[164:167], v12 offset:7168
  v_mfma_f32_16x16x32_bf16 v[180:183], a[176:179], a[128:131], v[180:183]
  v_exp_f32 v76, v76 clamp
  v_max_f32 v84, s16, v84
  s_waitcnt lgkmcnt(4)
  v_mfma_f32_16x16x32_bf16 v[176:179], a[180:183], a[52:55], v[176:179]
  ds_read_b128 a[168:171], v12 offset:11264
  v_exp_f32 v77, v77 clamp
  v_mfma_f32_16x16x32_bf16 v[180:183], a[180:183], a[132:135], v[180:183]
  v_max_f32 v85, s16, v85
  v_exp_f32 v78, v78 clamp
  s_waitcnt lgkmcnt(4)
  v_mfma_f32_16x16x32_bf16 v[176:179], a[184:187], a[56:59], v[176:179]
  ds_read_b128 a[172:175], v12 offset:15360
  v_max_f32 v86, s16, v86
  v_mfma_f32_16x16x32_bf16 v[180:183], a[184:187], a[136:139], v[180:183]
  v_exp_f32 v79, v79 clamp
  v_max_f32 v87, s16, v87
  s_waitcnt lgkmcnt(4)
  v_mfma_f32_16x16x32_bf16 v[176:179], a[188:191], a[60:63], v[176:179]
  ds_read_b128 a[176:179], v12 offset:19456
  v_mfma_f32_16x16x32_bf16 v[180:183], a[188:191], a[140:143], v[180:183]
  v_add_f32 v188, v84, v76
  v_add_f32 v189, v85, v77
  s_waitcnt lgkmcnt(4)
  v_mfma_f32_16x16x32_bf16 v[176:179], a[160:163], a[64:67], v[176:179]
  v_add_f32 v190, v86, v78
  v_mfma_f32_16x16x32_bf16 v[180:183], a[160:163], a[144:147], v[180:183]
  v_add_f32 v191, v87, v79
  v_cvt_pk_bf16_f32 v206, v188, v189
  s_waitcnt lgkmcnt(3)
  v_mfma_f32_16x16x32_bf16 v[176:179], a[164:167], a[68:71], v[176:179]
  v_cndmask_b32 v206, 0, v206, s[32:33]
  v_mfma_f32_16x16x32_bf16 v[180:183], a[164:167], a[148:151], v[180:183]
  v_cvt_pk_bf16_f32 v207, v190, v191
  v_cndmask_b32 v207, 0, v207, s[32:33]
  s_waitcnt lgkmcnt(2)
  v_mfma_f32_16x16x32_bf16 v[176:179], a[168:171], a[72:75], v[176:179]
  v_mfma_f32_16x16x32_bf16 v[180:183], a[168:171], a[152:155], v[180:183]
  s_waitcnt lgkmcnt(1)
  v_mfma_f32_16x16x32_bf16 v[176:179], a[172:175], a[76:79], v[176:179]
  v_mfma_f32_16x16x32_bf16 v[180:183], a[172:175], a[156:159], v[180:183]
  s_waitcnt lgkmcnt(0)
  v_mfma_f32_16x16x32_bf16 v[176:179], a[176:179], v[236:239], v[176:179]
  v_mfma_f32_16x16x32_bf16 v[180:183], a[176:179], v[240:243], v[180:183]
  s_barrier
  s_nop 5
  v_pk_fma_f32 v[84:85], v[176:177], v[226:227], s[16:17] op_sel:[0,0,0] op_sel_hi:[1,0,1]
  v_pk_fma_f32 v[86:87], v[178:179], v[226:227], s[16:17] op_sel:[0,0,0] op_sel_hi:[1,0,1]
  v_mul_f32 v76, 0x3fb8aa3b, v84
  v_mul_f32 v77, 0x3fb8aa3b, v85
  v_mul_f32 v78, 0x3fb8aa3b, v86
  v_mul_f32 v79, 0x3fb8aa3b, v87
  v_exp_f32 v76, v76 clamp
  v_max_f32 v84, s16, v84
  v_exp_f32 v77, v77 clamp
  v_max_f32 v85, s16, v85
  v_exp_f32 v78, v78 clamp
  v_max_f32 v86, s16, v86
  v_exp_f32 v79, v79 clamp
  v_max_f32 v87, s16, v87
  v_pk_add_f32 v[176:177], v[84:85], v[76:77]
  v_pk_add_f32 v[178:179], v[86:87], v[78:79]
  v_cvt_pk_bf16_f32 v200, v176, v177
  v_cvt_pk_bf16_f32 v201, v178, v179
  v_pk_fma_f32 v[84:85], v[180:181], v[226:227], s[16:17] op_sel:[0,1,0] op_sel_hi:[1,1,1]
  v_pk_fma_f32 v[86:87], v[182:183], v[226:227], s[16:17] op_sel:[0,1,0] op_sel_hi:[1,1,1]
  v_mul_f32 v76, 0x3fb8aa3b, v84
  v_mul_f32 v77, 0x3fb8aa3b, v85
  v_mul_f32 v78, 0x3fb8aa3b, v86
  v_mul_f32 v79, 0x3fb8aa3b, v87
  v_exp_f32 v76, v76 clamp
  v_max_f32 v84, s16, v84
  v_exp_f32 v77, v77 clamp
  v_max_f32 v85, s16, v85
  v_exp_f32 v78, v78 clamp
  v_max_f32 v86, s16, v86
  v_exp_f32 v79, v79 clamp
  v_max_f32 v87, s16, v87
  v_pk_add_f32 v[180:181], v[84:85], v[76:77]
  v_pk_add_f32 v[182:183], v[86:87], v[78:79]
  v_cvt_pk_bf16_f32 v204, v180, v181
  v_cvt_pk_bf16_f32 v205, v182, v183
  s_waitcnt vmcnt(6)
  s_lshl_b32 s59, s37, 8
  s_mul_i32 s19, s36, 8192
  s_add_u32 s19, s19, 41260032
  s_add_u32 s19, s19, s59
  s_lshl_b32 s20, s51, 2
  s_add_u32 s19, s19, s20
  v_mov_b32 v20, s14
  v_mov_b32 v21, s15
  s_mov_b64 exec, 1
  buffer_store_dwordx2 v[20:21], v5, s[4:7], s19 offen sc1
  s_mov_b64 exec, -1
  s_add_u32 s21, s46, 16384
  buffer_load_dwordx4 a[0:3], v2, s[4:7], s21 offen offset:0 sc1
  buffer_load_dwordx4 a[4:7], v2, s[4:7], s21 offen offset:1024 sc1
  buffer_load_dwordx4 a[8:11], v2, s[4:7], s21 offen offset:2048 sc1
  buffer_load_dwordx4 a[12:15], v2, s[4:7], s21 offen offset:3072 sc1
  s_add_u32 s21, s46, 20480
  buffer_load_dwordx4 a[16:19], v2, s[4:7], s21 offen offset:0 sc1
  buffer_load_dwordx4 a[20:23], v2, s[4:7], s21 offen offset:1024 sc1
  buffer_load_dwordx4 a[24:27], v2, s[4:7], s21 offen offset:2048 sc1
  buffer_load_dwordx4 a[28:31], v2, s[4:7], s21 offen offset:3072 sc1
  s_add_u32 s21, s46, 24576
  buffer_load_dwordx4 a[32:35], v2, s[4:7], s21 offen offset:0 sc1
  s_add_u32 m0, s43, 0
  s_add_u32 s21, s47, 28672
  buffer_load_dwordx4 v2, s[4:7], s21 offen offset:0 sc1 lds
  buffer_load_dwordx4 v2, s[4:7], s21 offen offset:1024 sc1 lds
  buffer_load_dwordx4 v2, s[4:7], s21 offen offset:2048 sc1 lds
  s_cmp_lg_u32 s18, 0
  s_cbranch_scc1 L_ok1
  s_lshl_b32 s59, s37, 8
  s_mul_i32 s19, s36, 8192
  s_add_u32 s19, s19, 41260032
  s_add_u32 s19, s19, s59
  s_mov_b32 s24, 0
  s_mov_b32 exec_hi, 0
L_ct1:
  buffer_load_dwordx2 v[22:23], v8, s[4:7], s19 offen sc1
  s_add_u32 s24, s24, 1
  s_waitcnt vmcnt(0)
  v_cmp_ne_u64 vcc, s[14:15], v[22:23]
  s_nop 0
  s_cmp_eq_u64 vcc, 0
  s_cbranch_scc1 L_pd1
  s_sleep 1
  s_cmp_lt_u32 s24, 100000
  s_cbranch_scc1 L_ct1
L_pd1:
  s_mov_b64 exec, -1
L_ok1:
  s_barrier
  buffer_load_dwordx4 v[112:115], v28, s[4:7], s60 offen sc1
  buffer_load_dwordx4 v[116:119], v31, s[4:7], s60 offen sc1
  buffer_load_dwordx4 v[120:123], v29, s[4:7], s60 offen sc1
  buffer_load_dwordx4 v[124:127], v32, s[4:7], s60 offen sc1
  buffer_load_dwordx4 v[128:131], v30, s[4:7], s60 offen sc1
  buffer_load_dwordx4 v[132:135], v33, s[4:7], s60 offen sc1
  s_mul_i32 s59, s51, 20480
  s_mul_i32 s19, s36, 2621440
  s_add_u32 s19, s19, 20943872
  s_add_u32 s19, s19, s59
  s_lshl_b32 s59, s37, 7
  s_add_u32 s20, s19, s59
  s_add_u32 s20, s20, 16384
  s_lshl_b32 s59, s37, 9
  s_add_u32 s19, s19, s59
  s_waitcnt vmcnt(0)
  v_cvt_pk_bf16_f32 v48, v112, v113
  v_cvt_pk_bf16_f32 v49, v114, v115
  v_cvt_pk_bf16_f32 v50, v116, v117
  v_cvt_pk_bf16_f32 v51, v118, v119
  v_cvt_pk_bf16_f32 v52, v120, v121
  v_cvt_pk_bf16_f32 v53, v122, v123
  v_cvt_pk_bf16_f32 v54, v124, v125
  v_cvt_pk_bf16_f32 v55, v126, v127
  v_cvt_pk_bf16_f32 v56, v128, v129
  v_cvt_pk_bf16_f32 v57, v130, v131
  v_cvt_pk_bf16_f32 v58, v132, v133
  v_cvt_pk_bf16_f32 v59, v134, v135
  v_mfma_f32_16x16x32_bf16 v[136:139], v[48:51], v[192:195], 0
  v_mfma_f32_16x16x32_bf16 v[140:143], v[52:55], v[192:195], 0
  v_mfma_f32_16x16x32_bf16 v[144:147], v[56:59], v[192:195], 0
  v_mfma_f32_16x16x32_bf16 v[148:151], v[48:51], v[196:199], 0
  v_mfma_f32_16x16x32_bf16 v[152:155], v[52:55], v[196:199], 0
  v_mfma_f32_16x16x32_bf16 v[156:159], v[56:59], v[196:199], 0
  v_mfma_f32_16x16x32_bf16 v[160:163], v[48:51], v[200:203], 0
  v_mfma_f32_16x16x32_bf16 v[164:167], v[52:55], v[200:203], 0
  v_mfma_f32_16x16x32_bf16 v[168:171], v[56:59], v[200:203], 0
  v_mfma_f32_16x16x32_bf16 v[172:175], v[48:51], v[204:207], 0
  v_mfma_f32_16x16x32_bf16 v[176:179], v[52:55], v[204:207], 0
  v_mfma_f32_16x16x32_bf16 v[180:183], v[56:59], v[204:207], 0
  v_add_f32 v144, s16, v144
  v_rcp_f32 v144, v144
  s_nop 0
  v_pk_mul_f32 v[136:137], v[136:137], v[144:145] op_sel_hi:[1,0]
  v_pk_mul_f32 v[138:139], v[138:139], v[144:145] op_sel_hi:[1,0]
  v_pk_mul_f32 v[140:141], v[140:141], v[144:145] op_sel_hi:[1,0]
  v_pk_mul_f32 v[142:143], v[142:143], v[144:145] op_sel_hi:[1,0]
  v_cvt_pk_bf16_f32 v112, v136, v137
  v_cvt_pk_bf16_f32 v113, v138, v139
  v_cvt_pk_bf16_f32 v114, v140, v141
  v_cvt_pk_bf16_f32 v115, v142, v143
  s_add_u32 s59, s19, 0
  s_add_u32 s60, s20, 0
  buffer_store_dwordx4 v[112:115], v17, s[4:7], s59 offen sc1
  buffer_store_dwordx2 v[112:113], v18, s[4:7], s60 offen sc1
  v_add_f32 v156, s16, v156
  v_rcp_f32 v156, v156
  s_nop 0
  v_pk_mul_f32 v[148:149], v[148:149], v[156:157] op_sel_hi:[1,0]
  v_pk_mul_f32 v[150:151], v[150:151], v[156:157] op_sel_hi:[1,0]
  v_pk_mul_f32 v[152:153], v[152:153], v[156:157] op_sel_hi:[1,0]
  v_pk_mul_f32 v[154:155], v[154:155], v[156:157] op_sel_hi:[1,0]
  v_cvt_pk_bf16_f32 v116, v148, v149
  v_cvt_pk_bf16_f32 v117, v150, v151
  v_cvt_pk_bf16_f32 v118, v152, v153
  v_cvt_pk_bf16_f32 v119, v154, v155
  s_add_u32 s59, s19, 20480
  s_add_u32 s60, s20, 20480
  buffer_store_dwordx4 v[116:119], v17, s[4:7], s59 offen sc1
  buffer_store_dwordx2 v[116:117], v18, s[4:7], s60 offen sc1
  v_add_f32 v168, s16, v168
  v_rcp_f32 v168, v168
  s_nop 0
  v_pk_mul_f32 v[160:161], v[160:161], v[168:169] op_sel_hi:[1,0]
  v_pk_mul_f32 v[162:163], v[162:163], v[168:169] op_sel_hi:[1,0]
  v_pk_mul_f32 v[164:165], v[164:165], v[168:169] op_sel_hi:[1,0]
  v_pk_mul_f32 v[166:167], v[166:167], v[168:169] op_sel_hi:[1,0]
  v_cvt_pk_bf16_f32 v120, v160, v161
  v_cvt_pk_bf16_f32 v121, v162, v163
  v_cvt_pk_bf16_f32 v122, v164, v165
  v_cvt_pk_bf16_f32 v123, v166, v167
  s_add_u32 s59, s19, 1310720
  s_add_u32 s60, s20, 1310720
  buffer_store_dwordx4 v[120:123], v17, s[4:7], s59 offen sc1
  buffer_store_dwordx2 v[120:121], v18, s[4:7], s60 offen sc1
  v_add_f32 v180, s16, v180
  v_rcp_f32 v180, v180
  s_nop 0
  v_pk_mul_f32 v[172:173], v[172:173], v[180:181] op_sel_hi:[1,0]
  v_pk_mul_f32 v[174:175], v[174:175], v[180:181] op_sel_hi:[1,0]
  v_pk_mul_f32 v[176:177], v[176:177], v[180:181] op_sel_hi:[1,0]
  v_pk_mul_f32 v[178:179], v[178:179], v[180:181] op_sel_hi:[1,0]
  v_cvt_pk_bf16_f32 v124, v172, v173
  v_cvt_pk_bf16_f32 v125, v174, v175
  v_cvt_pk_bf16_f32 v126, v176, v177
  v_cvt_pk_bf16_f32 v127, v178, v179
  s_add_u32 s59, s19, 1331200
  s_add_u32 s60, s20, 1331200
  buffer_store_dwordx4 v[124:127], v17, s[4:7], s59 offen sc1
  buffer_store_dwordx2 v[124:125], v18, s[4:7], s60 offen sc1
  s_waitcnt vmcnt(4)
  s_mul_i32 s19, s36, 65536
  s_add_u32 s19, s19, 0
  s_add_u32 s19, s19, s55
  s_lshl_b32 s59, s37, 3
  s_add_u32 s19, s19, s59
  v_mov_b32 v20, s14
  v_mov_b32 v21, s15
  s_mov_b64 exec, 1
  buffer_store_dwordx2 v[20:21], v5, s[4:7], s19 offen sc1
  s_mov_b64 exec, -1
  s_waitcnt vmcnt(1)
  s_mul_i32 s19, s36, 65536
  s_add_u32 s19, s19, 8192
  s_add_u32 s19, s19, s55
  s_lshl_b32 s59, s37, 3
  s_add_u32 s19, s19, s59
  v_mov_b32 v20, s14
  v_mov_b32 v21, s15
  s_mov_b64 exec, 1
  buffer_store_dwordx2 v[20:21], v5, s[4:7], s19 offen sc1
  s_mov_b64 exec, -1
  buffer_load_dwordx4 v2, s[4:7], s21 offen offset:3072 sc1 lds
  s_add_u32 m0, s43, 4096
  s_add_u32 s21, s47, 32768
  buffer_load_dwordx4 v2, s[4:7], s21 offen offset:0 sc1 lds
  buffer_load_dwordx4 v2, s[4:7], s21 offen offset:1024 sc1 lds
  buffer_load_dwordx4 v2, s[4:7], s21 offen offset:2048 sc1 lds
  s_add_u32 m0, s43, 28672
  s_add_u32 s21, s47, 57344
  buffer_load_dwordx4 v2, s[4:7], s21 offen offset:0 sc1 lds
  buffer_load_dwordx4 v2, s[4:7], s21 offen offset:1024 sc1 lds
  buffer_load_dwordx4 v2, s[4:7], s21 offen offset:2048 sc1 lds
  buffer_load_dwordx4 v2, s[4:7], s21 offen offset:3072 sc1 lds
  s_add_u32 m0, s43, 32768
  s_add_u32 s21, s47, 61440
  buffer_load_dwordx4 v2, s[4:7], s21 offen offset:0 sc1 lds
  buffer_load_dwordx4 v2, s[4:7], s21 offen offset:1024 sc1 lds
  buffer_load_dwordx4 v2, s[4:7], s21 offen offset:2048 sc1 lds
  s_add_u32 m0, s43, 57344
  s_add_u32 s21, s47, 86016
  buffer_load_dwordx4 v2, s[4:7], s21 offen offset:0 sc1 lds
  buffer_load_dwordx4 v2, s[4:7], s21 offen offset:1024 sc1 lds
  buffer_load_dwordx4 v2, s[4:7], s21 offen offset:2048 sc1 lds
  buffer_load_dwordx4 v2, s[4:7], s21 offen offset:3072 sc1 lds
  s_add_u32 m0, s43, 61440
  s_add_u32 s21, s47, 90112
  buffer_load_dwordx4 v2, s[4:7], s21 offen offset:0 sc1 lds
  buffer_load_dwordx4 v2, s[4:7], s21 offen offset:1024 sc1 lds
  buffer_load_dwordx4 v2, s[4:7], s21 offen offset:2048 sc1 lds
  s_add_u32 s25, s49, 0
  buffer_load_dwordx4 a[36:39], v2, s[4:7], s25 offen offset:0 sc1
  buffer_load_dwordx4 a[40:43], v2, s[4:7], s25 offen offset:1024 sc1
  s_mul_i32 s59, s52, 20480
  s_mul_i32 s57, s36, 2621440
  s_add_u32 s57, s57, 20943872
  s_add_u32 s57, s57, s59
  s_add_u32 s57, s57, s42
  s_mul_i32 s59, s52, 20480
  s_mul_i32 s58, s36, 2621440
  s_add_u32 s58, s58, 22254592
  s_add_u32 s58, s58, s59
  s_add_u32 s58, s58, s42
  v_and_b32 v6, 31, v1
  v_lshlrev_b32 v6, 3, v6
  v_lshrrev_b32 v7, 5, v1
  v_lshl_add_u32 v6, v7, 13, v6
  s_cmp_lg_u32 s18, 0
  s_cbranch_scc1 L_ok2
  s_mul_i32 s19, s36, 65536
  s_add_u32 s19, s19, 0
  s_add_u32 s19, s19, s56
  s_mov_b32 s24, 0
  s_mov_b32 exec_hi, -1
L_ct2:
  buffer_load_dwordx2 v[22:23], v6, s[4:7], s19 offen sc1
  s_add_u32 s24, s24, 1
  s_waitcnt vmcnt(0)
  v_cmp_ne_u64 vcc, s[14:15], v[22:23]
  s_nop 0
  s_cmp_eq_u64 vcc, 0
  s_cbranch_scc1 L_pd2
  s_sleep 1
  s_cmp_lt_u32 s24, 100000
  s_cbranch_scc1 L_ct2
L_pd2:
  s_mov_b64 exec, -1
L_ok2:
  s_barrier
  s_add_u32 s22, s57, 0
  buffer_load_dwordx4 v[64:67], v2, s[4:7], s22 offen offset:0 sc1
  buffer_load_dwordx4 v[68:71], v14, s[4:7], s22 offen offset:0 sc1
  buffer_load_dwordx4 v[72:75], v2, s[4:7], s22 offen offset:1024 sc1
  buffer_load_dwordx4 v[76:79], v14, s[4:7], s22 offen offset:1024 sc1
  buffer_load_dwordx4 v[80:83], v2, s[4:7], s22 offen offset:2048 sc1
  buffer_load_dwordx4 v[84:87], v14, s[4:7], s22 offen offset:2048 sc1
  buffer_load_dwordx4 v[88:91], v2, s[4:7], s22 offen offset:3072 sc1
  buffer_load_dwordx4 v[92:95], v14, s[4:7], s22 offen offset:3072 sc1
  s_sub_u32 s22, s57, s42
  s_add_u32 s22, s22, s40
  s_add_u32 s22, s22, 16384
  buffer_load_dwordx2 v[96:97], v16, s[4:7], s22 offen offset:0 sc1
  buffer_load_dwordx2 v[98:99], v16, s[4:7], s22 offen offset:128 sc1
  s_sub_u32 s22, s57, s42
  s_add_u32 s22, s22, s40
  s_add_u32 s22, s22, 36864
  buffer_load_dwordx2 v[100:101], v16, s[4:7], s22 offen offset:0 sc1
  buffer_load_dwordx2 v[102:103], v16, s[4:7], s22 offen offset:128 sc1
  s_waitcnt vmcnt(10)
  s_waitcnt vmcnt(63)
  v_mfma_f32_16x16x32_bf16 v[112:115], a[192:195], v[64:67], 0
  v_mfma_f32_16x16x32_bf16 v[132:135], a[192:195], v[68:71], 0
  s_mul_i32 s19, s36, 5242880
  s_add_u32 s19, s19, 10458112
  s_add_u32 s19, s19, s53
  s_mul_i32 s20, s36, 5242880
  s_add_u32 s20, s20, 10458112
  s_add_u32 s20, s20, s54
  buffer_load_dwordx4 v[152:155], v2, s[4:7], s19 offen sc1
  buffer_load_dwordx4 v[156:159], v2, s[4:7], s19 offen offset:1024 sc1
  buffer_load_dwordx2 v[160:161], v11, s[4:7], s20 offen sc1
  v_mfma_f32_16x16x32_bf16 v[116:119], a[196:199], v[64:67], 0
  v_mfma_f32_16x16x32_bf16 v[136:139], a[196:199], v[68:71], 0
  v_mfma_f32_16x16x32_bf16 v[120:123], a[200:203], v[64:67], 0
  v_mfma_f32_16x16x32_bf16 v[140:143], a[200:203], v[68:71], 0
  s_add_u32 s22, s58, 0
  buffer_load_dwordx4 v[104:107], v2, s[4:7], s22 offen offset:0 sc1
  v_mfma_f32_16x16x32_bf16 v[124:127], a[204:207], v[64:67], 0
  v_mfma_f32_16x16x32_bf16 v[144:147], a[204:207], v[68:71], 0
  v_mfma_f32_16x16x32_bf16 v[128:131], a[208:211], v[64:67], 0
  buffer_load_dwordx4 v[108:111], v14, s[4:7], s22 offen offset:0 sc1
  v_mfma_f32_16x16x32_bf16 v[148:151], a[208:211], v[68:71], 0
  s_waitcnt vmcnt(13)
  s_waitcnt vmcnt(63)
  v_mfma_f32_16x16x32_bf16 v[112:115], a[212:215], v[72:75], v[112:115]
  v_mfma_f32_16x16x32_bf16 v[132:135], a[212:215], v[76:79], v[132:135]
  buffer_load_dwordx4 v[48:51], v2, s[4:7], s22 offen offset:1024 sc1
  v_mfma_f32_16x16x32_bf16 v[116:119], a[216:219], v[72:75], v[116:119]
  v_mfma_f32_16x16x32_bf16 v[136:139], a[216:219], v[76:79], v[136:139]
  v_mfma_f32_16x16x32_bf16 v[120:123], a[220:223], v[72:75], v[120:123]
  v_mfma_f32_16x16x32_bf16 v[140:143], a[220:223], v[76:79], v[140:143]
  buffer_load_dwordx4 v[52:55], v14, s[4:7], s22 offen offset:1024 sc1
  v_mfma_f32_16x16x32_bf16 v[124:127], a[224:227], v[72:75], v[124:127]
  v_mfma_f32_16x16x32_bf16 v[144:147], a[224:227], v[76:79], v[144:147]
  v_mfma_f32_16x16x32_bf16 v[128:131], a[228:231], v[72:75], v[128:131]
  buffer_load_dwordx4 v[56:59], v2, s[4:7], s22 offen offset:2048 sc1
  v_mfma_f32_16x16x32_bf16 v[148:151], a[228:231], v[76:79], v[148:151]
  s_waitcnt vmcnt(14)
  s_waitcnt vmcnt(63)
  v_mfma_f32_16x16x32_bf16 v[112:115], a[232:235], v[80:83], v[112:115]
  v_mfma_f32_16x16x32_bf16 v[132:135], a[232:235], v[84:87], v[132:135]
  buffer_load_dwordx4 v[60:63], v14, s[4:7], s22 offen offset:2048 sc1
  v_mfma_f32_16x16x32_bf16 v[116:119], a[236:239], v[80:83], v[116:119]
  v_mfma_f32_16x16x32_bf16 v[136:139], a[236:239], v[84:87], v[136:139]
  v_mfma_f32_16x16x32_bf16 v[120:123], a[240:243], v[80:83], v[120:123]
  v_mfma_f32_16x16x32_bf16 v[140:143], a[240:243], v[84:87], v[140:143]
  buffer_load_dwordx4 v[64:67], v2, s[4:7], s22 offen offset:3072 sc1
  v_mfma_f32_16x16x32_bf16 v[124:127], a[244:247], v[80:83], v[124:127]
  v_mfma_f32_16x16x32_bf16 v[144:147], a[244:247], v[84:87], v[144:147]
  v_mfma_f32_16x16x32_bf16 v[128:131], a[248:251], v[80:83], v[128:131]
  buffer_load_dwordx4 v[68:71], v14, s[4:7], s22 offen offset:3072 sc1
  v_mfma_f32_16x16x32_bf16 v[148:151], a[248:251], v[84:87], v[148:151]
  s_waitcnt vmcnt(15)
  s_waitcnt vmcnt(63)
  v_mfma_f32_16x16x32_bf16 v[112:115], a[252:255], v[88:91], v[112:115]
  v_mfma_f32_16x16x32_bf16 v[132:135], a[252:255], v[92:95], v[132:135]
  v_mfma_f32_16x16x32_bf16 v[116:119], a[0:3], v[88:91], v[116:119]
  s_sub_u32 s22, s58, s42
  s_add_u32 s22, s22, s40
  s_add_u32 s22, s22, 16384
  buffer_load_dwordx2 v[72:73], v16, s[4:7], s22 offen offset:0 sc1
  buffer_load_dwordx2 v[74:75], v16, s[4:7], s22 offen offset:128 sc1
  v_mfma_f32_16x16x32_bf16 v[136:139], a[0:3], v[92:95], v[136:139]
  v_mfma_f32_16x16x32_bf16 v[120:123], a[4:7], v[88:91], v[120:123]
  v_mfma_f32_16x16x32_bf16 v[140:143], a[4:7], v[92:95], v[140:143]
  v_mfma_f32_16x16x32_bf16 v[124:127], a[8:11], v[88:91], v[124:127]
  v_mfma_f32_16x16x32_bf16 v[144:147], a[8:11], v[92:95], v[144:147]
  s_sub_u32 s22, s58, s42
  s_add_u32 s22, s22, s40
  s_add_u32 s22, s22, 36864
  buffer_load_dwordx2 v[76:77], v16, s[4:7], s22 offen offset:0 sc1
  buffer_load_dwordx2 v[78:79], v16, s[4:7], s22 offen offset:128 sc1
  v_mfma_f32_16x16x32_bf16 v[128:131], a[12:15], v[88:91], v[128:131]
  v_mfma_f32_16x16x32_bf16 v[148:151], a[12:15], v[92:95], v[148:151]
  s_waitcnt vmcnt(15)
  s_waitcnt vmcnt(63)
  v_mfma_f32_16x16x32_bf16 v[112:115], a[16:19], v[96:99], v[112:115]
  v_mfma_f32_16x16x32_bf16 v[132:135], a[16:19], v[100:103], v[132:135]
  v_mfma_f32_16x16x32_bf16 v[116:119], a[20:23], v[96:99], v[116:119]
  buffer_load_dwordx4 a[44:47], v2, s[4:7], s25 offen offset:2048 sc1
  v_mfma_f32_16x16x32_bf16 v[136:139], a[20:23], v[100:103], v[136:139]
  v_mfma_f32_16x16x32_bf16 v[120:123], a[24:27], v[96:99], v[120:123]
  v_mfma_f32_16x16x32_bf16 v[140:143], a[24:27], v[100:103], v[140:143]
  v_mfma_f32_16x16x32_bf16 v[124:127], a[28:31], v[96:99], v[124:127]
  v_mfma_f32_16x16x32_bf16 v[144:147], a[28:31], v[100:103], v[144:147]
  buffer_load_dwordx4 a[48:51], v2, s[4:7], s25 offen offset:3072 sc1
  v_mfma_f32_16x16x32_bf16 v[128:131], a[32:35], v[96:99], v[128:131]
  v_mfma_f32_16x16x32_bf16 v[148:151], a[32:35], v[100:103], v[148:151]
  s_add_u32 s25, s49, 4096
  buffer_load_dwordx4 a[52:55], v2, s[4:7], s25 offen offset:0 sc1
  buffer_load_dwordx4 a[56:59], v2, s[4:7], s25 offen offset:1024 sc1
  buffer_load_dwordx4 a[60:63], v2, s[4:7], s25 offen offset:2048 sc1
  buffer_load_dwordx4 a[64:67], v2, s[4:7], s25 offen offset:3072 sc1
  s_cmp_gt_u32 s18, 0
  s_cselect_b32 s19, 1, 0
  s_sub_u32 s19, s18, s19
  s_mul_i32 s19, s19, 5120
  s_add_u32 s19, s19, 133120
  v_add_u32 v224, s19, v2
  s_cmp_gt_u32 s18, 1
  s_cselect_b32 s19, 1, 0
  s_sub_u32 s19, s18, s19
  s_mul_i32 s19, s19, 5120
  s_add_u32 s19, s19, 148480
  v_add_u32 v225, s19, v2
  s_barrier
  s_cmp_eq_u32 s18, 0
  s_cbranch_scc1 L_rw3_0
  ds_write_b128 v224, v[112:115] offset:0
  ds_write_b128 v224, v[116:119] offset:1024
  ds_write_b128 v224, v[120:123] offset:2048
  ds_write_b128 v224, v[124:127] offset:3072
  ds_write_b128 v224, v[128:131] offset:4096
L_rw3_0:
  s_cmp_eq_u32 s18, 1
  s_cbranch_scc1 L_rw3_1
  ds_write_b128 v225, v[132:135] offset:0
  ds_write_b128 v225, v[136:139] offset:1024
  ds_write_b128 v225, v[140:143] offset:2048
  ds_write_b128 v225, v[144:147] offset:3072
  ds_write_b128 v225, v[148:151] offset:4096
L_rw3_1:
  s_waitcnt vmcnt(18)
  s_lshr_b32 s19, s18, 1
  s_cmp_lg_u32 s19, 0
  s_cbranch_scc1 L_rp3
  s_and_b32 s19, s18, 1
  s_mul_i32 s20, s19, 15360
  s_add_u32 s20, s20, 133120
  v_add_u32 v224, s20, v2
  v_lshlrev_b32 v164, 16, v152
  v_and_b32 v165, 0xffff0000, v152
  v_lshlrev_b32 v166, 16, v153
  v_and_b32 v167, 0xffff0000, v153
  v_lshlrev_b32 v168, 16, v154
  v_and_b32 v169, 0xffff0000, v154
  v_lshlrev_b32 v170, 16, v155
  v_and_b32 v171, 0xffff0000, v155
  v_lshlrev_b32 v172, 16, v156
  v_and_b32 v173, 0xffff0000, v156
  v_lshlrev_b32 v174, 16, v157
  v_and_b32 v175, 0xffff0000, v157
  v_lshlrev_b32 v176, 16, v158
  v_and_b32 v177, 0xffff0000, v158
  v_lshlrev_b32 v178, 16, v159
  v_and_b32 v179, 0xffff0000, v159
  v_lshlrev_b32 v180, 16, v160
  v_and_b32 v181, 0xffff0000, v160
  v_lshlrev_b32 v182, 16, v161
  v_and_b32 v183, 0xffff0000, v161
  s_waitcnt lgkmcnt(0)
  s_cmp_eq_u32 s19, 0
  s_cbranch_scc1 L_r03
  v_pk_add_f32 v[112:113], v[132:133], v[164:165]
  v_pk_add_f32 v[114:115], v[134:135], v[166:167]
  v_pk_add_f32 v[116:117], v[136:137], v[168:169]
  v_pk_add_f32 v[118:119], v[138:139], v[170:171]
  v_pk_add_f32 v[120:121], v[140:141], v[172:173]
  v_pk_add_f32 v[122:123], v[142:143], v[174:175]
  v_pk_add_f32 v[124:125], v[144:145], v[176:177]
  v_pk_add_f32 v[126:127], v[146:147], v[178:179]
  v_pk_add_f32 v[128:129], v[148:149], v[180:181]
  v_pk_add_f32 v[130:131], v[150:151], v[182:183]
  s_branch L_rp3
L_r03:
  v_pk_add_f32 v[112:113], v[112:113], v[164:165]
  v_pk_add_f32 v[114:115], v[114:115], v[166:167]
  v_pk_add_f32 v[116:117], v[116:117], v[168:169]
  v_pk_add_f32 v[118:119], v[118:119], v[170:171]
  v_pk_add_f32 v[120:121], v[120:121], v[172:173]
  v_pk_add_f32 v[122:123], v[122:123], v[174:175]
  v_pk_add_f32 v[124:125], v[124:125], v[176:177]
  v_pk_add_f32 v[126:127], v[126:127], v[178:179]
  v_pk_add_f32 v[128:129], v[128:129], v[180:181]
  v_pk_add_f32 v[130:131], v[130:131], v[182:183]
L_rp3:
  s_waitcnt lgkmcnt(0)
  s_barrier
  s_lshr_b32 s19, s18, 1
  s_cmp_lg_u32 s19, 0
  s_cbranch_scc1 L_rf3
  ds_read_b128 v[164:167], v224 offset:0
  ds_read_b128 v[168:171], v224 offset:1024
  ds_read_b128 v[172:175], v224 offset:2048
  ds_read_b128 v[176:179], v224 offset:3072
  ds_read_b128 v[180:183], v224 offset:4096
  ds_read_b128 v[184:187], v224 offset:5120
  ds_read_b128 v[188:191], v224 offset:6144
  ds_read_b128 v[192:195], v224 offset:7168
  ds_read_b128 v[196:199], v224 offset:8192
  ds_read_b128 v[200:203], v224 offset:9216
  ds_read_b128 v[204:207], v224 offset:10240
  ds_read_b128 v[208:211], v224 offset:11264
  ds_read_b128 v[212:215], v224 offset:12288
  ds_read_b128 v[216:219], v224 offset:13312
  ds_read_b128 v[220:223], v224 offset:14336
  s_waitcnt lgkmcnt(10)
  v_pk_add_f32 v[112:113], v[112:113], v[164:165]
  v_pk_add_f32 v[114:115], v[114:115], v[166:167]
  v_pk_add_f32 v[116:117], v[116:117], v[168:169]
  v_pk_add_f32 v[118:119], v[118:119], v[170:171]
  v_pk_add_f32 v[120:121], v[120:121], v[172:173]
  v_pk_add_f32 v[122:123], v[122:123], v[174:175]
  v_pk_add_f32 v[124:125], v[124:125], v[176:177]
  v_pk_add_f32 v[126:127], v[126:127], v[178:179]
  v_pk_add_f32 v[128:129], v[128:129], v[180:181]
  v_pk_add_f32 v[130:131], v[130:131], v[182:183]
  s_waitcnt lgkmcnt(5)
  v_pk_add_f32 v[112:113], v[112:113], v[184:185]
  v_pk_add_f32 v[114:115], v[114:115], v[186:187]
  v_pk_add_f32 v[116:117], v[116:117], v[188:189]
  v_pk_add_f32 v[118:119], v[118:119], v[190:191]
  v_pk_add_f32 v[120:121], v[120:121], v[192:193]
  v_pk_add_f32 v[122:123], v[122:123], v[194:195]
  v_pk_add_f32 v[124:125], v[124:125], v[196:197]
  v_pk_add_f32 v[126:127], v[126:127], v[198:199]
  v_pk_add_f32 v[128:129], v[128:129], v[200:201]
  v_pk_add_f32 v[130:131], v[130:131], v[202:203]
  s_waitcnt lgkmcnt(0)
  v_pk_add_f32 v[112:113], v[112:113], v[204:205]
  v_pk_add_f32 v[114:115], v[114:115], v[206:207]
  v_pk_add_f32 v[116:117], v[116:117], v[208:209]
  v_pk_add_f32 v[118:119], v[118:119], v[210:211]
  v_pk_add_f32 v[120:121], v[120:121], v[212:213]
  v_pk_add_f32 v[122:123], v[122:123], v[214:215]
  v_pk_add_f32 v[124:125], v[124:125], v[216:217]
  v_pk_add_f32 v[126:127], v[126:127], v[218:219]
  v_pk_add_f32 v[128:129], v[128:129], v[220:221]
  v_pk_add_f32 v[130:131], v[130:131], v[222:223]
  v_cvt_pk_bf16_f32 v164, v112, v113
  v_cvt_pk_bf16_f32 v165, v114, v115
  v_cvt_pk_bf16_f32 v166, v116, v117
  v_cvt_pk_bf16_f32 v167, v118, v119
  v_cvt_pk_bf16_f32 v168, v120, v121
  v_cvt_pk_bf16_f32 v169, v122, v123
  v_cvt_pk_bf16_f32 v170, v124, v125
  v_cvt_pk_bf16_f32 v171, v126, v127
  v_cvt_pk_bf16_f32 v172, v128, v129
  v_cvt_pk_bf16_f32 v173, v130, v131
  s_mul_i32 s19, s36, 5242880
  s_add_u32 s19, s19, 13079552
  s_add_u32 s19, s19, s53
  s_mul_i32 s20, s36, 5242880
  s_add_u32 s20, s20, 13079552
  s_add_u32 s20, s20, s54
  buffer_store_dwordx4 v[164:167], v2, s[4:7], s19 offen sc1
  buffer_store_dwordx4 v[168:171], v2, s[4:7], s19 offen offset:1024 sc1
  v_mov_b32 v174, v172
  v_mov_b32 v175, v173
  v_mov_b32 v6, v172
  v_mov_b32 v7, v173
  s_nop 0
  v_permlane16_swap_b32 v6, v174
  v_permlane16_swap_b32 v7, v175
  s_mov_b64 exec, s[34:35]
  buffer_store_dwordx4 v[172:175], v11, s[4:7], s20 offen sc1
  s_mov_b64 exec, -1
  s_and_b32 s19, s18, 1
  s_add_u32 s19, s19, s52
  s_lshl_b32 s59, s19, 10
  s_lshl_b32 s20, s39, 7
  s_add_u32 s59, s59, s20
  s_mul_i32 s19, s36, 262144
  s_add_u32 s19, s19, 40473600
  s_add_u32 s19, s19, s59
  v_mov_b32 v132, 0
  v_mov_b32 v133, 0
  v_dot2c_f32_bf16 v132, s23, v164
  v_dot2c_f32_bf16 v133, v164, v164
  v_dot2c_f32_bf16 v132, s23, v165
  v_dot2c_f32_bf16 v133, v165, v165
  v_dot2c_f32_bf16 v132, s23, v166
  v_dot2c_f32_bf16 v133, v166, v166
  v_dot2c_f32_bf16 v132, s23, v167
  v_dot2c_f32_bf16 v133, v167, v167
  v_dot2c_f32_bf16 v132, s23, v168
  v_dot2c_f32_bf16 v133, v168, v168
  v_dot2c_f32_bf16 v132, s23, v169
  v_dot2c_f32_bf16 v133, v169, v169
  v_dot2c_f32_bf16 v132, s23, v170
  v_dot2c_f32_bf16 v133, v170, v170
  v_dot2c_f32_bf16 v132, s23, v171
  v_dot2c_f32_bf16 v133, v171, v171
  v_dot2c_f32_bf16 v132, s23, v172
  v_dot2c_f32_bf16 v133, v172, v172
  v_dot2c_f32_bf16 v132, s23, v173
  v_dot2c_f32_bf16 v133, v173, v173
  s_nop 2
  v_permlane32_swap_b32 v132, v133
  v_add_f32 v132, v132, v133
  v_mov_b32 v134, v132
  s_nop 1
  v_permlane16_swap_b32 v132, v134
  v_add_f32 v132, v132, v134
  v_mov_b32 v133, v132
  s_nop 1
  v_permlane32_swap_b32 v132, v133
  s_mov_b64 exec, 0xffff
  buffer_store_dwordx2 v[132:133], v9, s[4:7], s19 offen sc1
  s_mov_b64 exec, -1
L_rf3:
  s_waitcnt vmcnt(16)
  v_mfma_f32_16x16x32_bf16 v[112:115], a[192:195], v[104:107], 0
  v_mfma_f32_16x16x32_bf16 v[132:135], a[192:195], v[108:111], 0
  s_mul_i32 s19, s36, 5242880
  s_add_u32 s19, s19, 11768832
  s_add_u32 s19, s19, s53
  s_mul_i32 s20, s36, 5242880
  s_add_u32 s20, s20, 11768832
  s_add_u32 s20, s20, s54
  buffer_load_dwordx4 v[152:155], v2, s[4:7], s19 offen sc1
  buffer_load_dwordx4 v[156:159], v2, s[4:7], s19 offen offset:1024 sc1
  buffer_load_dwordx2 v[160:161], v11, s[4:7], s20 offen sc1
  v_mfma_f32_16x16x32_bf16 v[116:119], a[196:199], v[104:107], 0
  v_mfma_f32_16x16x32_bf16 v[136:139], a[196:199], v[108:111], 0
  v_mfma_f32_16x16x32_bf16 v[120:123], a[200:203], v[104:107], 0
  v_mfma_f32_16x16x32_bf16 v[140:143], a[200:203], v[108:111], 0
  s_add_u32 s25, s49, 8192
  buffer_load_dwordx4 a[68:71], v2, s[4:7], s25 offen offset:0 sc1
  v_mfma_f32_16x16x32_bf16 v[124:127], a[204:207], v[104:107], 0
  v_mfma_f32_16x16x32_bf16 v[144:147], a[204:207], v[108:111], 0
  v_mfma_f32_16x16x32_bf16 v[128:131], a[208:211], v[104:107], 0
  buffer_load_dwordx4 a[72:75], v2, s[4:7], s25 offen offset:1024 sc1
  v_mfma_f32_16x16x32_bf16 v[148:151], a[208:211], v[108:111], 0
  s_waitcnt vmcnt(19)
  v_mfma_f32_16x16x32_bf16 v[112:115], a[212:215], v[48:51], v[112:115]
  v_mfma_f32_16x16x32_bf16 v[132:135], a[212:215], v[52:55], v[132:135]
  buffer_load_dwordx4 a[76:79], v2, s[4:7], s25 offen offset:2048 sc1
  v_mfma_f32_16x16x32_bf16 v[116:119], a[216:219], v[48:51], v[116:119]
  v_mfma_f32_16x16x32_bf16 v[136:139], a[216:219], v[52:55], v[136:139]
  v_mfma_f32_16x16x32_bf16 v[120:123], a[220:223], v[48:51], v[120:123]
  v_mfma_f32_16x16x32_bf16 v[140:143], a[220:223], v[52:55], v[140:143]
  buffer_load_dwordx4 a[80:83], v2, s[4:7], s25 offen offset:3072 sc1
  v_mfma_f32_16x16x32_bf16 v[124:127], a[224:227], v[48:51], v[124:127]
  v_mfma_f32_16x16x32_bf16 v[144:147], a[224:227], v[52:55], v[144:147]
  v_mfma_f32_16x16x32_bf16 v[128:131], a[228:231], v[48:51], v[128:131]
  s_add_u32 s25, s49, 12288
  buffer_load_dwordx4 a[84:87], v2, s[4:7], s25 offen offset:0 sc1
  v_mfma_f32_16x16x32_bf16 v[148:151], a[228:231], v[52:55], v[148:151]
  s_lshr_b32 s19, s18, 1
  s_cmp_lg_u32 s19, 0
  s_cbranch_scc1 L_rs3
  s_waitcnt vmcnt(8)
  s_mul_i32 s19, s36, 65536
  s_add_u32 s19, s19, 16384
  s_add_u32 s19, s19, s56
  s_and_b32 s20, s18, 1
  s_lshl_b32 s59, s39, 1
  s_add_u32 s59, s59, s20
  s_lshl_b32 s59, s59, 3
  s_add_u32 s19, s19, s59
  v_mov_b32 v20, s14
  v_mov_b32 v21, s15
  s_mov_b64 exec, 1
  buffer_store_dwordx2 v[20:21], v5, s[4:7], s19 offen sc1
  s_mov_b64 exec, -1
L_rs3:
  s_waitcnt vmcnt(20)
  v_mfma_f32_16x16x32_bf16 v[112:115], a[232:235], v[56:59], v[112:115]
  v_mfma_f32_16x16x32_bf16 v[132:135], a[232:235], v[60:63], v[132:135]
  buffer_load_dwordx4 a[88:91], v2, s[4:7], s25 offen offset:1024 sc1
  v_mfma_f32_16x16x32_bf16 v[116:119], a[236:239], v[56:59], v[116:119]
  v_mfma_f32_16x16x32_bf16 v[136:139], a[236:239], v[60:63], v[136:139]
  v_mfma_f32_16x16x32_bf16 v[120:123], a[240:243], v[56:59], v[120:123]
  v_mfma_f32_16x16x32_bf16 v[140:143], a[240:243], v[60:63], v[140:143]
  buffer_load_dwordx4 a[92:95], v2, s[4:7], s25 offen offset:2048 sc1
  v_mfma_f32_16x16x32_bf16 v[124:127], a[244:247], v[56:59], v[124:127]
  v_mfma_f32_16x16x32_bf16 v[144:147], a[244:247], v[60:63], v[144:147]
  v_mfma_f32_16x16x32_bf16 v[128:131], a[248:251], v[56:59], v[128:131]
  buffer_load_dwordx4 a[96:99], v2, s[4:7], s25 offen offset:3072 sc1
  v_mfma_f32_16x16x32_bf16 v[148:151], a[248:251], v[60:63], v[148:151]
  s_waitcnt vmcnt(21)
  v_mfma_f32_16x16x32_bf16 v[112:115], a[252:255], v[64:67], v[112:115]
  v_mfma_f32_16x16x32_bf16 v[132:135], a[252:255], v[68:71], v[132:135]
  v_mfma_f32_16x16x32_bf16 v[116:119], a[0:3], v[64:67], v[116:119]
  v_mfma_f32_16x16x32_bf16 v[136:139], a[0:3], v[68:71], v[136:139]
  v_mfma_f32_16x16x32_bf16 v[120:123], a[4:7], v[64:67], v[120:123]
  v_mfma_f32_16x16x32_bf16 v[140:143], a[4:7], v[68:71], v[140:143]
  v_mfma_f32_16x16x32_bf16 v[124:127], a[8:11], v[64:67], v[124:127]
  v_mfma_f32_16x16x32_bf16 v[144:147], a[8:11], v[68:71], v[144:147]
  v_mfma_f32_16x16x32_bf16 v[128:131], a[12:15], v[64:67], v[128:131]
  v_mfma_f32_16x16x32_bf16 v[148:151], a[12:15], v[68:71], v[148:151]
  s_waitcnt vmcnt(17)
  v_mfma_f32_16x16x32_bf16 v[112:115], a[16:19], v[72:75], v[112:115]
  v_mfma_f32_16x16x32_bf16 v[132:135], a[16:19], v[76:79], v[132:135]
  s_add_u32 s25, s49, 16384
  buffer_load_dwordx4 a[100:103], v2, s[4:7], s25 offen offset:0 sc1
  v_mfma_f32_16x16x32_bf16 v[116:119], a[20:23], v[72:75], v[116:119]
  v_mfma_f32_16x16x32_bf16 v[136:139], a[20:23], v[76:79], v[136:139]
  v_mfma_f32_16x16x32_bf16 v[120:123], a[24:27], v[72:75], v[120:123]
  v_mfma_f32_16x16x32_bf16 v[140:143], a[24:27], v[76:79], v[140:143]
  buffer_load_dwordx4 a[104:107], v2, s[4:7], s25 offen offset:1024 sc1
  v_mfma_f32_16x16x32_bf16 v[124:127], a[28:31], v[72:75], v[124:127]
  v_mfma_f32_16x16x32_bf16 v[144:147], a[28:31], v[76:79], v[144:147]
  v_mfma_f32_16x16x32_bf16 v[128:131], a[32:35], v[72:75], v[128:131]
  buffer_load_dwordx4 a[108:111], v2, s[4:7], s25 offen offset:2048 sc1
  v_mfma_f32_16x16x32_bf16 v[148:151], a[32:35], v[76:79], v[148:151]
  buffer_load_dwordx4 a[112:115], v2, s[4:7], s25 offen offset:3072 sc1
  s_add_u32 s25, s49, 20480
  buffer_load_dwordx4 a[116:119], v2, s[4:7], s25 offen offset:0 sc1
  buffer_load_dwordx4 a[120:123], v2, s[4:7], s25 offen offset:1024 sc1
  buffer_load_dwordx4 a[124:127], v2, s[4:7], s25 offen offset:2048 sc1
  s_cmp_gt_u32 s18, 2
  s_cselect_b32 s19, 1, 0
  s_sub_u32 s19, s18, s19
  s_mul_i32 s19, s19, 5120
  s_add_u32 s19, s19, 133120
  v_add_u32 v224, s19, v2
  s_cmp_gt_u32 s18, 3
  s_cselect_b32 s19, 1, 0
  s_sub_u32 s19, s18, s19
  s_mul_i32 s19, s19, 5120
  s_add_u32 s19, s19, 148480
  v_add_u32 v225, s19, v2
  s_barrier
  s_cmp_eq_u32 s18, 2
  s_cbranch_scc1 L_rw4_0
  ds_write_b128 v224, v[112:115] offset:0
  ds_write_b128 v224, v[116:119] offset:1024
  ds_write_b128 v224, v[120:123] offset:2048
  ds_write_b128 v224, v[124:127] offset:3072
  ds_write_b128 v224, v[128:131] offset:4096
L_rw4_0:
  s_cmp_eq_u32 s18, 3
  s_cbranch_scc1 L_rw4_1
  ds_write_b128 v225, v[132:135] offset:0
  ds_write_b128 v225, v[136:139] offset:1024
  ds_write_b128 v225, v[140:143] offset:2048
  ds_write_b128 v225, v[144:147] offset:3072
  ds_write_b128 v225, v[148:151] offset:4096
L_rw4_1:
  s_waitcnt vmcnt(15)
  s_lshr_b32 s19, s18, 1
  s_cmp_lg_u32 s19, 1
  s_cbranch_scc1 L_rp4
  s_and_b32 s19, s18, 1
  s_mul_i32 s20, s19, 15360
  s_add_u32 s20, s20, 133120
  v_add_u32 v224, s20, v2
  v_lshlrev_b32 v164, 16, v152
  v_and_b32 v165, 0xffff0000, v152
  v_lshlrev_b32 v166, 16, v153
  v_and_b32 v167, 0xffff0000, v153
  v_lshlrev_b32 v168, 16, v154
  v_and_b32 v169, 0xffff0000, v154
  v_lshlrev_b32 v170, 16, v155
  v_and_b32 v171, 0xffff0000, v155
  v_lshlrev_b32 v172, 16, v156
  v_and_b32 v173, 0xffff0000, v156
  v_lshlrev_b32 v174, 16, v157
  v_and_b32 v175, 0xffff0000, v157
  v_lshlrev_b32 v176, 16, v158
  v_and_b32 v177, 0xffff0000, v158
  v_lshlrev_b32 v178, 16, v159
  v_and_b32 v179, 0xffff0000, v159
  v_lshlrev_b32 v180, 16, v160
  v_and_b32 v181, 0xffff0000, v160
  v_lshlrev_b32 v182, 16, v161
  v_and_b32 v183, 0xffff0000, v161
  s_waitcnt lgkmcnt(0)
  s_cmp_eq_u32 s19, 0
  s_cbranch_scc1 L_r04
  v_pk_add_f32 v[112:113], v[132:133], v[164:165]
  v_pk_add_f32 v[114:115], v[134:135], v[166:167]
  v_pk_add_f32 v[116:117], v[136:137], v[168:169]
  v_pk_add_f32 v[118:119], v[138:139], v[170:171]
  v_pk_add_f32 v[120:121], v[140:141], v[172:173]
  v_pk_add_f32 v[122:123], v[142:143], v[174:175]
  v_pk_add_f32 v[124:125], v[144:145], v[176:177]
  v_pk_add_f32 v[126:127], v[146:147], v[178:179]
  v_pk_add_f32 v[128:129], v[148:149], v[180:181]
  v_pk_add_f32 v[130:131], v[150:151], v[182:183]
  s_branch L_rp4
L_r04:
  v_pk_add_f32 v[112:113], v[112:113], v[164:165]
  v_pk_add_f32 v[114:115], v[114:115], v[166:167]
  v_pk_add_f32 v[116:117], v[116:117], v[168:169]
  v_pk_add_f32 v[118:119], v[118:119], v[170:171]
  v_pk_add_f32 v[120:121], v[120:121], v[172:173]
  v_pk_add_f32 v[122:123], v[122:123], v[174:175]
  v_pk_add_f32 v[124:125], v[124:125], v[176:177]
  v_pk_add_f32 v[126:127], v[126:127], v[178:179]
  v_pk_add_f32 v[128:129], v[128:129], v[180:181]
  v_pk_add_f32 v[130:131], v[130:131], v[182:183]
L_rp4:
  s_waitcnt lgkmcnt(0)
  s_barrier
  s_lshr_b32 s19, s18, 1
  s_cmp_lg_u32 s19, 1
  s_cbranch_scc1 L_rf4
  ds_read_b128 v[164:167], v224 offset:0
  ds_read_b128 v[168:171], v224 offset:1024
  ds_read_b128 v[172:175], v224 offset:2048
  ds_read_b128 v[176:179], v224 offset:3072
  ds_read_b128 v[180:183], v224 offset:4096
  ds_read_b128 v[184:187], v224 offset:5120
  ds_read_b128 v[188:191], v224 offset:6144
  ds_read_b128 v[192:195], v224 offset:7168
  ds_read_b128 v[196:199], v224 offset:8192
  ds_read_b128 v[200:203], v224 offset:9216
  ds_read_b128 v[204:207], v224 offset:10240
  ds_read_b128 v[208:211], v224 offset:11264
  ds_read_b128 v[212:215], v224 offset:12288
  ds_read_b128 v[216:219], v224 offset:13312
  ds_read_b128 v[220:223], v224 offset:14336
  s_waitcnt lgkmcnt(10)
  v_pk_add_f32 v[112:113], v[112:113], v[164:165]
  v_pk_add_f32 v[114:115], v[114:115], v[166:167]
  v_pk_add_f32 v[116:117], v[116:117], v[168:169]
  v_pk_add_f32 v[118:119], v[118:119], v[170:171]
  v_pk_add_f32 v[120:121], v[120:121], v[172:173]
  v_pk_add_f32 v[122:123], v[122:123], v[174:175]
  v_pk_add_f32 v[124:125], v[124:125], v[176:177]
  v_pk_add_f32 v[126:127], v[126:127], v[178:179]
  v_pk_add_f32 v[128:129], v[128:129], v[180:181]
  v_pk_add_f32 v[130:131], v[130:131], v[182:183]
  s_waitcnt lgkmcnt(5)
  v_pk_add_f32 v[112:113], v[112:113], v[184:185]
  v_pk_add_f32 v[114:115], v[114:115], v[186:187]
  v_pk_add_f32 v[116:117], v[116:117], v[188:189]
  v_pk_add_f32 v[118:119], v[118:119], v[190:191]
  v_pk_add_f32 v[120:121], v[120:121], v[192:193]
  v_pk_add_f32 v[122:123], v[122:123], v[194:195]
  v_pk_add_f32 v[124:125], v[124:125], v[196:197]
  v_pk_add_f32 v[126:127], v[126:127], v[198:199]
  v_pk_add_f32 v[128:129], v[128:129], v[200:201]
  v_pk_add_f32 v[130:131], v[130:131], v[202:203]
  s_waitcnt lgkmcnt(0)
  v_pk_add_f32 v[112:113], v[112:113], v[204:205]
  v_pk_add_f32 v[114:115], v[114:115], v[206:207]
  v_pk_add_f32 v[116:117], v[116:117], v[208:209]
  v_pk_add_f32 v[118:119], v[118:119], v[210:211]
  v_pk_add_f32 v[120:121], v[120:121], v[212:213]
  v_pk_add_f32 v[122:123], v[122:123], v[214:215]
  v_pk_add_f32 v[124:125], v[124:125], v[216:217]
  v_pk_add_f32 v[126:127], v[126:127], v[218:219]
  v_pk_add_f32 v[128:129], v[128:129], v[220:221]
  v_pk_add_f32 v[130:131], v[130:131], v[222:223]
  v_cvt_pk_bf16_f32 v164, v112, v113
  v_cvt_pk_bf16_f32 v165, v114, v115
  v_cvt_pk_bf16_f32 v166, v116, v117
  v_cvt_pk_bf16_f32 v167, v118, v119
  v_cvt_pk_bf16_f32 v168, v120, v121
  v_cvt_pk_bf16_f32 v169, v122, v123
  v_cvt_pk_bf16_f32 v170, v124, v125
  v_cvt_pk_bf16_f32 v171, v126, v127
  v_cvt_pk_bf16_f32 v172, v128, v129
  v_cvt_pk_bf16_f32 v173, v130, v131
  s_mul_i32 s19, s36, 5242880
  s_add_u32 s19, s19, 14390272
  s_add_u32 s19, s19, s53
  s_mul_i32 s20, s36, 5242880
  s_add_u32 s20, s20, 14390272
  s_add_u32 s20, s20, s54
  buffer_store_dwordx4 v[164:167], v2, s[4:7], s19 offen sc1
  buffer_store_dwordx4 v[168:171], v2, s[4:7], s19 offen offset:1024 sc1
  v_mov_b32 v174, v172
  v_mov_b32 v175, v173
  v_mov_b32 v6, v172
  v_mov_b32 v7, v173
  s_nop 0
  v_permlane16_swap_b32 v6, v174
  v_permlane16_swap_b32 v7, v175
  s_mov_b64 exec, s[34:35]
  buffer_store_dwordx4 v[172:175], v11, s[4:7], s20 offen sc1
  s_mov_b64 exec, -1
  s_and_b32 s19, s18, 1
  s_add_u32 s19, s19, s52
  s_lshl_b32 s59, s19, 10
  s_lshl_b32 s20, s39, 7
  s_add_u32 s59, s59, s20
  s_mul_i32 s19, s36, 262144
  s_add_u32 s19, s19, 40539136
  s_add_u32 s19, s19, s59
  v_mov_b32 v132, 0
  v_mov_b32 v133, 0
  v_dot2c_f32_bf16 v132, s23, v164
  v_dot2c_f32_bf16 v133, v164, v164
  v_dot2c_f32_bf16 v132, s23, v165
  v_dot2c_f32_bf16 v133, v165, v165
  v_dot2c_f32_bf16 v132, s23, v166
  v_dot2c_f32_bf16 v133, v166, v166
  v_dot2c_f32_bf16 v132, s23, v167
  v_dot2c_f32_bf16 v133, v167, v167
  v_dot2c_f32_bf16 v132, s23, v168
  v_dot2c_f32_bf16 v133, v168, v168
  v_dot2c_f32_bf16 v132, s23, v169
  v_dot2c_f32_bf16 v133, v169, v169
  v_dot2c_f32_bf16 v132, s23, v170
  v_dot2c_f32_bf16 v133, v170, v170
  v_dot2c_f32_bf16 v132, s23, v171
  v_dot2c_f32_bf16 v133, v171, v171
  v_dot2c_f32_bf16 v132, s23, v172
  v_dot2c_f32_bf16 v133, v172, v172
  v_dot2c_f32_bf16 v132, s23, v173
  v_dot2c_f32_bf16 v133, v173, v173
  s_nop 2
  v_permlane32_swap_b32 v132, v133
  v_add_f32 v132, v132, v133
  v_mov_b32 v134, v132
  s_nop 1
  v_permlane16_swap_b32 v132, v134
  v_add_f32 v132, v132, v134
  v_mov_b32 v133, v132
  s_nop 1
  v_permlane32_swap_b32 v132, v133
  s_mov_b64 exec, 0xffff
  buffer_store_dwordx2 v[132:133], v9, s[4:7], s19 offen sc1
  s_mov_b64 exec, -1
L_rf4:
  buffer_load_dwordx4 a[128:131], v2, s[4:7], s25 offen offset:3072 sc1
  s_add_u32 s25, s49, 24576
  buffer_load_dwordx4 a[132:135], v2, s[4:7], s25 offen offset:0 sc1
  buffer_load_dwordx4 a[136:139], v2, s[4:7], s25 offen offset:1024 sc1
  buffer_load_dwordx4 a[140:143], v2, s[4:7], s25 offen offset:2048 sc1
  buffer_load_dwordx4 a[144:147], v2, s[4:7], s25 offen offset:3072 sc1
  s_add_u32 s25, s49, 28672
  buffer_load_dwordx4 a[148:151], v2, s[4:7], s25 offen offset:0 sc1
  buffer_load_dwordx4 a[152:155], v2, s[4:7], s25 offen offset:1024 sc1
  buffer_load_dwordx4 a[156:159], v2, s[4:7], s25 offen offset:2048 sc1
  buffer_load_dwordx4 a[160:163], v2, s[4:7], s25 offen offset:3072 sc1
  s_add_u32 s25, s49, 32768
  buffer_load_dwordx4 a[164:167], v2, s[4:7], s25 offen offset:0 sc1
  s_cmp_lg_u32 s18, 0
  s_cbranch_scc1 L_ok5
  s_mul_i32 s19, s36, 65536
  s_add_u32 s19, s19, 16384
  s_add_u32 s19, s19, s55
  s_mov_b32 s24, 0
  s_mov_b32 exec_hi, -1
L_ct5:
  buffer_load_dwordx2 v[22:23], v10, s[4:7], s19 offen sc1
  s_add_u32 s24, s24, 1
  s_waitcnt vmcnt(0)
  v_cmp_ne_u64 vcc, s[14:15], v[22:23]
  s_nop 0
  s_cmp_eq_u64 vcc, 0
  s_cbranch_scc1 L_pd5
  s_sleep 1
  s_cmp_lt_u32 s24, 100000
  s_cbranch_scc1 L_ct5
L_pd5:
  s_mov_b64 exec, -1
L_ok5:
  s_barrier
  s_mul_i32 s59, s51, 20480
  s_mul_i32 s57, s36, 5242880
  s_add_u32 s57, s57, 13079552
  s_add_u32 s57, s57, s59
  s_mul_i32 s59, s51, 20480
  s_mul_i32 s58, s36, 5242880
  s_add_u32 s58, s58, 14390272
  s_add_u32 s58, s58, s59
  s_lshl_b32 s59, s51, 10
  s_mul_i32 s19, s36, 262144
  s_add_u32 s19, s19, 40473600
  s_add_u32 s19, s19, s59
  buffer_load_dwordx2 v[40:41], v10, s[4:7], s19 offen offset:0 sc1
  buffer_load_dwordx2 v[42:43], v10, s[4:7], s19 offen offset:128 sc1
  buffer_load_dwordx2 v[44:45], v10, s[4:7], s19 offen offset:1024 sc1
  buffer_load_dwordx2 v[46:47], v10, s[4:7], s19 offen offset:1152 sc1
  s_add_u32 s22, s57, 0
  buffer_load_dwordx4 v[80:83], v2, s[4:7], s22 offen offset:0 sc1
  buffer_load_dwordx4 v[84:87], v14, s[4:7], s22 offen offset:0 sc1
  buffer_load_dwordx4 v[88:91], v2, s[4:7], s22 offen offset:1024 sc1
  buffer_load_dwordx4 v[92:95], v14, s[4:7], s22 offen offset:1024 sc1
  buffer_load_dwordx4 v[96:99], v2, s[4:7], s22 offen offset:2048 sc1
  buffer_load_dwordx4 v[100:103], v14, s[4:7], s22 offen offset:2048 sc1
  buffer_load_dwordx4 v[104:107], v2, s[4:7], s22 offen offset:3072 sc1
  buffer_load_dwordx4 v[108:111], v14, s[4:7], s22 offen offset:3072 sc1
  ds_read_b128 v[168:171], v12 offset:20480
  ds_read_b128 v[172:175], v12 offset:21504
  ds_read_b128 v[176:179], v12 offset:22528
  ds_read_b128 v[180:183], v12 offset:23552
  ds_read_b128 v[184:187], v12 offset:24576
  ds_read_b128 v[188:191], v12 offset:25600
  ds_read_b128 v[192:195], v12 offset:26624
  ds_read_b128 v[196:199], v12 offset:27648
  ds_read_b128 v[200:203], v12 offset:28672
  ds_read_b128 v[204:207], v12 offset:29696
  ds_read_b128 v[208:211], v12 offset:30720
  ds_read_b128 v[212:215], v12 offset:31744
  s_waitcnt vmcnt(6)
  s_waitcnt lgkmcnt(9)
  v_mfma_f32_16x16x32_bf16 v[112:115], v[168:171], v[80:83], 0
  v_mfma_f32_16x16x32_bf16 v[116:119], v[168:171], v[84:87], 0
  ds_read_b128 v[168:171], v12 offset:32768
  v_mfma_f32_16x16x32_bf16 v[120:123], v[172:175], v[80:83], 0
  s_add_u32 s22, s57, 4096
  buffer_load_dwordx4 v[48:51], v2, s[4:7], s22 offen offset:0 sc1
  v_mfma_f32_16x16x32_bf16 v[124:127], v[172:175], v[84:87], 0
  ds_read_b128 v[172:175], v12 offset:33792
  v_mfma_f32_16x16x32_bf16 v[128:131], v[176:179], v[80:83], 0
  v_mfma_f32_16x16x32_bf16 v[132:135], v[176:179], v[84:87], 0
  ds_read_b128 v[176:179], v12 offset:34816
  s_waitcnt lgkmcnt(9)
  v_mfma_f32_16x16x32_bf16 v[136:139], v[180:183], v[80:83], 0
  v_mfma_f32_16x16x32_bf16 v[140:143], v[180:183], v[84:87], 0
  ds_read_b128 v[180:183], v12 offset:35840
  buffer_load_dwordx4 v[52:55], v14, s[4:7], s22 offen offset:0 sc1
  v_mfma_f32_16x16x32_bf16 v[144:147], v[184:187], v[80:83], 0
  v_mfma_f32_16x16x32_bf16 v[148:151], v[184:187], v[84:87], 0
  ds_read_b128 v[184:187], v12 offset:36864
  v_mfma_f32_16x16x32_bf16 v[152:155], v[188:191], v[80:83], 0
  v_mfma_f32_16x16x32_bf16 v[156:159], v[188:191], v[84:87], 0
  ds_read_b128 v[188:191], v12 offset:37888
  buffer_load_dwordx4 v[56:59], v2, s[4:7], s22 offen offset:1024 sc1
  s_waitcnt lgkmcnt(9)
  v_mfma_f32_16x16x32_bf16 v[160:163], v[192:195], v[80:83], 0
  v_mfma_f32_16x16x32_bf16 v[164:167], v[192:195], v[84:87], 0
  ds_read_b128 v[192:195], v12 offset:38912
  s_waitcnt vmcnt(7)
  s_lshr_b32 s19, s18, 1
  s_cmp_lg_u32 s19, 1
  s_cbranch_scc1 L_rs4
  s_waitcnt vmcnt(25)
  s_mul_i32 s19, s36, 65536
  s_add_u32 s19, s19, 24576
  s_add_u32 s19, s19, s56
  s_and_b32 s20, s18, 1
  s_lshl_b32 s59, s39, 1
  s_add_u32 s59, s59, s20
  s_lshl_b32 s59, s59, 3
  s_add_u32 s19, s19, s59
  v_mov_b32 v20, s14
  v_mov_b32 v21, s15
  s_mov_b64 exec, 1
  buffer_store_dwordx2 v[20:21], v5, s[4:7], s19 offen sc1
  s_mov_b64 exec, -1
L_rs4:
  v_mfma_f32_16x16x32_bf16 v[112:115], v[196:199], v[88:91], v[112:115]
  v_mfma_f32_16x16x32_bf16 v[116:119], v[196:199], v[92:95], v[116:119]
  ds_read_b128 v[196:199], v12 offset:39936
  v_mfma_f32_16x16x32_bf16 v[120:123], v[200:203], v[88:91], v[120:123]
  buffer_load_dwordx4 v[60:63], v14, s[4:7], s22 offen offset:1024 sc1
  v_mfma_f32_16x16x32_bf16 v[124:127], v[200:203], v[92:95], v[124:127]
  ds_read_b128 v[200:203], v12 offset:40960
  s_waitcnt lgkmcnt(9)
  v_mfma_f32_16x16x32_bf16 v[128:131], v[204:207], v[88:91], v[128:131]
  v_mfma_f32_16x16x32_bf16 v[132:135], v[204:207], v[92:95], v[132:135]
  ds_read_b128 v[204:207], v12 offset:41984
  v_mfma_f32_16x16x32_bf16 v[136:139], v[208:211], v[88:91], v[136:139]
  v_mfma_f32_16x16x32_bf16 v[140:143], v[208:211], v[92:95], v[140:143]
  ds_read_b128 v[208:211], v12 offset:43008
  buffer_load_dwordx4 v[64:67], v2, s[4:7], s22 offen offset:2048 sc1
  v_mfma_f32_16x16x32_bf16 v[144:147], v[212:215], v[88:91], v[144:147]
  v_mfma_f32_16x16x32_bf16 v[148:151], v[212:215], v[92:95], v[148:151]
  ds_read_b128 v[212:215], v12 offset:44032
  s_waitcnt lgkmcnt(9)
  v_mfma_f32_16x16x32_bf16 v[152:155], v[168:171], v[88:91], v[152:155]
  v_mfma_f32_16x16x32_bf16 v[156:159], v[168:171], v[92:95], v[156:159]
  ds_read_b128 v[168:171], v12 offset:45056
  buffer_load_dwordx4 v[68:71], v14, s[4:7], s22 offen offset:2048 sc1
  v_mfma_f32_16x16x32_bf16 v[160:163], v[172:175], v[88:91], v[160:163]
  v_mfma_f32_16x16x32_bf16 v[164:167], v[172:175], v[92:95], v[164:167]
  ds_read_b128 v[172:175], v12 offset:46080
  s_waitcnt vmcnt(8)
  s_waitcnt vmcnt(14)
  v_mfma_f32_16x16x32_bf16 v[112:115], v[176:179], v[96:99], v[112:115]
  v_add_f32 v40, v40, v42
  v_mfma_f32_16x16x32_bf16 v[116:119], v[176:179], v[100:103], v[116:119]
  ds_read_b128 v[176:179], v12 offset:47104
  v_add_f32 v41, v41, v43
  s_waitcnt lgkmcnt(9)
  v_mfma_f32_16x16x32_bf16 v[120:123], v[180:183], v[96:99], v[120:123]
  buffer_load_dwordx4 v[72:75], v2, s[4:7], s22 offen offset:3072 sc1
  v_mfma_f32_16x16x32_bf16 v[124:127], v[180:183], v[100:103], v[124:127]
  ds_read_b128 v[180:183], v12 offset:48128
  v_mov_b32 v6, v40
  v_mfma_f32_16x16x32_bf16 v[128:131], v[184:187], v[96:99], v[128:131]
  v_mfma_f32_16x16x32_bf16 v[132:135], v[184:187], v[100:103], v[132:135]
  s_barrier
  ds_read_b128 v[184:187], v2 offset:0
  v_permlane32_swap_b32 v40, v6
  v_mfma_f32_16x16x32_bf16 v[136:139], v[188:191], v[96:99], v[136:139]
  v_mfma_f32_16x16x32_bf16 v[140:143], v[188:191], v[100:103], v[140:143]
  ds_read_b128 v[188:191], v2 offset:1024
  buffer_load_dwordx4 v[76:79], v14, s[4:7], s22 offen offset:3072 sc1
  v_add_f32 v40, v40, v6
  s_waitcnt lgkmcnt(9)
  v_mfma_f32_16x16x32_bf16 v[144:147], v[192:195], v[96:99], v[144:147]
  v_mov_b32 v6, v40
  v_mfma_f32_16x16x32_bf16 v[148:151], v[192:195], v[100:103], v[148:151]
  ds_read_b128 v[192:195], v2 offset:2048
  v_mfma_f32_16x16x32_bf16 v[152:155], v[196:199], v[96:99], v[152:155]
  v_permlane16_swap_b32 v40, v6
  v_mfma_f32_16x16x32_bf16 v[156:159], v[196:199], v[100:103], v[156:159]
  ds_read_b128 v[196:199], v2 offset:3072
  s_add_u32 s22, s57, 8192
  buffer_load_dwordx4 v[80:83], v2, s[4:7], s22 offen offset:0 sc1
  v_mfma_f32_16x16x32_bf16 v[160:163], v[200:203], v[96:99], v[160:163]
  v_add_f32 v40, v40, v6
  v_mfma_f32_16x16x32_bf16 v[164:167], v[200:203], v[100:103], v[164:167]
  ds_read_b128 v[200:203], v2 offset:4096
  s_waitcnt vmcnt(9)
  s_waitcnt lgkmcnt(9)
  v_mfma_f32_16x16x32_bf16 v[112:115], v[204:207], v[104:107], v[112:115]
  v_mov_b32 v6, v41
  v_mfma_f32_16x16x32_bf16 v[116:119], v[204:207], v[108:111], v[116:119]
  ds_read_b128 v[204:207], v2 offset:5120
  v_permlane32_swap_b32 v41, v6
  v_mfma_f32_16x16x32_bf16 v[120:123], v[208:211], v[104:107], v[120:123]
  buffer_load_dwordx4 v[84:87], v14, s[4:7], s22 offen offset:0 sc1
  v_mfma_f32_16x16x32_bf16 v[124:127], v[208:211], v[108:111], v[124:127]
  ds_read_b128 v[208:211], v2 offset:6144
  v_add_f32 v41, v41, v6
  v_mfma_f32_16x16x32_bf16 v[128:131], v[212:215], v[104:107], v[128:131]
  v_mov_b32 v6, v41
  v_mfma_f32_16x16x32_bf16 v[132:135], v[212:215], v[108:111], v[132:135]
  ds_read_b128 v[212:215], v2 offset:7168
  s_waitcnt lgkmcnt(9)
  v_mfma_f32_16x16x32_bf16 v[136:139], v[168:171], v[104:107], v[136:139]
  v_permlane16_swap_b32 v41, v6
  v_mfma_f32_16x16x32_bf16 v[140:143], v[168:171], v[108:111], v[140:143]
  ds_read_b128 v[168:171], v2 offset:8192
  buffer_load_dwordx4 v[88:91], v2, s[4:7], s22 offen offset:1024 sc1
  v_add_f32 v41, v41, v6
  v_mfma_f32_16x16x32_bf16 v[144:147], v[172:175], v[104:107], v[144:147]
  v_mfma_f32_16x16x32_bf16 v[148:151], v[172:175], v[108:111], v[148:151]
  ds_read_b128 v[172:175], v2 offset:9216
  v_mul_f32 v40, 0xbacccccd, v40
  v_mfma_f32_16x16x32_bf16 v[152:155], v[176:179], v[104:107], v[152:155]
  v_mul_f32 v41, 0x3acccccd, v41
  v_mfma_f32_16x16x32_bf16 v[156:159], v[176:179], v[108:111], v[156:159]
  ds_read_b128 v[176:179], v2 offset:10240
  buffer_load_dwordx4 v[92:95], v14, s[4:7], s22 offen offset:1024 sc1
  s_waitcnt lgkmcnt(9)
  v_mfma_f32_16x16x32_bf16 v[160:163], v[180:183], v[104:107], v[160:163]
  v_fma_f32 v41, -v40, v40, v41
  v_mfma_f32_16x16x32_bf16 v[164:167], v[180:183], v[108:111], v[164:167]
  ds_read_b128 v[180:183], v2 offset:11264
  s_waitcnt vmcnt(10)
  v_mfma_f32_16x16x32_bf16 v[112:115], v[184:187], v[48:51], v[112:115]
  v_max_f32 v41, 0, v41
  v_mfma_f32_16x16x32_bf16 v[116:119], v[184:187], v[52:55], v[116:119]
  ds_read_b128 v[184:187], v2 offset:12288
  v_add_f32 v41, 0x3727c5ac, v41
  v_mfma_f32_16x16x32_bf16 v[120:123], v[188:191], v[48:51], v[120:123]
  buffer_load_dwordx4 v[96:99], v2, s[4:7], s22 offen offset:2048 sc1
  v_mfma_f32_16x16x32_bf16 v[124:127], v[188:191], v[52:55], v[124:127]
  ds_read_b128 v[188:191], v2 offset:13312
  v_rsq_f32 v216, v41
  s_waitcnt lgkmcnt(9)
  v_mfma_f32_16x16x32_bf16 v[128:131], v[192:195], v[48:51], v[128:131]
  v_cvt_pk_bf16_f32 v220, v40, v40
  v_mfma_f32_16x16x32_bf16 v[132:135], v[192:195], v[52:55], v[132:135]
  ds_read_b128 v[192:195], v2 offset:14336
  v_mfma_f32_16x16x32_bf16 v[136:139], v[196:199], v[48:51], v[136:139]
  v_lshlrev_b32 v6, 16, v220
  v_mfma_f32_16x16x32_bf16 v[140:143], v[196:199], v[52:55], v[140:143]
  ds_read_b128 v[196:199], v2 offset:15360
  buffer_load_dwordx4 v[100:103], v14, s[4:7], s22 offen offset:2048 sc1
  v_sub_f32 v6, v40, v6
  v_mfma_f32_16x16x32_bf16 v[144:147], v[200:203], v[48:51], v[144:147]
  v_mfma_f32_16x16x32_bf16 v[148:151], v[200:203], v[52:55], v[148:151]
  ds_read_b128 v[200:203], v2 offset:16384
  v_cvt_pk_bf16_f32 v221, v6, v6
  s_waitcnt lgkmcnt(9)
  v_mfma_f32_16x16x32_bf16 v[152:155], v[204:207], v[48:51], v[152:155]
  v_mov_b32 v222, 0
  v_mfma_f32_16x16x32_bf16 v[156:159], v[204:207], v[52:55], v[156:159]
  ds_read_b128 v[204:207], v2 offset:17408
  buffer_load_dwordx4 v[104:107], v2, s[4:7], s22 offen offset:3072 sc1
  v_mfma_f32_16x16x32_bf16 v[160:163], v[208:211], v[48:51], v[160:163]
  v_mov_b32 v223, 0
  v_mfma_f32_16x16x32_bf16 v[164:167], v[208:211], v[52:55], v[164:167]
  ds_read_b128 v[208:211], v2 offset:18432
  s_waitcnt vmcnt(11)
  v_mfma_f32_16x16x32_bf16 v[112:115], v[212:215], v[56:59], v[112:115]
  v_add_f32 v44, v44, v46
  v_mfma_f32_16x16x32_bf16 v[116:119], v[212:215], v[60:63], v[116:119]
  ds_read_b128 v[212:215], v2 offset:19456
  v_add_f32 v45, v45, v47
  s_waitcnt lgkmcnt(9)
  v_mfma_f32_16x16x32_bf16 v[120:123], v[168:171], v[56:59], v[120:123]
  buffer_load_dwordx4 v[108:111], v14, s[4:7], s22 offen offset:3072 sc1
  v_mfma_f32_16x16x32_bf16 v[124:127], v[168:171], v[60:63], v[124:127]
  ds_read_b128 v[168:171], v2 offset:20480
  v_mov_b32 v6, v44
  v_mfma_f32_16x16x32_bf16 v[128:131], v[172:175], v[56:59], v[128:131]
  v_mfma_f32_16x16x32_bf16 v[132:135], v[172:175], v[60:63], v[132:135]
  ds_read_b128 v[172:175], v2 offset:21504
  v_permlane32_swap_b32 v44, v6
  v_mfma_f32_16x16x32_bf16 v[136:139], v[176:179], v[56:59], v[136:139]
  v_mfma_f32_16x16x32_bf16 v[140:143], v[176:179], v[60:63], v[140:143]
  ds_read_b128 v[176:179], v2 offset:22528
  s_add_u32 s22, s57, 12288
  buffer_load_dwordx4 v[48:51], v2, s[4:7], s22 offen offset:0 sc1
  v_add_f32 v44, v44, v6
  s_waitcnt lgkmcnt(9)
  v_mfma_f32_16x16x32_bf16 v[144:147], v[180:183], v[56:59], v[144:147]
  v_mov_b32 v6, v44
  v_mfma_f32_16x16x32_bf16 v[148:151], v[180:183], v[60:63], v[148:151]
  ds_read_b128 v[180:183], v2 offset:23552
  v_mfma_f32_16x16x32_bf16 v[152:155], v[184:187], v[56:59], v[152:155]
  v_permlane16_swap_b32 v44, v6
  v_mfma_f32_16x16x32_bf16 v[156:159], v[184:187], v[60:63], v[156:159]
  ds_read_b128 v[184:187], v2 offset:24576
  buffer_load_dwordx4 v[52:55], v14, s[4:7], s22 offen offset:0 sc1
  v_mfma_f32_16x16x32_bf16 v[160:163], v[188:191], v[56:59], v[160:163]
  v_add_f32 v44, v44, v6
  v_mfma_f32_16x16x32_bf16 v[164:167], v[188:191], v[60:63], v[164:167]
  ds_read_b128 v[188:191], v2 offset:25600
  s_waitcnt vmcnt(12)
  s_waitcnt lgkmcnt(9)
  v_mfma_f32_16x16x32_bf16 v[112:115], v[192:195], v[64:67], v[112:115]
  v_mov_b32 v6, v45
  v_mfma_f32_16x16x32_bf16 v[116:119], v[192:195], v[68:71], v[116:119]
  ds_read_b128 v[192:195], v2 offset:26624
  v_permlane32_swap_b32 v45, v6
  v_mfma_f32_16x16x32_bf16 v[120:123], v[196:199], v[64:67], v[120:123]
  buffer_load_dwordx4 v[56:59], v2, s[4:7], s22 offen offset:1024 sc1
  v_mfma_f32_16x16x32_bf16 v[124:127], v[196:199], v[68:71], v[124:127]
  ds_read_b128 v[196:199], v2 offset:27648
  v_add_f32 v45, v45, v6
  v_mfma_f32_16x16x32_bf16 v[128:131], v[200:203], v[64:67], v[128:131]
  v_mov_b32 v6, v45
  v_mfma_f32_16x16x32_bf16 v[132:135], v[200:203], v[68:71], v[132:135]
  ds_read_b128 v[200:203], v2 offset:28672
  s_waitcnt lgkmcnt(9)
  v_mfma_f32_16x16x32_bf16 v[136:139], v[204:207], v[64:67], v[136:139]
  v_permlane16_swap_b32 v45, v6
  v_mfma_f32_16x16x32_bf16 v[140:143], v[204:207], v[68:71], v[140:143]
  ds_read_b128 v[204:207], v2 offset:29696
  buffer_load_dwordx4 v[60:63], v14, s[4:7], s22 offen offset:1024 sc1
  v_add_f32 v45, v45, v6
  v_mfma_f32_16x16x32_bf16 v[144:147], v[208:211], v[64:67], v[144:147]
  v_mfma_f32_16x16x32_bf16 v[148:151], v[208:211], v[68:71], v[148:151]
  ds_read_b128 v[208:211], v2 offset:30720
  v_mul_f32 v44, 0xbacccccd, v44
  v_mfma_f32_16x16x32_bf16 v[152:155], v[212:215], v[64:67], v[152:155]
  v_mul_f32 v45, 0x3acccccd, v45
  v_mfma_f32_16x16x32_bf16 v[156:159], v[212:215], v[68:71], v[156:159]
  ds_read_b128 v[212:215], v2 offset:31744
  s_add_u32 m0, s43, 114688
  s_add_u32 s21, s47, 114688
  buffer_load_dwordx4 v2, s[4:7], s21 offen offset:0 sc1 lds
  s_waitcnt lgkmcnt(9)
  v_mfma_f32_16x16x32_bf16 v[160:163], v[168:171], v[64:67], v[160:163]
  v_fma_f32 v45, -v44, v44, v45
  v_mfma_f32_16x16x32_bf16 v[164:167], v[168:171], v[68:71], v[164:167]
  ds_read_b128 v[168:171], v2 offset:32768
  s_waitcnt vmcnt(13)
  v_mfma_f32_16x16x32_bf16 v[112:115], v[172:175], v[72:75], v[112:115]
  v_max_f32 v45, 0, v45
  v_mfma_f32_16x16x32_bf16 v[116:119], v[172:175], v[76:79], v[116:119]
  ds_read_b128 v[172:175], v2 offset:33792
  v_add_f32 v45, 0x3727c5ac, v45
  v_mfma_f32_16x16x32_bf16 v[120:123], v[176:179], v[72:75], v[120:123]
  buffer_load_dwordx4 v[64:67], v2, s[4:7], s22 offen offset:2048 sc1
  v_mfma_f32_16x16x32_bf16 v[124:127], v[176:179], v[76:79], v[124:127]
  ds_read_b128 v[176:179], v2 offset:34816
  v_rsq_f32 v217, v45
  s_waitcnt lgkmcnt(9)
  v_mfma_f32_16x16x32_bf16 v[128:131], v[180:183], v[72:75], v[128:131]
  v_cvt_pk_bf16_f32 v224, v44, v44
  v_mfma_f32_16x16x32_bf16 v[132:135], v[180:183], v[76:79], v[132:135]
  ds_read_b128 v[180:183], v2 offset:35840
  v_mfma_f32_16x16x32_bf16 v[136:139], v[184:187], v[72:75], v[136:139]
  v_lshlrev_b32 v6, 16, v224
  v_mfma_f32_16x16x32_bf16 v[140:143], v[184:187], v[76:79], v[140:143]
  ds_read_b128 v[184:187], v2 offset:36864
  buffer_load_dwordx4 v[68:71], v14, s[4:7], s22 offen offset:2048 sc1
  v_sub_f32 v6, v44, v6
  v_mfma_f32_16x16x32_bf16 v[144:147], v[188:191], v[72:75], v[144:147]
  v_mfma_f32_16x16x32_bf16 v[148:151], v[188:191], v[76:79], v[148:151]
  ds_read_b128 v[188:191], v2 offset:37888
  v_cvt_pk_bf16_f32 v225, v6, v6
  s_waitcnt lgkmcnt(9)
  v_mfma_f32_16x16x32_bf16 v[152:155], v[192:195], v[72:75], v[152:155]
  v_mov_b32 v226, 0
  v_mfma_f32_16x16x32_bf16 v[156:159], v[192:195], v[76:79], v[156:159]
  ds_read_b128 v[192:195], v2 offset:38912
  buffer_load_dwordx4 v2, s[4:7], s21 offen offset:1024 sc1 lds
  v_mfma_f32_16x16x32_bf16 v[160:163], v[196:199], v[72:75], v[160:163]
  v_mov_b32 v227, 0
  v_mfma_f32_16x16x32_bf16 v[164:167], v[196:199], v[76:79], v[164:167]
  ds_read_b128 v[196:199], v2 offset:39936
  s_waitcnt vmcnt(14)
  s_mul_i32 s19, s36, 65536
  s_add_u32 s19, s19, 24576
  s_add_u32 s19, s19, s55
  buffer_load_dwordx2 v[22:23], v8, s[4:7], s19 offen sc1
  v_mfma_f32_16x16x32_bf16 v[112:115], v[200:203], v[80:83], v[112:115]
  v_mfma_f32_16x16x32_bf16 v[116:119], v[200:203], v[84:87], v[116:119]
  ds_read_b128 v[200:203], v2 offset:40960
  s_waitcnt lgkmcnt(9)
  v_mfma_f32_16x16x32_bf16 v[120:123], v[204:207], v[80:83], v[120:123]
  buffer_load_dwordx4 v2, s[4:7], s21 offen offset:2048 sc1 lds
  v_mfma_f32_16x16x32_bf16 v[124:127], v[204:207], v[84:87], v[124:127]
  ds_read_b128 v[204:207], v2 offset:41984
  v_mfma_f32_16x16x32_bf16 v[128:131], v[208:211], v[80:83], v[128:131]
  v_mfma_f32_16x16x32_bf16 v[132:135], v[208:211], v[84:87], v[132:135]
  ds_read_b128 v[208:211], v2 offset:43008
  v_mfma_f32_16x16x32_bf16 v[136:139], v[212:215], v[80:83], v[136:139]
  v_mfma_f32_16x16x32_bf16 v[140:143], v[212:215], v[84:87], v[140:143]
  ds_read_b128 v[212:215], v2 offset:44032
  buffer_load_dwordx4 v2, s[4:7], s21 offen offset:3072 sc1 lds
  s_waitcnt lgkmcnt(9)
  v_mfma_f32_16x16x32_bf16 v[144:147], v[168:171], v[80:83], v[144:147]
  v_mfma_f32_16x16x32_bf16 v[148:151], v[168:171], v[84:87], v[148:151]
  ds_read_b128 v[168:171], v2 offset:45056
  v_mfma_f32_16x16x32_bf16 v[152:155], v[172:175], v[80:83], v[152:155]
  v_mfma_f32_16x16x32_bf16 v[156:159], v[172:175], v[84:87], v[156:159]
  ds_read_b128 v[172:175], v2 offset:46080
  s_add_u32 m0, s43, 118784
  s_add_u32 s21, s47, 118784
  buffer_load_dwordx4 v2, s[4:7], s21 offen offset:0 sc1 lds
  v_mfma_f32_16x16x32_bf16 v[160:163], v[176:179], v[80:83], v[160:163]
  v_mfma_f32_16x16x32_bf16 v[164:167], v[176:179], v[84:87], v[164:167]
  ds_read_b128 v[176:179], v2 offset:47104
  s_waitcnt vmcnt(16)
  s_waitcnt lgkmcnt(9)
  v_mfma_f32_16x16x32_bf16 v[112:115], v[180:183], v[88:91], v[112:115]
  v_mfma_f32_16x16x32_bf16 v[116:119], v[180:183], v[92:95], v[116:119]
  ds_read_b128 v[180:183], v2 offset:48128
  v_mfma_f32_16x16x32_bf16 v[120:123], v[184:187], v[88:91], v[120:123]
  buffer_load_dwordx4 v2, s[4:7], s21 offen offset:1024 sc1 lds
  v_mfma_f32_16x16x32_bf16 v[124:127], v[184:187], v[92:95], v[124:127]
  ds_read_b128 v[184:187], v2 offset:49152
  v_mfma_f32_16x16x32_bf16 v[128:131], v[188:191], v[88:91], v[128:131]
  v_mfma_f32_16x16x32_bf16 v[132:135], v[188:191], v[92:95], v[132:135]
  ds_read_b128 v[188:191], v2 offset:50176
  s_waitcnt lgkmcnt(9)
  v_mfma_f32_16x16x32_bf16 v[136:139], v[192:195], v[88:91], v[136:139]
  v_mfma_f32_16x16x32_bf16 v[140:143], v[192:195], v[92:95], v[140:143]
  ds_read_b128 v[192:195], v2 offset:51200
  buffer_load_dwordx4 v2, s[4:7], s21 offen offset:2048 sc1 lds
  v_mfma_f32_16x16x32_bf16 v[144:147], v[196:199], v[88:91], v[144:147]
  v_mfma_f32_16x16x32_bf16 v[148:151], v[196:199], v[92:95], v[148:151]
  ds_read_b128 v[196:199], v2 offset:52224
  v_mfma_f32_16x16x32_bf16 v[152:155], v[200:203], v[88:91], v[152:155]
  v_mfma_f32_16x16x32_bf16 v[156:159], v[200:203], v[92:95], v[156:159]
  ds_read_b128 v[200:203], v2 offset:53248
  buffer_load_dwordx4 v[72:75], v2, s[4:7], s22 offen offset:3072 sc1
  s_waitcnt lgkmcnt(9)
  v_mfma_f32_16x16x32_bf16 v[160:163], v[204:207], v[88:91], v[160:163]
  v_mfma_f32_16x16x32_bf16 v[164:167], v[204:207], v[92:95], v[164:167]
  ds_read_b128 v[204:207], v2 offset:54272
  s_waitcnt vmcnt(17)
  v_mfma_f32_16x16x32_bf16 v[112:115], v[208:211], v[96:99], v[112:115]
  v_mfma_f32_16x16x32_bf16 v[116:119], v[208:211], v[100:103], v[116:119]
  ds_read_b128 v[208:211], v2 offset:55296
  v_mfma_f32_16x16x32_bf16 v[120:123], v[212:215], v[96:99], v[120:123]
  buffer_load_dwordx4 v[76:79], v14, s[4:7], s22 offen offset:3072 sc1
  v_mfma_f32_16x16x32_bf16 v[124:127], v[212:215], v[100:103], v[124:127]
  ds_read_b128 v[212:215], v2 offset:56320
  s_waitcnt lgkmcnt(9)
  v_mfma_f32_16x16x32_bf16 v[128:131], v[168:171], v[96:99], v[128:131]
  v_mfma_f32_16x16x32_bf16 v[132:135], v[168:171], v[100:103], v[132:135]
  ds_read_b128 v[168:171], v2 offset:57344
  v_mfma_f32_16x16x32_bf16 v[136:139], v[172:175], v[96:99], v[136:139]
  v_mfma_f32_16x16x32_bf16 v[140:143], v[172:175], v[100:103], v[140:143]
  ds_read_b128 v[172:175], v2 offset:58368
  s_add_u32 s22, s57, 16384
  buffer_load_dwordx4 v[80:83], v2, s[4:7], s22 offen offset:0 sc1
  v_mfma_f32_16x16x32_bf16 v[144:147], v[176:179], v[96:99], v[144:147]
  v_mfma_f32_16x16x32_bf16 v[148:151], v[176:179], v[100:103], v[148:151]
  ds_read_b128 v[176:179], v2 offset:59392
  s_waitcnt lgkmcnt(9)
  v_mfma_f32_16x16x32_bf16 v[152:155], v[180:183], v[96:99], v[152:155]
  v_mfma_f32_16x16x32_bf16 v[156:159], v[180:183], v[100:103], v[156:159]
  ds_read_b128 v[180:183], v2 offset:60416
  buffer_load_dwordx4 v[84:87], v14, s[4:7], s22 offen offset:0 sc1
  v_mfma_f32_16x16x32_bf16 v[160:163], v[184:187], v[96:99], v[160:163]
  v_mfma_f32_16x16x32_bf16 v[164:167], v[184:187], v[100:103], v[164:167]
  ds_read_b128 v[184:187], v2 offset:61440
  s_waitcnt vmcnt(18)
  v_mfma_f32_16x16x32_bf16 v[112:115], v[188:191], v[104:107], v[112:115]
  v_mfma_f32_16x16x32_bf16 v[116:119], v[188:191], v[108:111], v[116:119]
  ds_read_b128 v[188:191], v2 offset:62464
  s_waitcnt lgkmcnt(9)
  v_mfma_f32_16x16x32_bf16 v[120:123], v[192:195], v[104:107], v[120:123]
  buffer_load_dwordx4 v[88:91], v2, s[4:7], s22 offen offset:1024 sc1
  v_mfma_f32_16x16x32_bf16 v[124:127], v[192:195], v[108:111], v[124:127]
  ds_read_b128 v[192:195], v2 offset:63488
  v_mfma_f32_16x16x32_bf16 v[128:131], v[196:199], v[104:107], v[128:131]
  v_mfma_f32_16x16x32_bf16 v[132:135], v[196:199], v[108:111], v[132:135]
  ds_read_b128 v[196:199], v2 offset:64512
  v_mfma_f32_16x16x32_bf16 v[136:139], v[200:203], v[104:107], v[136:139]
  v_mfma_f32_16x16x32_bf16 v[140:143], v[200:203], v[108:111], v[140:143]
  ds_read_b128 v[200:203], v12 offset:0
  buffer_load_dwordx4 v[92:95], v14, s[4:7], s22 offen offset:1024 sc1
  s_waitcnt lgkmcnt(9)
  v_mfma_f32_16x16x32_bf16 v[144:147], v[204:207], v[104:107], v[144:147]
  v_mfma_f32_16x16x32_bf16 v[148:151], v[204:207], v[108:111], v[148:151]
  ds_read_b128 v[204:207], v12 offset:1024
  v_mfma_f32_16x16x32_bf16 v[152:155], v[208:211], v[104:107], v[152:155]
  v_mfma_f32_16x16x32_bf16 v[156:159], v[208:211], v[108:111], v[156:159]
  ds_read_b128 v[208:211], v12 offset:2048
  buffer_load_dwordx4 v[96:99], v2, s[4:7], s22 offen offset:2048 sc1
  v_mfma_f32_16x16x32_bf16 v[160:163], v[212:215], v[104:107], v[160:163]
  v_mfma_f32_16x16x32_bf16 v[164:167], v[212:215], v[108:111], v[164:167]
  ds_read_b128 v[212:215], v12 offset:3072
  s_waitcnt vmcnt(19)
  s_waitcnt lgkmcnt(9)
  v_mfma_f32_16x16x32_bf16 v[112:115], v[168:171], v[48:51], v[112:115]
  v_mfma_f32_16x16x32_bf16 v[116:119], v[168:171], v[52:55], v[116:119]
  ds_read_b128 v[168:171], v12 offset:4096
  v_mfma_f32_16x16x32_bf16 v[120:123], v[172:175], v[48:51], v[120:123]
  buffer_load_dwordx4 v[100:103], v14, s[4:7], s22 offen offset:2048 sc1
  v_mfma_f32_16x16x32_bf16 v[124:127], v[172:175], v[52:55], v[124:127]
  ds_read_b128 v[172:175], v12 offset:5120
  v_mfma_f32_16x16x32_bf16 v[128:131], v[176:179], v[48:51], v[128:131]
  v_mfma_f32_16x16x32_bf16 v[132:135], v[176:179], v[52:55], v[132:135]
  ds_read_b128 v[176:179], v12 offset:6144
  s_waitcnt lgkmcnt(9)
  v_mfma_f32_16x16x32_bf16 v[136:139], v[180:183], v[48:51], v[136:139]
  v_mfma_f32_16x16x32_bf16 v[140:143], v[180:183], v[52:55], v[140:143]
  ds_read_b128 v[180:183], v12 offset:7168
  s_add_u32 m0, s41, 143360
  s_add_u32 s21, s48, 143360
  buffer_load_dwordx4 v2, s[4:7], s21 offen offset:0 sc1 lds
  v_mfma_f32_16x16x32_bf16 v[144:147], v[184:187], v[48:51], v[144:147]
  v_mfma_f32_16x16x32_bf16 v[148:151], v[184:187], v[52:55], v[148:151]
  ds_read_b128 v[184:187], v12 offset:8192
  v_mfma_f32_16x16x32_bf16 v[152:155], v[188:191], v[48:51], v[152:155]
  v_mfma_f32_16x16x32_bf16 v[156:159], v[188:191], v[52:55], v[156:159]
  ds_read_b128 v[188:191], v12 offset:9216
  buffer_load_dwordx4 v2, s[4:7], s21 offen offset:1024 sc1 lds
  s_waitcnt lgkmcnt(9)
  v_mfma_f32_16x16x32_bf16 v[160:163], v[192:195], v[48:51], v[160:163]
  v_mfma_f32_16x16x32_bf16 v[164:167], v[192:195], v[52:55], v[164:167]
  ds_read_b128 v[192:195], v12 offset:10240
  s_waitcnt vmcnt(20)
  s_waitcnt vmcnt(15)
  s_mov_b32 s24, 0
L_ct6:
  v_cmp_ne_u64 vcc, s[14:15], v[22:23]
  s_nop 0
  s_and_b32 s20, vcc_lo, 0xffff
  s_cbranch_scc0 L_ok6
  s_mul_i32 s19, s36, 65536
  s_add_u32 s19, s19, 24576
  s_add_u32 s19, s19, s55
  buffer_load_dwordx2 v[22:23], v8, s[4:7], s19 offen sc1
  s_add_u32 s24, s24, 1
  s_waitcnt vmcnt(0)
  s_cmp_lt_u32 s24, 100000
  s_cbranch_scc1 L_ct6
L_ok6:
  v_mfma_f32_16x16x32_bf16 v[112:115], v[196:199], v[56:59], v[112:115]
  v_mfma_f32_16x16x32_bf16 v[116:119], v[196:199], v[60:63], v[116:119]
  ds_read_b128 v[196:199], v12 offset:11264
  v_mfma_f32_16x16x32_bf16 v[120:123], v[200:203], v[56:59], v[120:123]
  buffer_load_dwordx4 v[104:107], v2, s[4:7], s22 offen offset:3072 sc1
  v_mfma_f32_16x16x32_bf16 v[124:127], v[200:203], v[60:63], v[124:127]
  ds_read_b128 v[200:203], v12 offset:12288
  s_waitcnt lgkmcnt(9)
  v_mfma_f32_16x16x32_bf16 v[128:131], v[204:207], v[56:59], v[128:131]
  v_mfma_f32_16x16x32_bf16 v[132:135], v[204:207], v[60:63], v[132:135]
  ds_read_b128 v[204:207], v12 offset:13312
  v_mfma_f32_16x16x32_bf16 v[136:139], v[208:211], v[56:59], v[136:139]
  v_mfma_f32_16x16x32_bf16 v[140:143], v[208:211], v[60:63], v[140:143]
  ds_read_b128 v[208:211], v12 offset:14336
  buffer_load_dwordx4 v[108:111], v14, s[4:7], s22 offen offset:3072 sc1
  v_mfma_f32_16x16x32_bf16 v[144:147], v[212:215], v[56:59], v[144:147]
  v_mfma_f32_16x16x32_bf16 v[148:151], v[212:215], v[60:63], v[148:151]
  ds_read_b128 v[212:215], v12 offset:15360
  s_waitcnt lgkmcnt(9)
  v_mfma_f32_16x16x32_bf16 v[152:155], v[168:171], v[56:59], v[152:155]
  v_mfma_f32_16x16x32_bf16 v[156:159], v[168:171], v[60:63], v[156:159]
  ds_read_b128 v[168:171], v12 offset:16384
  s_lshl_b32 s59, s51, 10
  s_mul_i32 s19, s36, 262144
  s_add_u32 s19, s19, 40539136
  s_add_u32 s19, s19, s59
  buffer_load_dwordx2 v[40:41], v10, s[4:7], s19 offen offset:0 sc1
  buffer_load_dwordx2 v[42:43], v10, s[4:7], s19 offen offset:128 sc1
  buffer_load_dwordx2 v[44:45], v10, s[4:7], s19 offen offset:1024 sc1
  buffer_load_dwordx2 v[46:47], v10, s[4:7], s19 offen offset:1152 sc1
  v_mfma_f32_16x16x32_bf16 v[160:163], v[172:175], v[56:59], v[160:163]
  v_mfma_f32_16x16x32_bf16 v[164:167], v[172:175], v[60:63], v[164:167]
  ds_read_b128 v[172:175], v12 offset:17408
  s_waitcnt vmcnt(23)
  v_mfma_f32_16x16x32_bf16 v[112:115], v[176:179], v[64:67], v[112:115]
  v_mfma_f32_16x16x32_bf16 v[116:119], v[176:179], v[68:71], v[116:119]
  ds_read_b128 v[176:179], v12 offset:18432
  s_waitcnt lgkmcnt(9)
  v_mfma_f32_16x16x32_bf16 v[120:123], v[180:183], v[64:67], v[120:123]
  s_add_u32 s22, s58, 0
  buffer_load_dwordx4 v[48:51], v2, s[4:7], s22 offen offset:0 sc1
  v_mfma_f32_16x16x32_bf16 v[124:127], v[180:183], v[68:71], v[124:127]
  ds_read_b128 v[180:183], v12 offset:19456
  v_mfma_f32_16x16x32_bf16 v[128:131], v[184:187], v[64:67], v[128:131]
  v_mfma_f32_16x16x32_bf16 v[132:135], v[184:187], v[68:71], v[132:135]
  s_waitcnt vmcnt(17)
  s_barrier
  ds_read_b128 v[184:187], v12 offset:49152
  v_mfma_f32_16x16x32_bf16 v[136:139], v[188:191], v[64:67], v[136:139]
  v_mfma_f32_16x16x32_bf16 v[140:143], v[188:191], v[68:71], v[140:143]
  ds_read_b128 v[188:191], v12 offset:50176
  buffer_load_dwordx4 v[52:55], v14, s[4:7], s22 offen offset:0 sc1
  s_waitcnt lgkmcnt(9)
  v_mfma_f32_16x16x32_bf16 v[144:147], v[192:195], v[64:67], v[144:147]
  v_mfma_f32_16x16x32_bf16 v[148:151], v[192:195], v[68:71], v[148:151]
  ds_read_b128 v[192:195], v12 offset:51200
  v_mfma_f32_16x16x32_bf16 v[152:155], v[196:199], v[64:67], v[152:155]
  v_mfma_f32_16x16x32_bf16 v[156:159], v[196:199], v[68:71], v[156:159]
  ds_read_b128 v[196:199], v12 offset:52224
  buffer_load_dwordx4 v[56:59], v2, s[4:7], s22 offen offset:1024 sc1
  v_mfma_f32_16x16x32_bf16 v[160:163], v[200:203], v[64:67], v[160:163]
  v_mfma_f32_16x16x32_bf16 v[164:167], v[200:203], v[68:71], v[164:167]
  ds_read_b128 v[200:203], v12 offset:53248
  s_waitcnt vmcnt(17)
  s_waitcnt lgkmcnt(9)
  v_mfma_f32_16x16x32_bf16 v[112:115], v[204:207], v[72:75], v[112:115]
  v_mfma_f32_16x16x32_bf16 v[116:119], v[204:207], v[76:79], v[116:119]
  ds_read_b128 v[204:207], v12 offset:54272
  v_mfma_f32_16x16x32_bf16 v[120:123], v[208:211], v[72:75], v[120:123]
  buffer_load_dwordx4 v[60:63], v14, s[4:7], s22 offen offset:1024 sc1
  v_mfma_f32_16x16x32_bf16 v[124:127], v[208:211], v[76:79], v[124:127]
  ds_read_b128 v[208:211], v12 offset:55296
  v_mfma_f32_16x16x32_bf16 v[128:131], v[212:215], v[72:75], v[128:131]
  v_mfma_f32_16x16x32_bf16 v[132:135], v[212:215], v[76:79], v[132:135]
  ds_read_b128 v[212:215], v12 offset:56320
  s_waitcnt lgkmcnt(9)
  v_mfma_f32_16x16x32_bf16 v[136:139], v[168:171], v[72:75], v[136:139]
  v_mfma_f32_16x16x32_bf16 v[140:143], v[168:171], v[76:79], v[140:143]
  ds_read_b128 v[168:171], v12 offset:57344
  buffer_load_dwordx4 v[64:67], v2, s[4:7], s22 offen offset:2048 sc1
  v_mfma_f32_16x16x32_bf16 v[144:147], v[172:175], v[72:75], v[144:147]
  v_mfma_f32_16x16x32_bf16 v[148:151], v[172:175], v[76:79], v[148:151]
  ds_read_b128 v[172:175], v12 offset:58368
  v_mfma_f32_16x16x32_bf16 v[152:155], v[176:179], v[72:75], v[152:155]
  v_mfma_f32_16x16x32_bf16 v[156:159], v[176:179], v[76:79], v[156:159]
  ds_read_b128 v[176:179], v12 offset:59392
  buffer_load_dwordx4 v[68:71], v14, s[4:7], s22 offen offset:2048 sc1
  s_waitcnt lgkmcnt(9)
  v_mfma_f32_16x16x32_bf16 v[160:163], v[180:183], v[72:75], v[160:163]
  v_mfma_f32_16x16x32_bf16 v[164:167], v[180:183], v[76:79], v[164:167]
  ds_read_b128 v[180:183], v12 offset:60416
  s_waitcnt vmcnt(18)
  v_mfma_f32_16x16x32_bf16 v[112:115], v[184:187], v[80:83], v[112:115]
  v_mfma_f32_16x16x32_bf16 v[116:119], v[184:187], v[84:87], v[116:119]
  ds_read_b128 v[184:187], v12 offset:61440
  v_mfma_f32_16x16x32_bf16 v[120:123], v[188:191], v[80:83], v[120:123]
  buffer_load_dwordx4 v[72:75], v2, s[4:7], s22 offen offset:3072 sc1
  v_mfma_f32_16x16x32_bf16 v[124:127], v[188:191], v[84:87], v[124:127]
  ds_read_b128 v[188:191], v12 offset:62464
  s_waitcnt lgkmcnt(9)
  v_mfma_f32_16x16x32_bf16 v[128:131], v[192:195], v[80:83], v[128:131]
  v_mfma_f32_16x16x32_bf16 v[132:135], v[192:195], v[84:87], v[132:135]
  ds_read_b128 v[192:195], v12 offset:63488
  v_mfma_f32_16x16x32_bf16 v[136:139], v[196:199], v[80:83], v[136:139]
  v_mfma_f32_16x16x32_bf16 v[140:143], v[196:199], v[84:87], v[140:143]
  ds_read_b128 v[196:199], v12 offset:64512
  buffer_load_dwordx4 v[76:79], v14, s[4:7], s22 offen offset:3072 sc1
  v_mfma_f32_16x16x32_bf16 v[144:147], v[200:203], v[80:83], v[144:147]
  v_mfma_f32_16x16x32_bf16 v[148:151], v[200:203], v[84:87], v[148:151]
  ds_read_b128 v[200:203], v13 offset:0
  s_waitcnt lgkmcnt(9)
  v_mfma_f32_16x16x32_bf16 v[152:155], v[204:207], v[80:83], v[152:155]
  v_mfma_f32_16x16x32_bf16 v[156:159], v[204:207], v[84:87], v[156:159]
  ds_read_b128 v[204:207], v13 offset:1024
  buffer_load_dwordx4 a[168:171], v2, s[4:7], s25 offen offset:1024 sc1
  v_mfma_f32_16x16x32_bf16 v[160:163], v[208:211], v[80:83], v[160:163]
  v_mfma_f32_16x16x32_bf16 v[164:167], v[208:211], v[84:87], v[164:167]
  ds_read_b128 v[208:211], v13 offset:2048
  s_waitcnt vmcnt(19)
  v_mfma_f32_16x16x32_bf16 v[112:115], v[212:215], v[88:91], v[112:115]
  v_mfma_f32_16x16x32_bf16 v[116:119], v[212:215], v[92:95], v[116:119]
  ds_read_b128 v[212:215], v13 offset:3072
  s_waitcnt lgkmcnt(9)
  v_mfma_f32_16x16x32_bf16 v[120:123], v[168:171], v[88:91], v[120:123]
  s_add_u32 s22, s58, 4096
  buffer_load_dwordx4 v[80:83], v2, s[4:7], s22 offen offset:0 sc1
  v_mfma_f32_16x16x32_bf16 v[124:127], v[168:171], v[92:95], v[124:127]
  ds_read_b128 v[168:171], v13 offset:4096
  v_mfma_f32_16x16x32_bf16 v[128:131], v[172:175], v[88:91], v[128:131]
  v_mfma_f32_16x16x32_bf16 v[132:135], v[172:175], v[92:95], v[132:135]
  ds_read_b128 v[172:175], v13 offset:5120
  v_mfma_f32_16x16x32_bf16 v[136:139], v[176:179], v[88:91], v[136:139]
  v_mfma_f32_16x16x32_bf16 v[140:143], v[176:179], v[92:95], v[140:143]
  ds_read_b128 v[176:179], v13 offset:6144
  buffer_load_dwordx4 v[84:87], v14, s[4:7], s22 offen offset:0 sc1
  s_waitcnt lgkmcnt(9)
  v_mfma_f32_16x16x32_bf16 v[144:147], v[180:183], v[88:91], v[144:147]
  v_mfma_f32_16x16x32_bf16 v[148:151], v[180:183], v[92:95], v[148:151]
  ds_read_b128 v[180:183], v13 offset:7168
  v_mfma_f32_16x16x32_bf16 v[152:155], v[184:187], v[88:91], v[152:155]
  v_mfma_f32_16x16x32_bf16 v[156:159], v[184:187], v[92:95], v[156:159]
  ds_read_b128 v[184:187], v13 offset:8192
  buffer_load_dwordx4 a[172:175], v2, s[4:7], s25 offen offset:2048 sc1
  v_mfma_f32_16x16x32_bf16 v[160:163], v[188:191], v[88:91], v[160:163]
  v_mfma_f32_16x16x32_bf16 v[164:167], v[188:191], v[92:95], v[164:167]
  ds_read_b128 v[188:191], v13 offset:9216
  s_waitcnt vmcnt(20)
  s_waitcnt lgkmcnt(9)
  v_mfma_f32_16x16x32_bf16 v[112:115], v[192:195], v[96:99], v[112:115]
  v_mfma_f32_16x16x32_bf16 v[116:119], v[192:195], v[100:103], v[116:119]
  ds_read_b128 v[192:195], v13 offset:10240
  v_mfma_f32_16x16x32_bf16 v[120:123], v[196:199], v[96:99], v[120:123]
  buffer_load_dwordx4 v[88:91], v2, s[4:7], s22 offen offset:1024 sc1
  v_mfma_f32_16x16x32_bf16 v[124:127], v[196:199], v[100:103], v[124:127]
  ds_read_b128 v[196:199], v13 offset:11264
  v_mfma_f32_16x16x32_bf16 v[128:131], v[200:203], v[96:99], v[128:131]
  v_mfma_f32_16x16x32_bf16 v[132:135], v[200:203], v[100:103], v[132:135]
  s_waitcnt vmcnt(19)
  s_barrier
  ds_read_b128 v[200:203], v13 offset:12288
  s_waitcnt lgkmcnt(9)
  v_mfma_f32_16x16x32_bf16 v[136:139], v[204:207], v[96:99], v[136:139]
  v_mfma_f32_16x16x32_bf16 v[140:143], v[204:207], v[100:103], v[140:143]
  ds_read_b128 v[204:207], v13 offset:13312
  buffer_load_dwordx4 v[92:95], v14, s[4:7], s22 offen offset:1024 sc1
  v_mfma_f32_16x16x32_bf16 v[144:147], v[208:211], v[96:99], v[144:147]
  v_mfma_f32_16x16x32_bf16 v[148:151], v[208:211], v[100:103], v[148:151]
  ds_read_b128 v[208:211], v13 offset:14336
  v_mfma_f32_16x16x32_bf16 v[152:155], v[212:215], v[96:99], v[152:155]
  v_mfma_f32_16x16x32_bf16 v[156:159], v[212:215], v[100:103], v[156:159]
  ds_read_b128 v[212:215], v13 offset:15360
  buffer_load_dwordx4 a[176:179], v2, s[4:7], s25 offen offset:3072 sc1
  s_waitcnt lgkmcnt(9)
  v_mfma_f32_16x16x32_bf16 v[160:163], v[168:171], v[96:99], v[160:163]
  v_mfma_f32_16x16x32_bf16 v[164:167], v[168:171], v[100:103], v[164:167]
  ds_read_b128 v[168:171], v13 offset:16384
  s_waitcnt vmcnt(19)
  v_mfma_f32_16x16x32_bf16 v[112:115], v[172:175], v[104:107], v[112:115]
  v_mfma_f32_16x16x32_bf16 v[116:119], v[172:175], v[108:111], v[116:119]
  ds_read_b128 v[172:175], v13 offset:17408
  v_mfma_f32_16x16x32_bf16 v[120:123], v[176:179], v[104:107], v[120:123]
  buffer_load_dwordx4 v[96:99], v2, s[4:7], s22 offen offset:2048 sc1
  v_mfma_f32_16x16x32_bf16 v[124:127], v[176:179], v[108:111], v[124:127]
  ds_read_b128 v[176:179], v13 offset:18432
  s_waitcnt lgkmcnt(9)
  v_mfma_f32_16x16x32_bf16 v[128:131], v[180:183], v[104:107], v[128:131]
  v_mfma_f32_16x16x32_bf16 v[132:135], v[180:183], v[108:111], v[132:135]
  ds_read_b128 v[180:183], v12 offset:20480
  v_mfma_f32_16x16x32_bf16 v[136:139], v[184:187], v[104:107], v[136:139]
  v_mfma_f32_16x16x32_bf16 v[140:143], v[184:187], v[108:111], v[140:143]
  ds_read_b128 v[184:187], v12 offset:21504
  buffer_load_dwordx4 v[100:103], v14, s[4:7], s22 offen offset:2048 sc1
  v_mfma_f32_16x16x32_bf16 v[144:147], v[188:191], v[104:107], v[144:147]
  v_mfma_f32_16x16x32_bf16 v[148:151], v[188:191], v[108:111], v[148:151]
  ds_read_b128 v[188:191], v12 offset:22528
  s_waitcnt lgkmcnt(9)
  v_mfma_f32_16x16x32_bf16 v[152:155], v[192:195], v[104:107], v[152:155]
  v_mfma_f32_16x16x32_bf16 v[156:159], v[192:195], v[108:111], v[156:159]
  ds_read_b128 v[192:195], v12 offset:23552
  s_add_u32 s25, s49, 36864
  buffer_load_dwordx4 a[180:183], v2, s[4:7], s25 offen offset:0 sc1
  v_mfma_f32_16x16x32_bf16 v[160:163], v[196:199], v[104:107], v[160:163]
  v_mfma_f32_16x16x32_bf16 v[164:167], v[196:199], v[108:111], v[164:167]
  ds_read_b128 v[196:199], v12 offset:24576
  v_mfma_f32_16x16x32_bf16 v[112:115], v[200:203], v[220:223], v[112:115]
  v_mfma_f32_16x16x32_bf16 v[116:119], v[200:203], v[224:227], v[116:119]
  ds_read_b128 v[200:203], v12 offset:25600
  s_waitcnt lgkmcnt(9)
  v_mfma_f32_16x16x32_bf16 v[120:123], v[204:207], v[220:223], v[120:123]
  v_mfma_f32_16x16x32_bf16 v[124:127], v[204:207], v[224:227], v[124:127]
  ds_read_b128 v[204:207], v12 offset:26624
  buffer_load_dwordx4 v[104:107], v2, s[4:7], s22 offen offset:3072 sc1
  v_mfma_f32_16x16x32_bf16 v[128:131], v[208:211], v[220:223], v[128:131]
  v_mfma_f32_16x16x32_bf16 v[132:135], v[208:211], v[224:227], v[132:135]
  ds_read_b128 v[208:211], v12 offset:27648
  v_mfma_f32_16x16x32_bf16 v[136:139], v[212:215], v[220:223], v[136:139]
  v_mfma_f32_16x16x32_bf16 v[140:143], v[212:215], v[224:227], v[140:143]
  ds_read_b128 v[212:215], v12 offset:28672
  s_waitcnt lgkmcnt(9)
  v_mfma_f32_16x16x32_bf16 v[144:147], v[168:171], v[220:223], v[144:147]
  v_mfma_f32_16x16x32_bf16 v[148:151], v[168:171], v[224:227], v[148:151]
  ds_read_b128 v[168:171], v12 offset:29696
  v_mfma_f32_16x16x32_bf16 v[152:155], v[172:175], v[220:223], v[152:155]
  buffer_load_dwordx4 v[108:111], v14, s[4:7], s22 offen offset:3072 sc1
  v_mfma_f32_16x16x32_bf16 v[156:159], v[172:175], v[224:227], v[156:159]
  ds_read_b128 v[172:175], v12 offset:30720
  v_mfma_f32_16x16x32_bf16 v[160:163], v[176:179], v[220:223], v[160:163]
  v_mfma_f32_16x16x32_bf16 v[164:167], v[176:179], v[224:227], v[164:167]
  ds_read_b128 v[176:179], v12 offset:31744
  v_pk_mul_f32 v[216:217], v[216:217], v[216:217]
  v_cmp_lt_u32 vcc, 31, v1
  s_nop 1
  v_cndmask_b32 v228, v216, v217, vcc
  s_mul_i32 s59, s51, 55296
  s_mul_i32 s19, s36, 7077888
  s_add_u32 s19, s19, 26186752
  s_add_u32 s19, s19, s59
  s_cmp_eq_u32 s37, 31
  s_cselect_b32 s19, 2146435072, s19
  s_mul_i32 s59, s37, 768
  s_add_u32 s20, s19, s59
  s_add_u32 s20, s20, 31744
  s_lshl_b32 s59, s37, 10
  s_add_u32 s19, s19, s59
  s_add_u32 s59, s20, 55296
  v_pk_mul_f32 v[112:113], v[112:113], v[216:217] op_sel:[0,0] op_sel_hi:[1,0]
  v_pk_mul_f32 v[114:115], v[114:115], v[216:217] op_sel:[0,0] op_sel_hi:[1,0]
  v_pk_mul_f32 v[112:113], v[112:113], v[120:121]
  v_pk_mul_f32 v[114:115], v[114:115], v[122:123]
  v_cvt_pk_bf16_f32 v120, v112, v113
  v_cvt_pk_bf16_f32 v121, v114, v115
  v_pk_mul_f32 v[128:129], v[128:129], v[216:217] op_sel:[0,0] op_sel_hi:[1,0]
  v_pk_mul_f32 v[130:131], v[130:131], v[216:217] op_sel:[0,0] op_sel_hi:[1,0]
  v_pk_mul_f32 v[128:129], v[128:129], v[136:137]
  v_pk_mul_f32 v[130:131], v[130:131], v[138:139]
  v_cvt_pk_bf16_f32 v122, v128, v129
  v_cvt_pk_bf16_f32 v123, v130, v131
  buffer_store_dwordx4 v[120:123], v2, s[4:7], s19 offen sc1
  v_pk_mul_f32 v[116:117], v[116:117], v[216:217] op_sel:[0,1] op_sel_hi:[1,1]
  v_pk_mul_f32 v[118:119], v[118:119], v[216:217] op_sel:[0,1] op_sel_hi:[1,1]
  v_pk_mul_f32 v[116:117], v[116:117], v[124:125]
  v_pk_mul_f32 v[118:119], v[118:119], v[126:127]
  v_cvt_pk_bf16_f32 v124, v116, v117
  v_cvt_pk_bf16_f32 v125, v118, v119
  v_pk_mul_f32 v[132:133], v[132:133], v[216:217] op_sel:[0,1] op_sel_hi:[1,1]
  v_pk_mul_f32 v[134:135], v[134:135], v[216:217] op_sel:[0,1] op_sel_hi:[1,1]
  v_pk_mul_f32 v[132:133], v[132:133], v[140:141]
  v_pk_mul_f32 v[134:135], v[134:135], v[142:143]
  v_cvt_pk_bf16_f32 v126, v132, v133
  v_cvt_pk_bf16_f32 v127, v134, v135
  buffer_store_dwordx4 v[124:127], v15, s[4:7], s19 offen sc1
  v_permlane32_swap_b32 v160, v164
  v_permlane32_swap_b32 v161, v165
  v_permlane32_swap_b32 v162, v166
  v_permlane32_swap_b32 v163, v167
  v_pk_mul_f32 v[144:145], v[144:145], v[216:217] op_sel:[0,0] op_sel_hi:[1,0]
  v_pk_mul_f32 v[146:147], v[146:147], v[216:217] op_sel:[0,0] op_sel_hi:[1,0]
  v_pk_mul_f32 v[144:145], v[144:145], v[152:153]
  v_pk_mul_f32 v[146:147], v[146:147], v[154:155]
  v_cvt_pk_bf16_f32 v152, v144, v145
  v_cvt_pk_bf16_f32 v153, v146, v147
  v_pk_mul_f32 v[148:149], v[148:149], v[216:217] op_sel:[0,1] op_sel_hi:[1,1]
  v_pk_mul_f32 v[150:151], v[150:151], v[216:217] op_sel:[0,1] op_sel_hi:[1,1]
  v_pk_mul_f32 v[148:149], v[148:149], v[156:157]
  v_pk_mul_f32 v[150:151], v[150:151], v[158:159]
  v_cvt_pk_bf16_f32 v156, v148, v149
  v_cvt_pk_bf16_f32 v157, v150, v151
  v_pk_mul_f32 v[160:161], v[160:161], v[228:229] op_sel_hi:[1,0]
  v_pk_mul_f32 v[162:163], v[162:163], v[228:229] op_sel_hi:[1,0]
  v_pk_mul_f32 v[160:161], v[160:161], v[164:165]
  v_pk_mul_f32 v[162:163], v[162:163], v[166:167]
  v_cvt_pk_bf16_f32 v154, v160, v161
  v_cvt_pk_bf16_f32 v155, v162, v163
  v_cvt_pk_bf16_f32 v158, v160, v161
  v_cvt_pk_bf16_f32 v159, v162, v163
  v_permlane16_swap_b32 v152, v154
  v_permlane16_swap_b32 v153, v155
  buffer_store_dwordx4 v[152:155], v34, s[4:7], s20 offen sc1
  v_permlane16_swap_b32 v156, v158
  v_permlane16_swap_b32 v157, v159
  buffer_store_dwordx4 v[156:159], v35, s[4:7], s59 offen sc1
  s_waitcnt vmcnt(22)
  s_waitcnt lgkmcnt(9)
  v_mfma_f32_16x16x32_bf16 v[112:115], v[180:183], v[48:51], 0
  v_mfma_f32_16x16x32_bf16 v[116:119], v[180:183], v[52:55], 0
  ds_read_b128 v[180:183], v12 offset:32768
  v_mfma_f32_16x16x32_bf16 v[120:123], v[184:187], v[48:51], 0
  buffer_load_dwordx4 a[184:187], v2, s[4:7], s25 offen offset:1024 sc1
  v_mfma_f32_16x16x32_bf16 v[124:127], v[184:187], v[52:55], 0
  ds_read_b128 v[184:187], v12 offset:33792
  v_mfma_f32_16x16x32_bf16 v[128:131], v[188:191], v[48:51], 0
  v_mfma_f32_16x16x32_bf16 v[132:135], v[188:191], v[52:55], 0
  ds_read_b128 v[188:191], v12 offset:34816
  s_waitcnt lgkmcnt(9)
  v_mfma_f32_16x16x32_bf16 v[136:139], v[192:195], v[48:51], 0
  v_mfma_f32_16x16x32_bf16 v[140:143], v[192:195], v[52:55], 0
  ds_read_b128 v[192:195], v12 offset:35840
  buffer_load_dwordx4 a[188:191], v2, s[4:7], s25 offen offset:2048 sc1
  v_mfma_f32_16x16x32_bf16 v[144:147], v[196:199], v[48:51], 0
  v_mfma_f32_16x16x32_bf16 v[148:151], v[196:199], v[52:55], 0
  ds_read_b128 v[196:199], v12 offset:36864
  v_mfma_f32_16x16x32_bf16 v[152:155], v[200:203], v[48:51], 0
  v_mfma_f32_16x16x32_bf16 v[156:159], v[200:203], v[52:55], 0
  ds_read_b128 v[200:203], v12 offset:37888
  buffer_load_dwordx4 a[0:3], v2, s[4:7], s25 offen offset:3072 sc1
  s_waitcnt lgkmcnt(9)
  v_mfma_f32_16x16x32_bf16 v[160:163], v[204:207], v[48:51], 0
  v_mfma_f32_16x16x32_bf16 v[164:167], v[204:207], v[52:55], 0
  ds_read_b128 v[204:207], v12 offset:38912
  s_waitcnt vmcnt(23)
  v_mfma_f32_16x16x32_bf16 v[112:115], v[208:211], v[56:59], v[112:115]
  v_mfma_f32_16x16x32_bf16 v[116:119], v[208:211], v[60:63], v[116:119]
  ds_read_b128 v[208:211], v12 offset:39936
  v_mfma_f32_16x16x32_bf16 v[120:123], v[212:215], v[56:59], v[120:123]
  s_add_u32 s22, s58, 8192
  buffer_load_dwordx4 v[48:51], v2, s[4:7], s22 offen offset:0 sc1
  v_mfma_f32_16x16x32_bf16 v[124:127], v[212:215], v[60:63], v[124:127]
  ds_read_b128 v[212:215], v12 offset:40960
  s_waitcnt lgkmcnt(9)
  v_mfma_f32_16x16x32_bf16 v[128:131], v[168:171], v[56:59], v[128:131]
  v_mfma_f32_16x16x32_bf16 v[132:135], v[168:171], v[60:63], v[132:135]
  ds_read_b128 v[168:171], v12 offset:41984
  v_mfma_f32_16x16x32_bf16 v[136:139], v[172:175], v[56:59], v[136:139]
  v_mfma_f32_16x16x32_bf16 v[140:143], v[172:175], v[60:63], v[140:143]
  ds_read_b128 v[172:175], v12 offset:43008
  buffer_load_dwordx4 v[52:55], v14, s[4:7], s22 offen offset:0 sc1
  v_mfma_f32_16x16x32_bf16 v[144:147], v[176:179], v[56:59], v[144:147]
  v_mfma_f32_16x16x32_bf16 v[148:151], v[176:179], v[60:63], v[148:151]
  ds_read_b128 v[176:179], v12 offset:44032
  s_waitcnt lgkmcnt(9)
  v_mfma_f32_16x16x32_bf16 v[152:155], v[180:183], v[56:59], v[152:155]
  v_mfma_f32_16x16x32_bf16 v[156:159], v[180:183], v[60:63], v[156:159]
  ds_read_b128 v[180:183], v12 offset:45056
  s_add_u32 s25, s49, 40960
  buffer_load_dwordx4 a[4:7], v2, s[4:7], s25 offen offset:0 sc1
  v_mfma_f32_16x16x32_bf16 v[160:163], v[184:187], v[56:59], v[160:163]
  v_mfma_f32_16x16x32_bf16 v[164:167], v[184:187], v[60:63], v[164:167]
  ds_read_b128 v[184:187], v12 offset:46080
  s_waitcnt vmcnt(24)
  s_waitcnt vmcnt(30)
  v_mfma_f32_16x16x32_bf16 v[112:115], v[188:191], v[64:67], v[112:115]
  v_add_f32 v40, v40, v42
  v_mfma_f32_16x16x32_bf16 v[116:119], v[188:191], v[68:71], v[116:119]
  ds_read_b128 v[188:191], v12 offset:47104
  v_add_f32 v41, v41, v43
  s_waitcnt lgkmcnt(9)
  v_mfma_f32_16x16x32_bf16 v[120:123], v[192:195], v[64:67], v[120:123]
  buffer_load_dwordx4 v[56:59], v2, s[4:7], s22 offen offset:1024 sc1
  v_mfma_f32_16x16x32_bf16 v[124:127], v[192:195], v[68:71], v[124:127]
  ds_read_b128 v[192:195], v12 offset:48128
  v_mov_b32 v6, v40
  v_mfma_f32_16x16x32_bf16 v[128:131], v[196:199], v[64:67], v[128:131]
  v_mfma_f32_16x16x32_bf16 v[132:135], v[196:199], v[68:71], v[132:135]
  ds_read_b128 v[196:199], v2 offset:0
  v_permlane32_swap_b32 v40, v6
  v_mfma_f32_16x16x32_bf16 v[136:139], v[200:203], v[64:67], v[136:139]
  v_mfma_f32_16x16x32_bf16 v[140:143], v[200:203], v[68:71], v[140:143]
  ds_read_b128 v[200:203], v2 offset:1024
  buffer_load_dwordx4 v[60:63], v14, s[4:7], s22 offen offset:1024 sc1
  v_add_f32 v40, v40, v6
  s_waitcnt lgkmcnt(9)
  v_mfma_f32_16x16x32_bf16 v[144:147], v[204:207], v[64:67], v[144:147]
  v_mov_b32 v6, v40
  v_mfma_f32_16x16x32_bf16 v[148:151], v[204:207], v[68:71], v[148:151]
  ds_read_b128 v[204:207], v2 offset:2048
  v_mfma_f32_16x16x32_bf16 v[152:155], v[208:211], v[64:67], v[152:155]
  v_permlane16_swap_b32 v40, v6
  v_mfma_f32_16x16x32_bf16 v[156:159], v[208:211], v[68:71], v[156:159]
  ds_read_b128 v[208:211], v2 offset:3072
  buffer_load_dwordx4 a[8:11], v2, s[4:7], s25 offen offset:1024 sc1
  v_mfma_f32_16x16x32_bf16 v[160:163], v[212:215], v[64:67], v[160:163]
  v_add_f32 v40, v40, v6
  v_mfma_f32_16x16x32_bf16 v[164:167], v[212:215], v[68:71], v[164:167]
  ds_read_b128 v[212:215], v2 offset:4096
  s_waitcnt vmcnt(25)
  s_waitcnt lgkmcnt(9)
  v_mfma_f32_16x16x32_bf16 v[112:115], v[168:171], v[72:75], v[112:115]
  v_mov_b32 v6, v41
  v_mfma_f32_16x16x32_bf16 v[116:119], v[168:171], v[76:79], v[116:119]
  ds_read_b128 v[168:171], v2 offset:5120
  v_permlane32_swap_b32 v41, v6
  v_mfma_f32_16x16x32_bf16 v[120:123], v[172:175], v[72:75], v[120:123]
  buffer_load_dwordx4 v[64:67], v2, s[4:7], s22 offen offset:2048 sc1
  v_mfma_f32_16x16x32_bf16 v[124:127], v[172:175], v[76:79], v[124:127]
  ds_read_b128 v[172:175], v2 offset:6144
  v_add_f32 v41, v41, v6
  v_mfma_f32_16x16x32_bf16 v[128:131], v[176:179], v[72:75], v[128:131]
  v_mov_b32 v6, v41
  v_mfma_f32_16x16x32_bf16 v[132:135], v[176:179], v[76:79], v[132:135]
  ds_read_b128 v[176:179], v2 offset:7168
  s_waitcnt lgkmcnt(9)
  v_mfma_f32_16x16x32_bf16 v[136:139], v[180:183], v[72:75], v[136:139]
  v_permlane16_swap_b32 v41, v6
  v_mfma_f32_16x16x32_bf16 v[140:143], v[180:183], v[76:79], v[140:143]
  ds_read_b128 v[180:183], v2 offset:8192
  buffer_load_dwordx4 v[68:71], v14, s[4:7], s22 offen offset:2048 sc1
  v_add_f32 v41, v41, v6
  v_mfma_f32_16x16x32_bf16 v[144:147], v[184:187], v[72:75], v[144:147]
  v_mfma_f32_16x16x32_bf16 v[148:151], v[184:187], v[76:79], v[148:151]
  ds_read_b128 v[184:187], v2 offset:9216
  v_mul_f32 v40, 0xbacccccd, v40
  v_mfma_f32_16x16x32_bf16 v[152:155], v[188:191], v[72:75], v[152:155]
  v_mul_f32 v41, 0x3acccccd, v41
  v_mfma_f32_16x16x32_bf16 v[156:159], v[188:191], v[76:79], v[156:159]
  ds_read_b128 v[188:191], v2 offset:10240
  buffer_load_dwordx4 a[12:15], v2, s[4:7], s25 offen offset:2048 sc1
  s_waitcnt lgkmcnt(9)
  v_mfma_f32_16x16x32_bf16 v[160:163], v[192:195], v[72:75], v[160:163]
  v_fma_f32 v41, -v40, v40, v41
  v_mfma_f32_16x16x32_bf16 v[164:167], v[192:195], v[76:79], v[164:167]
  ds_read_b128 v[192:195], v2 offset:11264
  s_waitcnt vmcnt(25)
  v_mfma_f32_16x16x32_bf16 v[112:115], v[196:199], v[80:83], v[112:115]
  v_max_f32 v41, 0, v41
  v_mfma_f32_16x16x32_bf16 v[116:119], v[196:199], v[84:87], v[116:119]
  ds_read_b128 v[196:199], v2 offset:12288
  v_add_f32 v41, 0x3727c5ac, v41
  v_mfma_f32_16x16x32_bf16 v[120:123], v[200:203], v[80:83], v[120:123]
  buffer_load_dwordx4 v[72:75], v2, s[4:7], s22 offen offset:3072 sc1
  v_mfma_f32_16x16x32_bf16 v[124:127], v[200:203], v[84:87], v[124:127]
  ds_read_b128 v[200:203], v2 offset:13312
  v_rsq_f32 v216, v41
  s_waitcnt lgkmcnt(9)
  v_mfma_f32_16x16x32_bf16 v[128:131], v[204:207], v[80:83], v[128:131]
  v_cvt_pk_bf16_f32 v220, v40, v40
  v_mfma_f32_16x16x32_bf16 v[132:135], v[204:207], v[84:87], v[132:135]
  ds_read_b128 v[204:207], v2 offset:14336
  v_mfma_f32_16x16x32_bf16 v[136:139], v[208:211], v[80:83], v[136:139]
  v_lshlrev_b32 v6, 16, v220
  v_mfma_f32_16x16x32_bf16 v[140:143], v[208:211], v[84:87], v[140:143]
  ds_read_b128 v[208:211], v2 offset:15360
  buffer_load_dwordx4 v[76:79], v14, s[4:7], s22 offen offset:3072 sc1
  v_sub_f32 v6, v40, v6
  v_mfma_f32_16x16x32_bf16 v[144:147], v[212:215], v[80:83], v[144:147]
  v_mfma_f32_16x16x32_bf16 v[148:151], v[212:215], v[84:87], v[148:151]
  ds_read_b128 v[212:215], v2 offset:16384
  v_cvt_pk_bf16_f32 v221, v6, v6
  s_waitcnt lgkmcnt(9)
  v_mfma_f32_16x16x32_bf16 v[152:155], v[168:171], v[80:83], v[152:155]
  v_mov_b32 v222, 0
  v_mfma_f32_16x16x32_bf16 v[156:159], v[168:171], v[84:87], v[156:159]
  ds_read_b128 v[168:171], v2 offset:17408
  buffer_load_dwordx4 a[16:19], v2, s[4:7], s25 offen offset:3072 sc1
  v_mfma_f32_16x16x32_bf16 v[160:163], v[172:175], v[80:83], v[160:163]
  v_mov_b32 v223, 0
  v_mfma_f32_16x16x32_bf16 v[164:167], v[172:175], v[84:87], v[164:167]
  ds_read_b128 v[172:175], v2 offset:18432
  s_waitcnt vmcnt(25)
  s_waitcnt vmcnt(15)
  s_mul_i32 s19, s36, 65536
  s_add_u32 s19, s19, 32768
  s_add_u32 s19, s19, s55
  s_lshl_b32 s59, s37, 3
  s_add_u32 s19, s19, s59
  v_mov_b32 v20, s14
  v_mov_b32 v21, s15
  s_mov_b64 exec, 1
  buffer_store_dwordx2 v[20:21], v5, s[4:7], s19 offen sc1
  s_mov_b64 exec, -1
  v_mfma_f32_16x16x32_bf16 v[112:115], v[176:179], v[88:91], v[112:115]
  v_add_f32 v44, v44, v46
  v_mfma_f32_16x16x32_bf16 v[116:119], v[176:179], v[92:95], v[116:119]
  ds_read_b128 v[176:179], v2 offset:19456
  v_add_f32 v45, v45, v47
  s_waitcnt lgkmcnt(9)
  v_mfma_f32_16x16x32_bf16 v[120:123], v[180:183], v[88:91], v[120:123]
  s_add_u32 s22, s58, 12288
  buffer_load_dwordx4 v[80:83], v2, s[4:7], s22 offen offset:0 sc1
  v_mfma_f32_16x16x32_bf16 v[124:127], v[180:183], v[92:95], v[124:127]
  ds_read_b128 v[180:183], v2 offset:20480
  v_mov_b32 v6, v44
  v_mfma_f32_16x16x32_bf16 v[128:131], v[184:187], v[88:91], v[128:131]
  v_mfma_f32_16x16x32_bf16 v[132:135], v[184:187], v[92:95], v[132:135]
  ds_read_b128 v[184:187], v2 offset:21504
  v_permlane32_swap_b32 v44, v6
  v_mfma_f32_16x16x32_bf16 v[136:139], v[188:191], v[88:91], v[136:139]
  v_mfma_f32_16x16x32_bf16 v[140:143], v[188:191], v[92:95], v[140:143]
  ds_read_b128 v[188:191], v2 offset:22528
  buffer_load_dwordx4 v[84:87], v14, s[4:7], s22 offen offset:0 sc1
  v_add_f32 v44, v44, v6
  s_waitcnt lgkmcnt(9)
  v_mfma_f32_16x16x32_bf16 v[144:147], v[192:195], v[88:91], v[144:147]
  v_mov_b32 v6, v44
  v_mfma_f32_16x16x32_bf16 v[148:151], v[192:195], v[92:95], v[148:151]
  ds_read_b128 v[192:195], v2 offset:23552
  v_mfma_f32_16x16x32_bf16 v[152:155], v[196:199], v[88:91], v[152:155]
  v_permlane16_swap_b32 v44, v6
  v_mfma_f32_16x16x32_bf16 v[156:159], v[196:199], v[92:95], v[156:159]
  ds_read_b128 v[196:199], v2 offset:24576
  s_add_u32 s25, s49, 45056
  buffer_load_dwordx4 a[20:23], v2, s[4:7], s25 offen offset:0 sc1
  v_mfma_f32_16x16x32_bf16 v[160:163], v[200:203], v[88:91], v[160:163]
  v_add_f32 v44, v44, v6
  v_mfma_f32_16x16x32_bf16 v[164:167], v[200:203], v[92:95], v[164:167]
  ds_read_b128 v[200:203], v2 offset:25600
  s_waitcnt vmcnt(25)
  s_waitcnt lgkmcnt(9)
  v_mfma_f32_16x16x32_bf16 v[112:115], v[204:207], v[96:99], v[112:115]
  v_mov_b32 v6, v45
  v_mfma_f32_16x16x32_bf16 v[116:119], v[204:207], v[100:103], v[116:119]
  ds_read_b128 v[204:207], v2 offset:26624
  v_permlane32_swap_b32 v45, v6
  v_mfma_f32_16x16x32_bf16 v[120:123], v[208:211], v[96:99], v[120:123]
  buffer_load_dwordx4 v[88:91], v2, s[4:7], s22 offen offset:1024 sc1
  v_mfma_f32_16x16x32_bf16 v[124:127], v[208:211], v[100:103], v[124:127]
  ds_read_b128 v[208:211], v2 offset:27648
  v_add_f32 v45, v45, v6
  v_mfma_f32_16x16x32_bf16 v[128:131], v[212:215], v[96:99], v[128:131]
  v_mov_b32 v6, v45
  v_mfma_f32_16x16x32_bf16 v[132:135], v[212:215], v[100:103], v[132:135]
  ds_read_b128 v[212:215], v2 offset:28672
  s_waitcnt lgkmcnt(9)
  v_mfma_f32_16x16x32_bf16 v[136:139], v[168:171], v[96:99], v[136:139]
  v_permlane16_swap_b32 v45, v6
  v_mfma_f32_16x16x32_bf16 v[140:143], v[168:171], v[100:103], v[140:143]
  ds_read_b128 v[168:171], v2 offset:29696
  buffer_load_dwordx4 v[92:95], v14, s[4:7], s22 offen offset:1024 sc1
  v_add_f32 v45, v45, v6
  v_mfma_f32_16x16x32_bf16 v[144:147], v[172:175], v[96:99], v[144:147]
  v_mfma_f32_16x16x32_bf16 v[148:151], v[172:175], v[100:103], v[148:151]
  ds_read_b128 v[172:175], v2 offset:30720
  v_mul_f32 v44, 0xbacccccd, v44
  v_mfma_f32_16x16x32_bf16 v[152:155], v[176:179], v[96:99], v[152:155]
  v_mul_f32 v45, 0x3acccccd, v45
  v_mfma_f32_16x16x32_bf16 v[156:159], v[176:179], v[100:103], v[156:159]
  ds_read_b128 v[176:179], v2 offset:31744
  buffer_load_dwordx4 a[24:27], v2, s[4:7], s25 offen offset:1024 sc1
  s_waitcnt lgkmcnt(9)
  v_mfma_f32_16x16x32_bf16 v[160:163], v[180:183], v[96:99], v[160:163]
  v_fma_f32 v45, -v44, v44, v45
  v_mfma_f32_16x16x32_bf16 v[164:167], v[180:183], v[100:103], v[164:167]
  ds_read_b128 v[180:183], v2 offset:32768
  s_waitcnt vmcnt(25)
  v_mfma_f32_16x16x32_bf16 v[112:115], v[184:187], v[104:107], v[112:115]
  v_max_f32 v45, 0, v45
  v_mfma_f32_16x16x32_bf16 v[116:119], v[184:187], v[108:111], v[116:119]
  ds_read_b128 v[184:187], v2 offset:33792
  v_add_f32 v45, 0x3727c5ac, v45
  v_mfma_f32_16x16x32_bf16 v[120:123], v[188:191], v[104:107], v[120:123]
  buffer_load_dwordx4 v[96:99], v2, s[4:7], s22 offen offset:2048 sc1
  v_mfma_f32_16x16x32_bf16 v[124:127], v[188:191], v[108:111], v[124:127]
  ds_read_b128 v[188:191], v2 offset:34816
  v_rsq_f32 v217, v45
  s_waitcnt lgkmcnt(9)
  v_mfma_f32_16x16x32_bf16 v[128:131], v[192:195], v[104:107], v[128:131]
  v_cvt_pk_bf16_f32 v224, v44, v44
  v_mfma_f32_16x16x32_bf16 v[132:135], v[192:195], v[108:111], v[132:135]
  ds_read_b128 v[192:195], v2 offset:35840
  v_mfma_f32_16x16x32_bf16 v[136:139], v[196:199], v[104:107], v[136:139]
  v_lshlrev_b32 v6, 16, v224
  v_mfma_f32_16x16x32_bf16 v[140:143], v[196:199], v[108:111], v[140:143]
  ds_read_b128 v[196:199], v2 offset:36864
  buffer_load_dwordx4 v[100:103], v14, s[4:7], s22 offen offset:2048 sc1
  v_sub_f32 v6, v44, v6
  v_mfma_f32_16x16x32_bf16 v[144:147], v[200:203], v[104:107], v[144:147]
  v_mfma_f32_16x16x32_bf16 v[148:151], v[200:203], v[108:111], v[148:151]
  ds_read_b128 v[200:203], v2 offset:37888
  v_cvt_pk_bf16_f32 v225, v6, v6
  s_waitcnt lgkmcnt(9)
  v_mfma_f32_16x16x32_bf16 v[152:155], v[204:207], v[104:107], v[152:155]
  v_mov_b32 v226, 0
  v_mfma_f32_16x16x32_bf16 v[156:159], v[204:207], v[108:111], v[156:159]
  ds_read_b128 v[204:207], v2 offset:38912
  buffer_load_dwordx4 a[28:31], v2, s[4:7], s25 offen offset:2048 sc1
  v_mfma_f32_16x16x32_bf16 v[160:163], v[208:211], v[104:107], v[160:163]
  v_mov_b32 v227, 0
  v_mfma_f32_16x16x32_bf16 v[164:167], v[208:211], v[108:111], v[164:167]
  ds_read_b128 v[208:211], v2 offset:39936
  s_waitcnt vmcnt(19)
  v_mfma_f32_16x16x32_bf16 v[112:115], v[212:215], v[48:51], v[112:115]
  v_mfma_f32_16x16x32_bf16 v[116:119], v[212:215], v[52:55], v[116:119]
  ds_read_b128 v[212:215], v2 offset:40960
  s_waitcnt lgkmcnt(9)
  v_mfma_f32_16x16x32_bf16 v[120:123], v[168:171], v[48:51], v[120:123]
  buffer_load_dwordx4 v[104:107], v2, s[4:7], s22 offen offset:3072 sc1
  v_mfma_f32_16x16x32_bf16 v[124:127], v[168:171], v[52:55], v[124:127]
  ds_read_b128 v[168:171], v2 offset:41984
  v_mfma_f32_16x16x32_bf16 v[128:131], v[172:175], v[48:51], v[128:131]
  v_mfma_f32_16x16x32_bf16 v[132:135], v[172:175], v[52:55], v[132:135]
  ds_read_b128 v[172:175], v2 offset:43008
  v_mfma_f32_16x16x32_bf16 v[136:139], v[176:179], v[48:51], v[136:139]
  v_mfma_f32_16x16x32_bf16 v[140:143], v[176:179], v[52:55], v[140:143]
  ds_read_b128 v[176:179], v2 offset:44032
  buffer_load_dwordx4 v[108:111], v14, s[4:7], s22 offen offset:3072 sc1
  s_waitcnt lgkmcnt(9)
  v_mfma_f32_16x16x32_bf16 v[144:147], v[180:183], v[48:51], v[144:147]
  v_mfma_f32_16x16x32_bf16 v[148:151], v[180:183], v[52:55], v[148:151]
  ds_read_b128 v[180:183], v2 offset:45056
  v_mfma_f32_16x16x32_bf16 v[152:155], v[184:187], v[48:51], v[152:155]
  v_mfma_f32_16x16x32_bf16 v[156:159], v[184:187], v[52:55], v[156:159]
  ds_read_b128 v[184:187], v2 offset:46080
  buffer_load_dwordx4 a[32:35], v2, s[4:7], s25 offen offset:3072 sc1
  v_mfma_f32_16x16x32_bf16 v[160:163], v[188:191], v[48:51], v[160:163]
  v_mfma_f32_16x16x32_bf16 v[164:167], v[188:191], v[52:55], v[164:167]
  ds_read_b128 v[188:191], v2 offset:47104
  s_waitcnt vmcnt(19)
  s_mul_i32 s19, s36, 65536
  s_add_u32 s19, s19, 32768
  s_add_u32 s19, s19, s56
  buffer_load_dwordx2 v[22:23], v8, s[4:7], s19 offen sc1
  s_mul_i32 s59, s52, 55296
  s_mul_i32 s57, s36, 7077888
  s_add_u32 s57, s57, 26186752
  s_add_u32 s57, s57, s59
  s_add_u32 s57, s57, s61
  s_waitcnt lgkmcnt(9)
  v_mfma_f32_16x16x32_bf16 v[112:115], v[192:195], v[56:59], v[112:115]
  v_mfma_f32_16x16x32_bf16 v[116:119], v[192:195], v[60:63], v[116:119]
  ds_read_b128 v[192:195], v2 offset:48128
  v_mfma_f32_16x16x32_bf16 v[120:123], v[196:199], v[56:59], v[120:123]
  s_add_u32 s22, s58, 16384
  buffer_load_dwordx4 v[48:51], v2, s[4:7], s22 offen offset:0 sc1
  v_mfma_f32_16x16x32_bf16 v[124:127], v[196:199], v[60:63], v[124:127]
  ds_read_b128 v[196:199], v2 offset:49152
  v_mfma_f32_16x16x32_bf16 v[128:131], v[200:203], v[56:59], v[128:131]
  v_mfma_f32_16x16x32_bf16 v[132:135], v[200:203], v[60:63], v[132:135]
  ds_read_b128 v[200:203], v2 offset:50176
  s_waitcnt lgkmcnt(9)
  v_mfma_f32_16x16x32_bf16 v[136:139], v[204:207], v[56:59], v[136:139]
  v_mfma_f32_16x16x32_bf16 v[140:143], v[204:207], v[60:63], v[140:143]
  ds_read_b128 v[204:207], v2 offset:51200
  buffer_load_dwordx4 v[52:55], v14, s[4:7], s22 offen offset:0 sc1
  v_mfma_f32_16x16x32_bf16 v[144:147], v[208:211], v[56:59], v[144:147]
  v_mfma_f32_16x16x32_bf16 v[148:151], v[208:211], v[60:63], v[148:151]
  ds_read_b128 v[208:211], v2 offset:52224
  v_mfma_f32_16x16x32_bf16 v[152:155], v[212:215], v[56:59], v[152:155]
  v_mfma_f32_16x16x32_bf16 v[156:159], v[212:215], v[60:63], v[156:159]
  ds_read_b128 v[212:215], v2 offset:53248
  s_add_u32 s25, s49, 49152
  buffer_load_dwordx4 a[192:195], v2, s[4:7], s25 offen offset:0 sc1
  s_waitcnt lgkmcnt(9)
  v_mfma_f32_16x16x32_bf16 v[160:163], v[168:171], v[56:59], v[160:163]
  v_mfma_f32_16x16x32_bf16 v[164:167], v[168:171], v[60:63], v[164:167]
  ds_read_b128 v[168:171], v2 offset:54272
  s_waitcnt vmcnt(20)
  v_mfma_f32_16x16x32_bf16 v[112:115], v[172:175], v[64:67], v[112:115]
  v_mfma_f32_16x16x32_bf16 v[116:119], v[172:175], v[68:71], v[116:119]
  ds_read_b128 v[172:175], v2 offset:55296
  v_mfma_f32_16x16x32_bf16 v[120:123], v[176:179], v[64:67], v[120:123]
  buffer_load_dwordx4 v[56:59], v2, s[4:7], s22 offen offset:1024 sc1
  v_mfma_f32_16x16x32_bf16 v[124:127], v[176:179], v[68:71], v[124:127]
  ds_read_b128 v[176:179], v2 offset:56320
  s_waitcnt lgkmcnt(9)
  v_mfma_f32_16x16x32_bf16 v[128:131], v[180:183], v[64:67], v[128:131]
  v_mfma_f32_16x16x32_bf16 v[132:135], v[180:183], v[68:71], v[132:135]
  ds_read_b128 v[180:183], v2 offset:57344
  v_mfma_f32_16x16x32_bf16 v[136:139], v[184:187], v[64:67], v[136:139]
  v_mfma_f32_16x16x32_bf16 v[140:143], v[184:187], v[68:71], v[140:143]
  ds_read_b128 v[184:187], v2 offset:58368
  buffer_load_dwordx4 v[60:63], v14, s[4:7], s22 offen offset:1024 sc1
  v_mfma_f32_16x16x32_bf16 v[144:147], v[188:191], v[64:67], v[144:147]
  v_mfma_f32_16x16x32_bf16 v[148:151], v[188:191], v[68:71], v[148:151]
  ds_read_b128 v[188:191], v2 offset:59392
  s_waitcnt lgkmcnt(9)
  v_mfma_f32_16x16x32_bf16 v[152:155], v[192:195], v[64:67], v[152:155]
  v_mfma_f32_16x16x32_bf16 v[156:159], v[192:195], v[68:71], v[156:159]
  ds_read_b128 v[192:195], v2 offset:60416
  buffer_load_dwordx4 a[196:199], v2, s[4:7], s25 offen offset:1024 sc1
  v_mfma_f32_16x16x32_bf16 v[160:163], v[196:199], v[64:67], v[160:163]
  v_mfma_f32_16x16x32_bf16 v[164:167], v[196:199], v[68:71], v[164:167]
  ds_read_b128 v[196:199], v2 offset:61440
  s_waitcnt vmcnt(20)
  v_mfma_f32_16x16x32_bf16 v[112:115], v[200:203], v[72:75], v[112:115]
  v_mfma_f32_16x16x32_bf16 v[116:119], v[200:203], v[76:79], v[116:119]
  ds_read_b128 v[200:203], v2 offset:62464
  s_waitcnt lgkmcnt(9)
  v_mfma_f32_16x16x32_bf16 v[120:123], v[204:207], v[72:75], v[120:123]
  buffer_load_dwordx4 v[64:67], v2, s[4:7], s22 offen offset:2048 sc1
  v_mfma_f32_16x16x32_bf16 v[124:127], v[204:207], v[76:79], v[124:127]
  ds_read_b128 v[204:207], v2 offset:63488
  v_mfma_f32_16x16x32_bf16 v[128:131], v[208:211], v[72:75], v[128:131]
  v_mfma_f32_16x16x32_bf16 v[132:135], v[208:211], v[76:79], v[132:135]
  ds_read_b128 v[208:211], v2 offset:64512
  v_mfma_f32_16x16x32_bf16 v[136:139], v[212:215], v[72:75], v[136:139]
  v_mfma_f32_16x16x32_bf16 v[140:143], v[212:215], v[76:79], v[140:143]
  ds_read_b128 v[212:215], v12 offset:0
  buffer_load_dwordx4 v[68:71], v14, s[4:7], s22 offen offset:2048 sc1
  s_waitcnt lgkmcnt(9)
  v_mfma_f32_16x16x32_bf16 v[144:147], v[168:171], v[72:75], v[144:147]
  v_mfma_f32_16x16x32_bf16 v[148:151], v[168:171], v[76:79], v[148:151]
  ds_read_b128 v[168:171], v12 offset:1024
  v_mfma_f32_16x16x32_bf16 v[152:155], v[172:175], v[72:75], v[152:155]
  v_mfma_f32_16x16x32_bf16 v[156:159], v[172:175], v[76:79], v[156:159]
  ds_read_b128 v[172:175], v12 offset:2048
  buffer_load_dwordx4 a[200:203], v2, s[4:7], s25 offen offset:2048 sc1
  v_mfma_f32_16x16x32_bf16 v[160:163], v[176:179], v[72:75], v[160:163]
  v_mfma_f32_16x16x32_bf16 v[164:167], v[176:179], v[76:79], v[164:167]
  ds_read_b128 v[176:179], v12 offset:3072
  s_waitcnt vmcnt(20)
  s_waitcnt lgkmcnt(9)
  v_mfma_f32_16x16x32_bf16 v[112:115], v[180:183], v[80:83], v[112:115]
  v_mfma_f32_16x16x32_bf16 v[116:119], v[180:183], v[84:87], v[116:119]
  ds_read_b128 v[180:183], v12 offset:4096
  v_mfma_f32_16x16x32_bf16 v[120:123], v[184:187], v[80:83], v[120:123]
  v_mfma_f32_16x16x32_bf16 v[124:127], v[184:187], v[84:87], v[124:127]
  ds_read_b128 v[184:187], v12 offset:5120
  buffer_load_dwordx4 v[72:75], v2, s[4:7], s22 offen offset:3072 sc1
  v_mfma_f32_16x16x32_bf16 v[128:131], v[188:191], v[80:83], v[128:131]
  v_mfma_f32_16x16x32_bf16 v[132:135], v[188:191], v[84:87], v[132:135]
  ds_read_b128 v[188:191], v12 offset:6144
  s_waitcnt lgkmcnt(9)
  v_mfma_f32_16x16x32_bf16 v[136:139], v[192:195], v[80:83], v[136:139]
  v_mfma_f32_16x16x32_bf16 v[140:143], v[192:195], v[84:87], v[140:143]
  ds_read_b128 v[192:195], v12 offset:7168
  v_mfma_f32_16x16x32_bf16 v[144:147], v[196:199], v[80:83], v[144:147]
  v_mfma_f32_16x16x32_bf16 v[148:151], v[196:199], v[84:87], v[148:151]
  ds_read_b128 v[196:199], v12 offset:8192
  v_mfma_f32_16x16x32_bf16 v[152:155], v[200:203], v[80:83], v[152:155]
  buffer_load_dwordx4 v[76:79], v14, s[4:7], s22 offen offset:3072 sc1
  v_mfma_f32_16x16x32_bf16 v[156:159], v[200:203], v[84:87], v[156:159]
  ds_read_b128 v[200:203], v12 offset:9216
  s_waitcnt lgkmcnt(9)
  v_mfma_f32_16x16x32_bf16 v[160:163], v[204:207], v[80:83], v[160:163]
  v_mfma_f32_16x16x32_bf16 v[164:167], v[204:207], v[84:87], v[164:167]
  ds_read_b128 v[204:207], v12 offset:10240
  s_waitcnt vmcnt(19)
  v_mfma_f32_16x16x32_bf16 v[112:115], v[208:211], v[88:91], v[112:115]
  v_mfma_f32_16x16x32_bf16 v[116:119], v[208:211], v[92:95], v[116:119]
  ds_read_b128 v[208:211], v12 offset:11264
  v_mfma_f32_16x16x32_bf16 v[120:123], v[212:215], v[88:91], v[120:123]
  buffer_load_dwordx4 a[204:207], v2, s[4:7], s25 offen offset:3072 sc1
  v_mfma_f32_16x16x32_bf16 v[124:127], v[212:215], v[92:95], v[124:127]
  ds_read_b128 v[212:215], v12 offset:12288
  s_waitcnt lgkmcnt(9)
  v_mfma_f32_16x16x32_bf16 v[128:131], v[168:171], v[88:91], v[128:131]
  v_mfma_f32_16x16x32_bf16 v[132:135], v[168:171], v[92:95], v[132:135]
  ds_read_b128 v[168:171], v12 offset:13312
  v_mfma_f32_16x16x32_bf16 v[136:139], v[172:175], v[88:91], v[136:139]
  v_mfma_f32_16x16x32_bf16 v[140:143], v[172:175], v[92:95], v[140:143]
  ds_read_b128 v[172:175], v12 offset:14336
  s_add_u32 s25, s49, 53248
  buffer_load_dwordx4 a[208:211], v2, s[4:7], s25 offen offset:0 sc1
  v_mfma_f32_16x16x32_bf16 v[144:147], v[176:179], v[88:91], v[144:147]
  v_mfma_f32_16x16x32_bf16 v[148:151], v[176:179], v[92:95], v[148:151]
  ds_read_b128 v[176:179], v12 offset:15360
  s_waitcnt lgkmcnt(9)
  v_mfma_f32_16x16x32_bf16 v[152:155], v[180:183], v[88:91], v[152:155]
  v_mfma_f32_16x16x32_bf16 v[156:159], v[180:183], v[92:95], v[156:159]
  ds_read_b128 v[180:183], v12 offset:16384
  buffer_load_dwordx4 a[212:215], v2, s[4:7], s25 offen offset:1024 sc1
  v_mfma_f32_16x16x32_bf16 v[160:163], v[184:187], v[88:91], v[160:163]
  v_mfma_f32_16x16x32_bf16 v[164:167], v[184:187], v[92:95], v[164:167]
  ds_read_b128 v[184:187], v12 offset:17408
  s_waitcnt vmcnt(19)
  s_waitcnt vmcnt(14)
  s_mov_b32 s24, 0
L_ct7:
  v_cmp_ne_u64 vcc, s[14:15], v[22:23]
  s_nop 0
  s_and_b32 s20, vcc_lo, -1
  s_cbranch_scc0 L_ok7
  s_mul_i32 s19, s36, 65536
  s_add_u32 s19, s19, 32768
  s_add_u32 s19, s19, s56
  buffer_load_dwordx2 v[22:23], v8, s[4:7], s19 offen sc1
  s_add_u32 s24, s24, 1
  s_waitcnt vmcnt(0)
  s_cmp_lt_u32 s24, 100000
  s_cbranch_scc1 L_ct7
L_ok7:
  v_mfma_f32_16x16x32_bf16 v[112:115], v[188:191], v[96:99], v[112:115]
  v_mfma_f32_16x16x32_bf16 v[116:119], v[188:191], v[100:103], v[116:119]
  ds_read_b128 v[188:191], v12 offset:18432
  s_waitcnt lgkmcnt(9)
  v_mfma_f32_16x16x32_bf16 v[120:123], v[192:195], v[96:99], v[120:123]
  s_add_u32 s22, s57, 0
  buffer_load_dwordx4 v[80:83], v2, s[4:7], s22 offen offset:0 sc1
  v_mfma_f32_16x16x32_bf16 v[124:127], v[192:195], v[100:103], v[124:127]
  ds_read_b128 v[192:195], v12 offset:19456
  v_mfma_f32_16x16x32_bf16 v[128:131], v[196:199], v[96:99], v[128:131]
  v_mfma_f32_16x16x32_bf16 v[132:135], v[196:199], v[100:103], v[132:135]
  ds_read_b128 v[196:199], v12 offset:49152
  v_mfma_f32_16x16x32_bf16 v[136:139], v[200:203], v[96:99], v[136:139]
  v_mfma_f32_16x16x32_bf16 v[140:143], v[200:203], v[100:103], v[140:143]
  ds_read_b128 v[200:203], v12 offset:50176
  buffer_load_dwordx4 v[84:87], v15, s[4:7], s22 offen offset:0 sc1
  s_waitcnt lgkmcnt(9)
  v_mfma_f32_16x16x32_bf16 v[144:147], v[204:207], v[96:99], v[144:147]
  v_mfma_f32_16x16x32_bf16 v[148:151], v[204:207], v[100:103], v[148:151]
  ds_read_b128 v[204:207], v12 offset:51200
  v_mfma_f32_16x16x32_bf16 v[152:155], v[208:211], v[96:99], v[152:155]
  v_mfma_f32_16x16x32_bf16 v[156:159], v[208:211], v[100:103], v[156:159]
  ds_read_b128 v[208:211], v12 offset:52224
  buffer_load_dwordx4 v[88:91], v2, s[4:7], s22 offen offset:1024 sc1
  v_mfma_f32_16x16x32_bf16 v[160:163], v[212:215], v[96:99], v[160:163]
  v_mfma_f32_16x16x32_bf16 v[164:167], v[212:215], v[100:103], v[164:167]
  ds_read_b128 v[212:215], v12 offset:53248
  s_waitcnt vmcnt(19)
  s_waitcnt lgkmcnt(9)
  v_mfma_f32_16x16x32_bf16 v[112:115], v[168:171], v[104:107], v[112:115]
  v_mfma_f32_16x16x32_bf16 v[116:119], v[168:171], v[108:111], v[116:119]
  ds_read_b128 v[168:171], v12 offset:54272
  v_mfma_f32_16x16x32_bf16 v[120:123], v[172:175], v[104:107], v[120:123]
  buffer_load_dwordx4 v[92:95], v15, s[4:7], s22 offen offset:1024 sc1
  v_mfma_f32_16x16x32_bf16 v[124:127], v[172:175], v[108:111], v[124:127]
  ds_read_b128 v[172:175], v12 offset:55296
  v_mfma_f32_16x16x32_bf16 v[128:131], v[176:179], v[104:107], v[128:131]
  v_mfma_f32_16x16x32_bf16 v[132:135], v[176:179], v[108:111], v[132:135]
  ds_read_b128 v[176:179], v12 offset:56320
  s_waitcnt lgkmcnt(9)
  v_mfma_f32_16x16x32_bf16 v[136:139], v[180:183], v[104:107], v[136:139]
  v_mfma_f32_16x16x32_bf16 v[140:143], v[180:183], v[108:111], v[140:143]
  ds_read_b128 v[180:183], v12 offset:57344
  buffer_load_dwordx4 v[96:99], v2, s[4:7], s22 offen offset:2048 sc1
  v_mfma_f32_16x16x32_bf16 v[144:147], v[184:187], v[104:107], v[144:147]
  v_mfma_f32_16x16x32_bf16 v[148:151], v[184:187], v[108:111], v[148:151]
  ds_read_b128 v[184:187], v12 offset:58368
  v_mfma_f32_16x16x32_bf16 v[152:155], v[188:191], v[104:107], v[152:155]
  v_mfma_f32_16x16x32_bf16 v[156:159], v[188:191], v[108:111], v[156:159]
  ds_read_b128 v[188:191], v12 offset:59392
  buffer_load_dwordx4 v[100:103], v15, s[4:7], s22 offen offset:2048 sc1
  s_waitcnt lgkmcnt(9)
  v_mfma_f32_16x16x32_bf16 v[160:163], v[192:195], v[104:107], v[160:163]
  v_mfma_f32_16x16x32_bf16 v[164:167], v[192:195], v[108:111], v[164:167]
  ds_read_b128 v[192:195], v12 offset:60416
  s_waitcnt vmcnt(18)
  v_mfma_f32_16x16x32_bf16 v[112:115], v[196:199], v[48:51], v[112:115]
  v_mfma_f32_16x16x32_bf16 v[116:119], v[196:199], v[52:55], v[116:119]
  ds_read_b128 v[196:199], v12 offset:61440
  v_mfma_f32_16x16x32_bf16 v[120:123], v[200:203], v[48:51], v[120:123]
  v_mfma_f32_16x16x32_bf16 v[124:127], v[200:203], v[52:55], v[124:127]
  ds_read_b128 v[200:203], v12 offset:62464
  buffer_load_dwordx4 v[104:107], v2, s[4:7], s22 offen offset:3072 sc1
  s_waitcnt lgkmcnt(9)
  v_mfma_f32_16x16x32_bf16 v[128:131], v[204:207], v[48:51], v[128:131]
  v_mfma_f32_16x16x32_bf16 v[132:135], v[204:207], v[52:55], v[132:135]
  ds_read_b128 v[204:207], v12 offset:63488
  v_mfma_f32_16x16x32_bf16 v[136:139], v[208:211], v[48:51], v[136:139]
  v_mfma_f32_16x16x32_bf16 v[140:143], v[208:211], v[52:55], v[140:143]
  ds_read_b128 v[208:211], v12 offset:64512
  v_mfma_f32_16x16x32_bf16 v[144:147], v[212:215], v[48:51], v[144:147]
  v_mfma_f32_16x16x32_bf16 v[148:151], v[212:215], v[52:55], v[148:151]
  ds_read_b128 v[212:215], v13 offset:0
  s_waitcnt lgkmcnt(9)
  v_mfma_f32_16x16x32_bf16 v[152:155], v[168:171], v[48:51], v[152:155]
  buffer_load_dwordx4 v[108:111], v15, s[4:7], s22 offen offset:3072 sc1
  v_mfma_f32_16x16x32_bf16 v[156:159], v[168:171], v[52:55], v[156:159]
  ds_read_b128 v[168:171], v13 offset:1024
  v_mfma_f32_16x16x32_bf16 v[160:163], v[172:175], v[48:51], v[160:163]
  v_mfma_f32_16x16x32_bf16 v[164:167], v[172:175], v[52:55], v[164:167]
  ds_read_b128 v[172:175], v13 offset:2048
  s_waitcnt vmcnt(17)
  v_mfma_f32_16x16x32_bf16 v[112:115], v[176:179], v[56:59], v[112:115]
  v_mfma_f32_16x16x32_bf16 v[116:119], v[176:179], v[60:63], v[116:119]
  ds_read_b128 v[176:179], v13 offset:3072
  s_waitcnt lgkmcnt(9)
  v_mfma_f32_16x16x32_bf16 v[120:123], v[180:183], v[56:59], v[120:123]
  s_add_u32 s22, s57, 4096
  buffer_load_dwordx4 v[48:51], v2, s[4:7], s22 offen offset:0 sc1
  v_mfma_f32_16x16x32_bf16 v[124:127], v[180:183], v[60:63], v[124:127]
  ds_read_b128 v[180:183], v13 offset:4096
  v_mfma_f32_16x16x32_bf16 v[128:131], v[184:187], v[56:59], v[128:131]
  v_mfma_f32_16x16x32_bf16 v[132:135], v[184:187], v[60:63], v[132:135]
  ds_read_b128 v[184:187], v13 offset:5120
  v_mfma_f32_16x16x32_bf16 v[136:139], v[188:191], v[56:59], v[136:139]
  v_mfma_f32_16x16x32_bf16 v[140:143], v[188:191], v[60:63], v[140:143]
  ds_read_b128 v[188:191], v13 offset:6144
  buffer_load_dwordx4 v[52:55], v15, s[4:7], s22 offen offset:0 sc1
  s_waitcnt lgkmcnt(9)
  v_mfma_f32_16x16x32_bf16 v[144:147], v[192:195], v[56:59], v[144:147]
  v_mfma_f32_16x16x32_bf16 v[148:151], v[192:195], v[60:63], v[148:151]
  ds_read_b128 v[192:195], v13 offset:7168
  v_mfma_f32_16x16x32_bf16 v[152:155], v[196:199], v[56:59], v[152:155]
  v_mfma_f32_16x16x32_bf16 v[156:159], v[196:199], v[60:63], v[156:159]
  ds_read_b128 v[196:199], v13 offset:8192
  buffer_load_dwordx4 a[216:219], v2, s[4:7], s25 offen offset:2048 sc1
  v_mfma_f32_16x16x32_bf16 v[160:163], v[200:203], v[56:59], v[160:163]
  v_mfma_f32_16x16x32_bf16 v[164:167], v[200:203], v[60:63], v[164:167]
  ds_read_b128 v[200:203], v13 offset:9216
  s_waitcnt vmcnt(17)
  s_waitcnt lgkmcnt(9)
  v_mfma_f32_16x16x32_bf16 v[112:115], v[204:207], v[64:67], v[112:115]
  v_mfma_f32_16x16x32_bf16 v[116:119], v[204:207], v[68:71], v[116:119]
  ds_read_b128 v[204:207], v13 offset:10240
  v_mfma_f32_16x16x32_bf16 v[120:123], v[208:211], v[64:67], v[120:123]
  v_mfma_f32_16x16x32_bf16 v[124:127], v[208:211], v[68:71], v[124:127]
  ds_read_b128 v[208:211], v13 offset:11264
  buffer_load_dwordx4 v[56:59], v2, s[4:7], s22 offen offset:1024 sc1
  v_mfma_f32_16x16x32_bf16 v[128:131], v[212:215], v[64:67], v[128:131]
  v_mfma_f32_16x16x32_bf16 v[132:135], v[212:215], v[68:71], v[132:135]
  ds_read_b128 v[212:215], v13 offset:12288
  s_waitcnt lgkmcnt(9)
  v_mfma_f32_16x16x32_bf16 v[136:139], v[168:171], v[64:67], v[136:139]
  v_mfma_f32_16x16x32_bf16 v[140:143], v[168:171], v[68:71], v[140:143]
  ds_read_b128 v[168:171], v13 offset:13312
  v_mfma_f32_16x16x32_bf16 v[144:147], v[172:175], v[64:67], v[144:147]
  v_mfma_f32_16x16x32_bf16 v[148:151], v[172:175], v[68:71], v[148:151]
  ds_read_b128 v[172:175], v13 offset:14336
  v_mfma_f32_16x16x32_bf16 v[152:155], v[176:179], v[64:67], v[152:155]
  buffer_load_dwordx4 v[60:63], v15, s[4:7], s22 offen offset:1024 sc1
  v_mfma_f32_16x16x32_bf16 v[156:159], v[176:179], v[68:71], v[156:159]
  ds_read_b128 v[176:179], v13 offset:15360
  s_waitcnt lgkmcnt(9)
  v_mfma_f32_16x16x32_bf16 v[160:163], v[180:183], v[64:67], v[160:163]
  v_mfma_f32_16x16x32_bf16 v[164:167], v[180:183], v[68:71], v[164:167]
  ds_read_b128 v[180:183], v13 offset:16384
  s_waitcnt vmcnt(16)
  v_mfma_f32_16x16x32_bf16 v[112:115], v[184:187], v[72:75], v[112:115]
  v_mfma_f32_16x16x32_bf16 v[116:119], v[184:187], v[76:79], v[116:119]
  ds_read_b128 v[184:187], v13 offset:17408
  v_mfma_f32_16x16x32_bf16 v[120:123], v[188:191], v[72:75], v[120:123]
  buffer_load_dwordx4 v[64:67], v2, s[4:7], s22 offen offset:2048 sc1
  v_mfma_f32_16x16x32_bf16 v[124:127], v[188:191], v[76:79], v[124:127]
  ds_read_b128 v[188:191], v13 offset:18432
  s_waitcnt lgkmcnt(9)
  v_mfma_f32_16x16x32_bf16 v[128:131], v[192:195], v[72:75], v[128:131]
  v_mfma_f32_16x16x32_bf16 v[132:135], v[192:195], v[76:79], v[132:135]
  v_mfma_f32_16x16x32_bf16 v[136:139], v[196:199], v[72:75], v[136:139]
  v_mfma_f32_16x16x32_bf16 v[140:143], v[196:199], v[76:79], v[140:143]
  buffer_load_dwordx4 v[68:71], v15, s[4:7], s22 offen offset:2048 sc1
  v_mfma_f32_16x16x32_bf16 v[144:147], v[200:203], v[72:75], v[144:147]
  v_mfma_f32_16x16x32_bf16 v[148:151], v[200:203], v[76:79], v[148:151]
  s_waitcnt lgkmcnt(6)
  v_mfma_f32_16x16x32_bf16 v[152:155], v[204:207], v[72:75], v[152:155]
  v_mfma_f32_16x16x32_bf16 v[156:159], v[204:207], v[76:79], v[156:159]
  buffer_load_dwordx4 a[220:223], v2, s[4:7], s25 offen offset:3072 sc1
  v_mfma_f32_16x16x32_bf16 v[160:163], v[208:211], v[72:75], v[160:163]
  v_mfma_f32_16x16x32_bf16 v[164:167], v[208:211], v[76:79], v[164:167]
  v_mfma_f32_16x16x32_bf16 v[112:115], v[212:215], v[220:223], v[112:115]
  v_mfma_f32_16x16x32_bf16 v[116:119], v[212:215], v[224:227], v[116:119]
  s_waitcnt lgkmcnt(3)
  v_mfma_f32_16x16x32_bf16 v[120:123], v[168:171], v[220:223], v[120:123]
  buffer_load_dwordx4 v[72:75], v2, s[4:7], s22 offen offset:3072 sc1
  v_mfma_f32_16x16x32_bf16 v[124:127], v[168:171], v[224:227], v[124:127]
  v_mfma_f32_16x16x32_bf16 v[128:131], v[172:175], v[220:223], v[128:131]
  v_mfma_f32_16x16x32_bf16 v[132:135], v[172:175], v[224:227], v[132:135]
  v_mfma_f32_16x16x32_bf16 v[136:139], v[176:179], v[220:223], v[136:139]
  v_mfma_f32_16x16x32_bf16 v[140:143], v[176:179], v[224:227], v[140:143]
  buffer_load_dwordx4 v[76:79], v15, s[4:7], s22 offen offset:3072 sc1
  s_waitcnt lgkmcnt(0)
  v_mfma_f32_16x16x32_bf16 v[144:147], v[180:183], v[220:223], v[144:147]
  v_mfma_f32_16x16x32_bf16 v[148:151], v[180:183], v[224:227], v[148:151]
  v_mfma_f32_16x16x32_bf16 v[152:155], v[184:187], v[220:223], v[152:155]
  v_mfma_f32_16x16x32_bf16 v[156:159], v[184:187], v[224:227], v[156:159]
  s_add_u32 s25, s49, 57344
  buffer_load_dwordx4 a[224:227], v2, s[4:7], s25 offen offset:0 sc1
  v_mfma_f32_16x16x32_bf16 v[160:163], v[188:191], v[220:223], v[160:163]
  v_mfma_f32_16x16x32_bf16 v[164:167], v[188:191], v[224:227], v[164:167]
  s_barrier
  v_pk_mul_f32 v[216:217], v[216:217], v[216:217]
  v_cmp_lt_u32 vcc, 31, v1
  s_nop 1
  v_cndmask_b32 v228, v216, v217, vcc
  s_mul_i32 s59, s51, 55296
  s_mul_i32 s19, s36, 7077888
  s_add_u32 s19, s19, 29725696
  s_add_u32 s19, s19, s59
  s_cmp_eq_u32 s37, 31
  s_cselect_b32 s19, 2146435072, s19
  s_mul_i32 s59, s37, 768
  s_add_u32 s20, s19, s59
  s_add_u32 s20, s20, 31744
  s_lshl_b32 s59, s37, 10
  s_add_u32 s19, s19, s59
  s_add_u32 s59, s20, 55296
  v_pk_mul_f32 v[112:113], v[112:113], v[216:217] op_sel:[0,0] op_sel_hi:[1,0]
  v_pk_mul_f32 v[114:115], v[114:115], v[216:217] op_sel:[0,0] op_sel_hi:[1,0]
  v_pk_mul_f32 v[112:113], v[112:113], v[120:121]
  v_pk_mul_f32 v[114:115], v[114:115], v[122:123]
  v_cvt_pk_bf16_f32 v120, v112, v113
  v_cvt_pk_bf16_f32 v121, v114, v115
  v_pk_mul_f32 v[128:129], v[128:129], v[216:217] op_sel:[0,0] op_sel_hi:[1,0]
  v_pk_mul_f32 v[130:131], v[130:131], v[216:217] op_sel:[0,0] op_sel_hi:[1,0]
  v_pk_mul_f32 v[128:129], v[128:129], v[136:137]
  v_pk_mul_f32 v[130:131], v[130:131], v[138:139]
  v_cvt_pk_bf16_f32 v122, v128, v129
  v_cvt_pk_bf16_f32 v123, v130, v131
  buffer_store_dwordx4 v[120:123], v2, s[4:7], s19 offen sc1
  v_pk_mul_f32 v[116:117], v[116:117], v[216:217] op_sel:[0,1] op_sel_hi:[1,1]
  v_pk_mul_f32 v[118:119], v[118:119], v[216:217] op_sel:[0,1] op_sel_hi:[1,1]
  v_pk_mul_f32 v[116:117], v[116:117], v[124:125]
  v_pk_mul_f32 v[118:119], v[118:119], v[126:127]
  v_cvt_pk_bf16_f32 v124, v116, v117
  v_cvt_pk_bf16_f32 v125, v118, v119
  v_pk_mul_f32 v[132:133], v[132:133], v[216:217] op_sel:[0,1] op_sel_hi:[1,1]
  v_pk_mul_f32 v[134:135], v[134:135], v[216:217] op_sel:[0,1] op_sel_hi:[1,1]
  v_pk_mul_f32 v[132:133], v[132:133], v[140:141]
  v_pk_mul_f32 v[134:135], v[134:135], v[142:143]
  v_cvt_pk_bf16_f32 v126, v132, v133
  v_cvt_pk_bf16_f32 v127, v134, v135
  buffer_store_dwordx4 v[124:127], v15, s[4:7], s19 offen sc1
  v_permlane32_swap_b32 v160, v164
  v_permlane32_swap_b32 v161, v165
  v_permlane32_swap_b32 v162, v166
  v_permlane32_swap_b32 v163, v167
  v_pk_mul_f32 v[144:145], v[144:145], v[216:217] op_sel:[0,0] op_sel_hi:[1,0]
  v_pk_mul_f32 v[146:147], v[146:147], v[216:217] op_sel:[0,0] op_sel_hi:[1,0]
  v_pk_mul_f32 v[144:145], v[144:145], v[152:153]
  v_pk_mul_f32 v[146:147], v[146:147], v[154:155]
  v_cvt_pk_bf16_f32 v152, v144, v145
  v_cvt_pk_bf16_f32 v153, v146, v147
  v_pk_mul_f32 v[148:149], v[148:149], v[216:217] op_sel:[0,1] op_sel_hi:[1,1]
  v_pk_mul_f32 v[150:151], v[150:151], v[216:217] op_sel:[0,1] op_sel_hi:[1,1]
  v_pk_mul_f32 v[148:149], v[148:149], v[156:157]
  v_pk_mul_f32 v[150:151], v[150:151], v[158:159]
  v_cvt_pk_bf16_f32 v156, v148, v149
  v_cvt_pk_bf16_f32 v157, v150, v151
  v_pk_mul_f32 v[160:161], v[160:161], v[228:229] op_sel_hi:[1,0]
  v_pk_mul_f32 v[162:163], v[162:163], v[228:229] op_sel_hi:[1,0]
  v_pk_mul_f32 v[160:161], v[160:161], v[164:165]
  v_pk_mul_f32 v[162:163], v[162:163], v[166:167]
  v_cvt_pk_bf16_f32 v154, v160, v161
  v_cvt_pk_bf16_f32 v155, v162, v163
  v_cvt_pk_bf16_f32 v158, v160, v161
  v_cvt_pk_bf16_f32 v159, v162, v163
  v_permlane16_swap_b32 v152, v154
  v_permlane16_swap_b32 v153, v155
  buffer_store_dwordx4 v[152:155], v34, s[4:7], s20 offen sc1
  v_permlane16_swap_b32 v156, v158
  v_permlane16_swap_b32 v157, v159
  buffer_store_dwordx4 v[156:159], v35, s[4:7], s59 offen sc1
  s_waitcnt vmcnt(21)
  s_waitcnt vmcnt(63)
  v_mfma_f32_16x16x32_bf16 v[112:115], a[36:39], v[80:83], 0
  v_mfma_f32_16x16x32_bf16 v[132:135], a[36:39], v[84:87], 0
  buffer_load_dwordx4 a[228:231], v2, s[4:7], s25 offen offset:1024 sc1
  v_mfma_f32_16x16x32_bf16 v[116:119], a[40:43], v[80:83], 0
  v_mfma_f32_16x16x32_bf16 v[136:139], a[40:43], v[84:87], 0
  v_mfma_f32_16x16x32_bf16 v[120:123], a[44:47], v[80:83], 0
  v_mfma_f32_16x16x32_bf16 v[140:143], a[44:47], v[84:87], 0
  buffer_load_dwordx4 a[232:235], v2, s[4:7], s25 offen offset:2048 sc1
  v_mfma_f32_16x16x32_bf16 v[124:127], a[48:51], v[80:83], 0
  v_mfma_f32_16x16x32_bf16 v[144:147], a[48:51], v[84:87], 0
  v_mfma_f32_16x16x32_bf16 v[128:131], a[52:55], v[80:83], 0
  buffer_load_dwordx4 a[236:239], v2, s[4:7], s25 offen offset:3072 sc1
  v_mfma_f32_16x16x32_bf16 v[148:151], a[52:55], v[84:87], 0
  s_waitcnt vmcnt(22)
  s_waitcnt vmcnt(63)
  v_mfma_f32_16x16x32_bf16 v[112:115], a[56:59], v[88:91], v[112:115]
  v_mfma_f32_16x16x32_bf16 v[132:135], a[56:59], v[92:95], v[132:135]
  s_add_u32 s22, s57, 8192
  buffer_load_dwordx4 v[80:83], v2, s[4:7], s22 offen offset:0 sc1
  v_mfma_f32_16x16x32_bf16 v[116:119], a[60:63], v[88:91], v[116:119]
  v_mfma_f32_16x16x32_bf16 v[136:139], a[60:63], v[92:95], v[136:139]
  v_mfma_f32_16x16x32_bf16 v[120:123], a[64:67], v[88:91], v[120:123]
  v_mfma_f32_16x16x32_bf16 v[140:143], a[64:67], v[92:95], v[140:143]
  buffer_load_dwordx4 v[84:87], v15, s[4:7], s22 offen offset:0 sc1
  v_mfma_f32_16x16x32_bf16 v[124:127], a[68:71], v[88:91], v[124:127]
  v_mfma_f32_16x16x32_bf16 v[144:147], a[68:71], v[92:95], v[144:147]
  v_mfma_f32_16x16x32_bf16 v[128:131], a[72:75], v[88:91], v[128:131]
  s_add_u32 s25, s49, 61440
  buffer_load_dwordx4 a[240:243], v2, s[4:7], s25 offen offset:0 sc1
  v_mfma_f32_16x16x32_bf16 v[148:151], a[72:75], v[92:95], v[148:151]
  s_waitcnt vmcnt(23)
  s_waitcnt vmcnt(63)
  v_mfma_f32_16x16x32_bf16 v[112:115], a[76:79], v[96:99], v[112:115]
  v_mfma_f32_16x16x32_bf16 v[132:135], a[76:79], v[100:103], v[132:135]
  buffer_load_dwordx4 v[88:91], v2, s[4:7], s22 offen offset:1024 sc1
  v_mfma_f32_16x16x32_bf16 v[116:119], a[80:83], v[96:99], v[116:119]
  v_mfma_f32_16x16x32_bf16 v[136:139], a[80:83], v[100:103], v[136:139]
  v_mfma_f32_16x16x32_bf16 v[120:123], a[84:87], v[96:99], v[120:123]
  v_mfma_f32_16x16x32_bf16 v[140:143], a[84:87], v[100:103], v[140:143]
  buffer_load_dwordx4 v[92:95], v15, s[4:7], s22 offen offset:1024 sc1
  v_mfma_f32_16x16x32_bf16 v[124:127], a[88:91], v[96:99], v[124:127]
  v_mfma_f32_16x16x32_bf16 v[144:147], a[88:91], v[100:103], v[144:147]
  v_mfma_f32_16x16x32_bf16 v[128:131], a[92:95], v[96:99], v[128:131]
  buffer_load_dwordx4 a[244:247], v2, s[4:7], s25 offen offset:1024 sc1
  v_mfma_f32_16x16x32_bf16 v[148:151], a[92:95], v[100:103], v[148:151]
  s_waitcnt vmcnt(9)
  s_mul_i32 s19, s36, 65536
  s_add_u32 s19, s19, 40960
  s_add_u32 s19, s19, s55
  s_lshl_b32 s59, s37, 3
  s_add_u32 s19, s19, s59
  v_mov_b32 v20, s14
  v_mov_b32 v21, s15
  s_mov_b64 exec, 1
  buffer_store_dwordx2 v[20:21], v5, s[4:7], s19 offen sc1
  s_mov_b64 exec, -1
  s_waitcnt vmcnt(24)
  s_waitcnt vmcnt(63)
  v_mfma_f32_16x16x32_bf16 v[112:115], a[96:99], v[104:107], v[112:115]
  v_mfma_f32_16x16x32_bf16 v[132:135], a[96:99], v[108:111], v[132:135]
  buffer_load_dwordx4 v[96:99], v2, s[4:7], s22 offen offset:2048 sc1
  v_mfma_f32_16x16x32_bf16 v[116:119], a[100:103], v[104:107], v[116:119]
  v_mfma_f32_16x16x32_bf16 v[136:139], a[100:103], v[108:111], v[136:139]
  v_mfma_f32_16x16x32_bf16 v[120:123], a[104:107], v[104:107], v[120:123]
  v_mfma_f32_16x16x32_bf16 v[140:143], a[104:107], v[108:111], v[140:143]
  buffer_load_dwordx4 v[100:103], v15, s[4:7], s22 offen offset:2048 sc1
  v_mfma_f32_16x16x32_bf16 v[124:127], a[108:111], v[104:107], v[124:127]
  v_mfma_f32_16x16x32_bf16 v[144:147], a[108:111], v[108:111], v[144:147]
  v_mfma_f32_16x16x32_bf16 v[128:131], a[112:115], v[104:107], v[128:131]
  buffer_load_dwordx4 a[248:251], v2, s[4:7], s25 offen offset:2048 sc1
  v_mfma_f32_16x16x32_bf16 v[148:151], a[112:115], v[108:111], v[148:151]
  s_waitcnt vmcnt(25)
  s_waitcnt vmcnt(63)
  v_mfma_f32_16x16x32_bf16 v[112:115], a[116:119], v[48:51], v[112:115]
  v_mfma_f32_16x16x32_bf16 v[132:135], a[116:119], v[52:55], v[132:135]
  buffer_load_dwordx4 v[104:107], v2, s[4:7], s22 offen offset:3072 sc1
  v_mfma_f32_16x16x32_bf16 v[116:119], a[120:123], v[48:51], v[116:119]
  v_mfma_f32_16x16x32_bf16 v[136:139], a[120:123], v[52:55], v[136:139]
  v_mfma_f32_16x16x32_bf16 v[120:123], a[124:127], v[48:51], v[120:123]
  v_mfma_f32_16x16x32_bf16 v[140:143], a[124:127], v[52:55], v[140:143]
  buffer_load_dwordx4 v[108:111], v15, s[4:7], s22 offen offset:3072 sc1
  v_mfma_f32_16x16x32_bf16 v[124:127], a[128:131], v[48:51], v[124:127]
  v_mfma_f32_16x16x32_bf16 v[144:147], a[128:131], v[52:55], v[144:147]
  v_mfma_f32_16x16x32_bf16 v[128:131], a[132:135], v[48:51], v[128:131]
  buffer_load_dwordx4 a[252:255], v2, s[4:7], s25 offen offset:3072 sc1
  v_mfma_f32_16x16x32_bf16 v[148:151], a[132:135], v[52:55], v[148:151]
  s_waitcnt vmcnt(25)
  s_waitcnt vmcnt(63)
  v_mfma_f32_16x16x32_bf16 v[112:115], a[136:139], v[56:59], v[112:115]
  v_mfma_f32_16x16x32_bf16 v[132:135], a[136:139], v[60:63], v[132:135]
  s_add_u32 s25, s49, 65536
  buffer_load_dwordx4 v[232:235], v2, s[4:7], s25 offen offset:0 sc1
  v_mfma_f32_16x16x32_bf16 v[116:119], a[140:143], v[56:59], v[116:119]
  v_mfma_f32_16x16x32_bf16 v[136:139], a[140:143], v[60:63], v[136:139]
  v_mfma_f32_16x16x32_bf16 v[120:123], a[144:147], v[56:59], v[120:123]
  v_mfma_f32_16x16x32_bf16 v[140:143], a[144:147], v[60:63], v[140:143]
  s_add_u32 s22, s57, 12288
  buffer_load_dwordx4 v[48:51], v2, s[4:7], s22 offen offset:0 sc1
  v_mfma_f32_16x16x32_bf16 v[124:127], a[148:151], v[56:59], v[124:127]
  v_mfma_f32_16x16x32_bf16 v[144:147], a[148:151], v[60:63], v[144:147]
  v_mfma_f32_16x16x32_bf16 v[128:131], a[152:155], v[56:59], v[128:131]
  buffer_load_dwordx4 v[52:55], v15, s[4:7], s22 offen offset:0 sc1
  v_mfma_f32_16x16x32_bf16 v[148:151], a[152:155], v[60:63], v[148:151]
  s_waitcnt vmcnt(26)
  s_waitcnt vmcnt(63)
  v_mfma_f32_16x16x32_bf16 v[112:115], a[156:159], v[64:67], v[112:115]
  v_mfma_f32_16x16x32_bf16 v[132:135], a[156:159], v[68:71], v[132:135]
  s_add_u32 s25, s50, 65536
  buffer_load_dwordx4 v[236:239], v2, s[4:7], s25 offen offset:1024 sc1
  v_mfma_f32_16x16x32_bf16 v[116:119], a[160:163], v[64:67], v[116:119]
  v_mfma_f32_16x16x32_bf16 v[136:139], a[160:163], v[68:71], v[136:139]
  v_mfma_f32_16x16x32_bf16 v[120:123], a[164:167], v[64:67], v[120:123]
  v_mfma_f32_16x16x32_bf16 v[140:143], a[164:167], v[68:71], v[140:143]
  buffer_load_dwordx4 v[240:243], v2, s[4:7], s25 offen offset:2048 sc1
  v_mfma_f32_16x16x32_bf16 v[124:127], a[168:171], v[64:67], v[124:127]
  v_mfma_f32_16x16x32_bf16 v[144:147], a[168:171], v[68:71], v[144:147]
  v_mfma_f32_16x16x32_bf16 v[128:131], a[172:175], v[64:67], v[128:131]
  buffer_load_dwordx4 v[244:247], v2, s[4:7], s25 offen offset:3072 sc1
  v_mfma_f32_16x16x32_bf16 v[148:151], a[172:175], v[68:71], v[148:151]
  s_waitcnt vmcnt(26)
  s_waitcnt vmcnt(63)
  v_mfma_f32_16x16x32_bf16 v[112:115], a[176:179], v[72:75], v[112:115]
  v_mfma_f32_16x16x32_bf16 v[132:135], a[176:179], v[76:79], v[132:135]
  s_add_u32 s25, s50, 69632
  buffer_load_dwordx4 v[248:251], v2, s[4:7], s25 offen offset:0 sc1
  v_mfma_f32_16x16x32_bf16 v[116:119], a[180:183], v[72:75], v[116:119]
  v_mfma_f32_16x16x32_bf16 v[136:139], a[180:183], v[76:79], v[136:139]
  v_mfma_f32_16x16x32_bf16 v[120:123], a[184:187], v[72:75], v[120:123]
  v_mfma_f32_16x16x32_bf16 v[140:143], a[184:187], v[76:79], v[140:143]
  buffer_load_dwordx4 v[252:255], v2, s[4:7], s25 offen offset:1024 sc1
  v_mfma_f32_16x16x32_bf16 v[124:127], a[188:191], v[72:75], v[124:127]
  v_mfma_f32_16x16x32_bf16 v[144:147], a[188:191], v[76:79], v[144:147]
  v_mfma_f32_16x16x32_bf16 v[128:131], a[0:3], v[72:75], v[128:131]
  s_add_u32 s22, s57, 12288
  s_add_u32 s22, s22, s62
  buffer_load_dwordx4 v[56:59], v2, s[4:7], s22 offen offset:1024 sc1
  v_mfma_f32_16x16x32_bf16 v[148:151], a[0:3], v[76:79], v[148:151]
  s_waitcnt vmcnt(19)
  s_waitcnt vmcnt(63)
  v_mfma_f32_16x16x32_bf16 v[112:115], a[4:7], v[80:83], v[112:115]
  v_mfma_f32_16x16x32_bf16 v[132:135], a[4:7], v[84:87], v[132:135]
  v_mfma_f32_16x16x32_bf16 v[116:119], a[8:11], v[80:83], v[116:119]
  buffer_load_dwordx4 v[60:63], v15, s[4:7], s22 offen offset:1024 sc1
  v_mfma_f32_16x16x32_bf16 v[136:139], a[8:11], v[84:87], v[136:139]
  v_mfma_f32_16x16x32_bf16 v[120:123], a[12:15], v[80:83], v[120:123]
  v_mfma_f32_16x16x32_bf16 v[140:143], a[12:15], v[84:87], v[140:143]
  v_mfma_f32_16x16x32_bf16 v[124:127], a[16:19], v[80:83], v[124:127]
  v_mfma_f32_16x16x32_bf16 v[144:147], a[16:19], v[84:87], v[144:147]
  s_mul_i32 s19, s36, 5242880
  s_add_u32 s19, s19, 13079552
  s_add_u32 s19, s19, s53
  s_mul_i32 s20, s36, 5242880
  s_add_u32 s20, s20, 13079552
  s_add_u32 s20, s20, s54
  buffer_load_dwordx4 v[152:155], v2, s[4:7], s19 offen sc1
  buffer_load_dwordx4 v[156:159], v2, s[4:7], s19 offen offset:1024 sc1
  buffer_load_dwordx2 v[160:161], v11, s[4:7], s20 offen sc1
  v_mfma_f32_16x16x32_bf16 v[128:131], a[20:23], v[80:83], v[128:131]
  v_mfma_f32_16x16x32_bf16 v[148:151], a[20:23], v[84:87], v[148:151]
  s_waitcnt vmcnt(20)
  s_waitcnt vmcnt(59)
  v_mfma_f32_16x16x32_bf16 v[112:115], a[24:27], v[88:91], v[112:115]
  v_mfma_f32_16x16x32_bf16 v[132:135], a[24:27], v[92:95], v[132:135]
  v_mfma_f32_16x16x32_bf16 v[116:119], a[28:31], v[88:91], v[116:119]
  v_mfma_f32_16x16x32_bf16 v[136:139], a[28:31], v[92:95], v[136:139]
  v_mfma_f32_16x16x32_bf16 v[120:123], a[32:35], v[88:91], v[120:123]
  v_mfma_f32_16x16x32_bf16 v[140:143], a[32:35], v[92:95], v[140:143]
  v_mfma_f32_16x16x32_bf16 v[124:127], a[192:195], v[88:91], v[124:127]
  v_mfma_f32_16x16x32_bf16 v[144:147], a[192:195], v[92:95], v[144:147]
  v_mfma_f32_16x16x32_bf16 v[128:131], a[196:199], v[88:91], v[128:131]
  v_mfma_f32_16x16x32_bf16 v[148:151], a[196:199], v[92:95], v[148:151]
  s_mul_i32 s19, s36, 65536
  s_add_u32 s19, s19, 40960
  s_add_u32 s19, s19, s56
  buffer_load_dwordx2 v[22:23], v8, s[4:7], s19 offen sc1
  s_mul_i32 s59, s52, 55296
  s_mul_i32 s60, s36, 7077888
  s_add_u32 s60, s60, 29725696
  s_add_u32 s60, s60, s59
  s_add_u32 s60, s60, s61
  s_waitcnt vmcnt(18)
  s_waitcnt vmcnt(41)
  v_mfma_f32_16x16x32_bf16 v[112:115], a[200:203], v[96:99], v[112:115]
  v_mfma_f32_16x16x32_bf16 v[132:135], a[200:203], v[100:103], v[132:135]
  s_add_u32 m0, s42, 0
  s_add_u32 s21, s44, 0
  buffer_load_dwordx4 v2, s[4:7], s21 offen offset:0 sc1 lds
  v_mfma_f32_16x16x32_bf16 v[116:119], a[204:207], v[96:99], v[116:119]
  v_mfma_f32_16x16x32_bf16 v[136:139], a[204:207], v[100:103], v[136:139]
  v_mfma_f32_16x16x32_bf16 v[120:123], a[208:211], v[96:99], v[120:123]
  v_mfma_f32_16x16x32_bf16 v[140:143], a[208:211], v[100:103], v[140:143]
  buffer_load_dwordx4 v2, s[4:7], s21 offen offset:1024 sc1 lds
  v_mfma_f32_16x16x32_bf16 v[124:127], a[212:215], v[96:99], v[124:127]
  v_mfma_f32_16x16x32_bf16 v[144:147], a[212:215], v[100:103], v[144:147]
  v_mfma_f32_16x16x32_bf16 v[128:131], a[216:219], v[96:99], v[128:131]
  buffer_load_dwordx4 v2, s[4:7], s21 offen offset:2048 sc1 lds
  v_mfma_f32_16x16x32_bf16 v[148:151], a[216:219], v[100:103], v[148:151]
  s_waitcnt vmcnt(18)
  s_waitcnt vmcnt(29)
  v_mfma_f32_16x16x32_bf16 v[112:115], a[220:223], v[104:107], v[112:115]
  v_mfma_f32_16x16x32_bf16 v[132:135], a[220:223], v[108:111], v[132:135]
  buffer_load_dwordx4 v2, s[4:7], s21 offen offset:3072 sc1 lds
  v_mfma_f32_16x16x32_bf16 v[116:119], a[224:227], v[104:107], v[116:119]
  v_mfma_f32_16x16x32_bf16 v[136:139], a[224:227], v[108:111], v[136:139]
  v_mfma_f32_16x16x32_bf16 v[120:123], a[228:231], v[104:107], v[120:123]
  v_mfma_f32_16x16x32_bf16 v[140:143], a[228:231], v[108:111], v[140:143]
  s_add_u32 m0, s42, 16384
  s_add_u32 s21, s44, 16384
  buffer_load_dwordx4 v2, s[4:7], s21 offen offset:0 sc1 lds
  v_mfma_f32_16x16x32_bf16 v[124:127], a[232:235], v[104:107], v[124:127]
  v_mfma_f32_16x16x32_bf16 v[144:147], a[232:235], v[108:111], v[144:147]
  v_mfma_f32_16x16x32_bf16 v[128:131], a[236:239], v[104:107], v[128:131]
  buffer_load_dwordx4 v2, s[4:7], s21 offen offset:1024 sc1 lds
  v_mfma_f32_16x16x32_bf16 v[148:151], a[236:239], v[108:111], v[148:151]
  s_waitcnt vmcnt(17)
  s_waitcnt vmcnt(19)
  v_mfma_f32_16x16x32_bf16 v[112:115], a[240:243], v[48:51], v[112:115]
  v_mfma_f32_16x16x32_bf16 v[132:135], a[240:243], v[52:55], v[132:135]
  buffer_load_dwordx4 v2, s[4:7], s21 offen offset:2048 sc1 lds
  v_mfma_f32_16x16x32_bf16 v[116:119], a[244:247], v[48:51], v[116:119]
  v_mfma_f32_16x16x32_bf16 v[136:139], a[244:247], v[52:55], v[136:139]
  v_mfma_f32_16x16x32_bf16 v[120:123], a[248:251], v[48:51], v[120:123]
  v_mfma_f32_16x16x32_bf16 v[140:143], a[248:251], v[52:55], v[140:143]
  buffer_load_dwordx4 v2, s[4:7], s21 offen offset:3072 sc1 lds
  v_mfma_f32_16x16x32_bf16 v[124:127], a[252:255], v[48:51], v[124:127]
  v_mfma_f32_16x16x32_bf16 v[144:147], a[252:255], v[52:55], v[144:147]
  v_mfma_f32_16x16x32_bf16 v[128:131], v[232:235], v[48:51], v[128:131]
  s_add_u32 m0, s42, 32768
  s_add_u32 s21, s44, 32768
  buffer_load_dwordx4 v2, s[4:7], s21 offen offset:0 sc1 lds
  v_mfma_f32_16x16x32_bf16 v[148:151], v[232:235], v[52:55], v[148:151]
  s_waitcnt vmcnt(13)
  s_waitcnt vmcnt(15)
  v_mfma_f32_16x16x32_bf16 v[112:115], v[236:239], v[56:59], v[112:115]
  v_mfma_f32_16x16x32_bf16 v[132:135], v[236:239], v[60:63], v[132:135]
  buffer_load_dwordx4 v2, s[4:7], s21 offen offset:1024 sc1 lds
  v_mfma_f32_16x16x32_bf16 v[116:119], v[240:243], v[56:59], v[116:119]
  v_mfma_f32_16x16x32_bf16 v[136:139], v[240:243], v[60:63], v[136:139]
  v_mfma_f32_16x16x32_bf16 v[120:123], v[244:247], v[56:59], v[120:123]
  v_mfma_f32_16x16x32_bf16 v[140:143], v[244:247], v[60:63], v[140:143]
  buffer_load_dwordx4 v2, s[4:7], s21 offen offset:2048 sc1 lds
  v_mfma_f32_16x16x32_bf16 v[124:127], v[248:251], v[56:59], v[124:127]
  v_mfma_f32_16x16x32_bf16 v[144:147], v[248:251], v[60:63], v[144:147]
  v_mfma_f32_16x16x32_bf16 v[128:131], v[252:255], v[56:59], v[128:131]
  buffer_load_dwordx4 v2, s[4:7], s21 offen offset:3072 sc1 lds
  v_mfma_f32_16x16x32_bf16 v[148:151], v[252:255], v[60:63], v[148:151]
  s_waitcnt vmcnt(12)
  s_mov_b32 s24, 0
L_ct8:
  v_cmp_ne_u64 vcc, s[14:15], v[22:23]
  s_nop 0
  s_and_b32 s20, vcc_lo, -1
  s_cbranch_scc0 L_ok8
  s_mul_i32 s19, s36, 65536
  s_add_u32 s19, s19, 40960
  s_add_u32 s19, s19, s56
  buffer_load_dwordx2 v[22:23], v8, s[4:7], s19 offen sc1
  s_add_u32 s24, s24, 1
  s_waitcnt vmcnt(0)
  s_cmp_lt_u32 s24, 100000
  s_cbranch_scc1 L_ct8
L_ok8:
  s_add_u32 s22, s60, 0
  buffer_load_dwordx4 v[64:67], v2, s[4:7], s22 offen offset:0 sc1
  buffer_load_dwordx4 v[68:71], v15, s[4:7], s22 offen offset:0 sc1
  buffer_load_dwordx4 v[72:75], v2, s[4:7], s22 offen offset:1024 sc1
  buffer_load_dwordx4 v[76:79], v15, s[4:7], s22 offen offset:1024 sc1
  buffer_load_dwordx4 v[80:83], v2, s[4:7], s22 offen offset:2048 sc1
  buffer_load_dwordx4 v[84:87], v15, s[4:7], s22 offen offset:2048 sc1
  buffer_load_dwordx4 v[88:91], v2, s[4:7], s22 offen offset:3072 sc1
  buffer_load_dwordx4 v[92:95], v15, s[4:7], s22 offen offset:3072 sc1
  s_add_u32 s22, s60, 4096
  buffer_load_dwordx4 v[96:99], v2, s[4:7], s22 offen offset:0 sc1
  buffer_load_dwordx4 v[100:103], v15, s[4:7], s22 offen offset:0 sc1
  s_cmp_gt_u32 s18, 0
  s_cselect_b32 s19, 1, 0
  s_sub_u32 s19, s18, s19
  s_mul_i32 s19, s19, 5120
  s_add_u32 s19, s19, 133120
  v_add_u32 v224, s19, v2
  s_cmp_gt_u32 s18, 1
  s_cselect_b32 s19, 1, 0
  s_sub_u32 s19, s18, s19
  s_mul_i32 s19, s19, 5120
  s_add_u32 s19, s19, 148480
  v_add_u32 v225, s19, v2
  s_barrier
  s_cmp_eq_u32 s18, 0
  s_cbranch_scc1 L_rw9_0
  ds_write_b128 v224, v[112:115] offset:0
  ds_write_b128 v224, v[116:119] offset:1024
  ds_write_b128 v224, v[120:123] offset:2048
  ds_write_b128 v224, v[124:127] offset:3072
  ds_write_b128 v224, v[128:131] offset:4096
L_rw9_0:
  s_cmp_eq_u32 s18, 1
  s_cbranch_scc1 L_rw9_1
  ds_write_b128 v225, v[132:135] offset:0
  ds_write_b128 v225, v[136:139] offset:1024
  ds_write_b128 v225, v[140:143] offset:2048
  ds_write_b128 v225, v[144:147] offset:3072
  ds_write_b128 v225, v[148:151] offset:4096
L_rw9_1:
  s_waitcnt vmcnt(23)
  s_lshr_b32 s19, s18, 1
  s_cmp_lg_u32 s19, 0
  s_cbranch_scc1 L_rp9
  s_and_b32 s19, s18, 1
  s_mul_i32 s20, s19, 15360
  s_add_u32 s20, s20, 133120
  v_add_u32 v224, s20, v2
  v_lshlrev_b32 v164, 16, v152
  v_and_b32 v165, 0xffff0000, v152
  v_lshlrev_b32 v166, 16, v153
  v_and_b32 v167, 0xffff0000, v153
  v_lshlrev_b32 v168, 16, v154
  v_and_b32 v169, 0xffff0000, v154
  v_lshlrev_b32 v170, 16, v155
  v_and_b32 v171, 0xffff0000, v155
  v_lshlrev_b32 v172, 16, v156
  v_and_b32 v173, 0xffff0000, v156
  v_lshlrev_b32 v174, 16, v157
  v_and_b32 v175, 0xffff0000, v157
  v_lshlrev_b32 v176, 16, v158
  v_and_b32 v177, 0xffff0000, v158
  v_lshlrev_b32 v178, 16, v159
  v_and_b32 v179, 0xffff0000, v159
  v_lshlrev_b32 v180, 16, v160
  v_and_b32 v181, 0xffff0000, v160
  v_lshlrev_b32 v182, 16, v161
  v_and_b32 v183, 0xffff0000, v161
  s_waitcnt lgkmcnt(0)
  s_cmp_eq_u32 s19, 0
  s_cbranch_scc1 L_r09
  v_pk_add_f32 v[112:113], v[132:133], v[164:165]
  v_pk_add_f32 v[114:115], v[134:135], v[166:167]
  v_pk_add_f32 v[116:117], v[136:137], v[168:169]
  v_pk_add_f32 v[118:119], v[138:139], v[170:171]
  v_pk_add_f32 v[120:121], v[140:141], v[172:173]
  v_pk_add_f32 v[122:123], v[142:143], v[174:175]
  v_pk_add_f32 v[124:125], v[144:145], v[176:177]
  v_pk_add_f32 v[126:127], v[146:147], v[178:179]
  v_pk_add_f32 v[128:129], v[148:149], v[180:181]
  v_pk_add_f32 v[130:131], v[150:151], v[182:183]
  s_branch L_rp9
L_r09:
  v_pk_add_f32 v[112:113], v[112:113], v[164:165]
  v_pk_add_f32 v[114:115], v[114:115], v[166:167]
  v_pk_add_f32 v[116:117], v[116:117], v[168:169]
  v_pk_add_f32 v[118:119], v[118:119], v[170:171]
  v_pk_add_f32 v[120:121], v[120:121], v[172:173]
  v_pk_add_f32 v[122:123], v[122:123], v[174:175]
  v_pk_add_f32 v[124:125], v[124:125], v[176:177]
  v_pk_add_f32 v[126:127], v[126:127], v[178:179]
  v_pk_add_f32 v[128:129], v[128:129], v[180:181]
  v_pk_add_f32 v[130:131], v[130:131], v[182:183]
L_rp9:
  s_waitcnt lgkmcnt(0)
  s_barrier
  s_lshr_b32 s19, s18, 1
  s_cmp_lg_u32 s19, 0
  s_cbranch_scc1 L_rf9
  ds_read_b128 v[164:167], v224 offset:0
  ds_read_b128 v[168:171], v224 offset:1024
  ds_read_b128 v[172:175], v224 offset:2048
  ds_read_b128 v[176:179], v224 offset:3072
  ds_read_b128 v[180:183], v224 offset:4096
  ds_read_b128 v[184:187], v224 offset:5120
  ds_read_b128 v[188:191], v224 offset:6144
  ds_read_b128 v[192:195], v224 offset:7168
  ds_read_b128 v[196:199], v224 offset:8192
  ds_read_b128 v[200:203], v224 offset:9216
  ds_read_b128 v[204:207], v224 offset:10240
  ds_read_b128 v[208:211], v224 offset:11264
  ds_read_b128 v[212:215], v224 offset:12288
  ds_read_b128 v[216:219], v224 offset:13312
  ds_read_b128 v[220:223], v224 offset:14336
  s_waitcnt lgkmcnt(10)
  v_pk_add_f32 v[112:113], v[112:113], v[164:165]
  v_pk_add_f32 v[114:115], v[114:115], v[166:167]
  v_pk_add_f32 v[116:117], v[116:117], v[168:169]
  v_pk_add_f32 v[118:119], v[118:119], v[170:171]
  v_pk_add_f32 v[120:121], v[120:121], v[172:173]
  v_pk_add_f32 v[122:123], v[122:123], v[174:175]
  v_pk_add_f32 v[124:125], v[124:125], v[176:177]
  v_pk_add_f32 v[126:127], v[126:127], v[178:179]
  v_pk_add_f32 v[128:129], v[128:129], v[180:181]
  v_pk_add_f32 v[130:131], v[130:131], v[182:183]
  s_waitcnt lgkmcnt(5)
  v_pk_add_f32 v[112:113], v[112:113], v[184:185]
  v_pk_add_f32 v[114:115], v[114:115], v[186:187]
  v_pk_add_f32 v[116:117], v[116:117], v[188:189]
  v_pk_add_f32 v[118:119], v[118:119], v[190:191]
  v_pk_add_f32 v[120:121], v[120:121], v[192:193]
  v_pk_add_f32 v[122:123], v[122:123], v[194:195]
  v_pk_add_f32 v[124:125], v[124:125], v[196:197]
  v_pk_add_f32 v[126:127], v[126:127], v[198:199]
  v_pk_add_f32 v[128:129], v[128:129], v[200:201]
  v_pk_add_f32 v[130:131], v[130:131], v[202:203]
  s_waitcnt lgkmcnt(0)
  v_pk_add_f32 v[112:113], v[112:113], v[204:205]
  v_pk_add_f32 v[114:115], v[114:115], v[206:207]
  v_pk_add_f32 v[116:117], v[116:117], v[208:209]
  v_pk_add_f32 v[118:119], v[118:119], v[210:211]
  v_pk_add_f32 v[120:121], v[120:121], v[212:213]
  v_pk_add_f32 v[122:123], v[122:123], v[214:215]
  v_pk_add_f32 v[124:125], v[124:125], v[216:217]
  v_pk_add_f32 v[126:127], v[126:127], v[218:219]
  v_pk_add_f32 v[128:129], v[128:129], v[220:221]
  v_pk_add_f32 v[130:131], v[130:131], v[222:223]
  v_cvt_pk_bf16_f32 v164, v112, v113
  v_cvt_pk_bf16_f32 v165, v114, v115
  v_cvt_pk_bf16_f32 v166, v116, v117
  v_cvt_pk_bf16_f32 v167, v118, v119
  v_cvt_pk_bf16_f32 v168, v120, v121
  v_cvt_pk_bf16_f32 v169, v122, v123
  v_cvt_pk_bf16_f32 v170, v124, v125
  v_cvt_pk_bf16_f32 v171, v126, v127
  v_cvt_pk_bf16_f32 v172, v128, v129
  v_cvt_pk_bf16_f32 v173, v130, v131
  s_cmp_lg_u32 s36, 0
  s_cbranch_scc1 L_fin0
  s_mul_i32 s19, s36, 5242880
  s_add_u32 s19, s19, 15700992
  s_add_u32 s19, s19, s53
  s_mul_i32 s20, s36, 5242880
  s_add_u32 s20, s20, 15700992
  s_add_u32 s20, s20, s54
  buffer_store_dwordx4 v[164:167], v2, s[4:7], s19 offen sc1
  buffer_store_dwordx4 v[168:171], v2, s[4:7], s19 offen offset:1024 sc1
  v_mov_b32 v174, v172
  v_mov_b32 v175, v173
  v_mov_b32 v6, v172
  v_mov_b32 v7, v173
  s_nop 0
  v_permlane16_swap_b32 v6, v174
  v_permlane16_swap_b32 v7, v175
  s_mov_b64 exec, s[34:35]
  buffer_store_dwordx4 v[172:175], v11, s[4:7], s20 offen sc1
  s_mov_b64 exec, -1
  s_and_b32 s19, s18, 1
  s_add_u32 s19, s19, s52
  s_lshl_b32 s59, s19, 10
  s_lshl_b32 s20, s39, 7
  s_add_u32 s59, s59, s20
  s_mul_i32 s19, s36, 262144
  s_add_u32 s19, s19, 40604672
  s_add_u32 s19, s19, s59
  v_mov_b32 v132, 0
  v_mov_b32 v133, 0
  v_dot2c_f32_bf16 v132, s23, v164
  v_dot2c_f32_bf16 v133, v164, v164
  v_dot2c_f32_bf16 v132, s23, v165
  v_dot2c_f32_bf16 v133, v165, v165
  v_dot2c_f32_bf16 v132, s23, v166
  v_dot2c_f32_bf16 v133, v166, v166
  v_dot2c_f32_bf16 v132, s23, v167
  v_dot2c_f32_bf16 v133, v167, v167
  v_dot2c_f32_bf16 v132, s23, v168
  v_dot2c_f32_bf16 v133, v168, v168
  v_dot2c_f32_bf16 v132, s23, v169
  v_dot2c_f32_bf16 v133, v169, v169
  v_dot2c_f32_bf16 v132, s23, v170
  v_dot2c_f32_bf16 v133, v170, v170
  v_dot2c_f32_bf16 v132, s23, v171
  v_dot2c_f32_bf16 v133, v171, v171
  v_dot2c_f32_bf16 v132, s23, v172
  v_dot2c_f32_bf16 v133, v172, v172
  v_dot2c_f32_bf16 v132, s23, v173
  v_dot2c_f32_bf16 v133, v173, v173
  s_nop 2
  v_permlane32_swap_b32 v132, v133
  v_add_f32 v132, v132, v133
  v_mov_b32 v134, v132
  s_nop 1
  v_permlane16_swap_b32 v132, v134
  v_add_f32 v132, v132, v134
  v_mov_b32 v133, v132
  s_nop 1
  v_permlane32_swap_b32 v132, v133
  s_mov_b64 exec, 0xffff
  buffer_store_dwordx2 v[132:133], v9, s[4:7], s19 offen sc1
  s_mov_b64 exec, -1
  s_branch L_rf9
L_fin0:
  v_mul_u32_u24 v132, 1280, v3
  v_lshl_add_u32 v133, v4, 3, v132
  v_lshl_add_u32 v132, v4, 4, v132
  s_and_b32 s19, s18, 1
  s_add_u32 s19, s19, s52
  s_add_u32 s19, s19, 0
  s_mul_i32 s20, s19, 20480
  s_lshr_b32 s19, s39, 1
  s_mul_i32 s19, s19, 320
  s_add_u32 s19, s19, s20
  s_and_b32 s20, s39, 1
  s_mul_i32 s59, s20, 192
  s_add_u32 s59, s59, s19
  s_lshl_b32 s20, s20, 5
  s_add_u32 s20, s20, s19
  buffer_store_dwordx4 v[164:167], v132, s[8:11], s59 offen
  buffer_store_dwordx4 v[168:171], v132, s[8:11], s59 offen offset:64
  buffer_store_dwordx2 v[172:173], v133, s[8:11], s20 offen offset:128
L_rf9:
  s_waitcnt vmcnt(8)
  v_mfma_f32_16x16x32_bf16 v[112:115], a[36:39], v[64:67], 0
  v_mfma_f32_16x16x32_bf16 v[132:135], a[36:39], v[68:71], 0
  buffer_load_dwordx4 v[104:107], v2, s[4:7], s22 offen offset:1024 sc1
  v_mfma_f32_16x16x32_bf16 v[116:119], a[40:43], v[64:67], 0
  v_mfma_f32_16x16x32_bf16 v[136:139], a[40:43], v[68:71], 0
  v_mfma_f32_16x16x32_bf16 v[120:123], a[44:47], v[64:67], 0
  v_mfma_f32_16x16x32_bf16 v[140:143], a[44:47], v[68:71], 0
  buffer_load_dwordx4 v[108:111], v15, s[4:7], s22 offen offset:1024 sc1
  v_mfma_f32_16x16x32_bf16 v[124:127], a[48:51], v[64:67], 0
  v_mfma_f32_16x16x32_bf16 v[144:147], a[48:51], v[68:71], 0
  v_mfma_f32_16x16x32_bf16 v[128:131], a[52:55], v[64:67], 0
  buffer_load_dwordx4 v[48:51], v2, s[4:7], s22 offen offset:2048 sc1
  v_mfma_f32_16x16x32_bf16 v[148:151], a[52:55], v[68:71], 0
  s_waitcnt vmcnt(9)
  v_mfma_f32_16x16x32_bf16 v[112:115], a[56:59], v[72:75], v[112:115]
  v_mfma_f32_16x16x32_bf16 v[132:135], a[56:59], v[76:79], v[132:135]
  buffer_load_dwordx4 v[52:55], v15, s[4:7], s22 offen offset:2048 sc1
  v_mfma_f32_16x16x32_bf16 v[116:119], a[60:63], v[72:75], v[116:119]
  v_mfma_f32_16x16x32_bf16 v[136:139], a[60:63], v[76:79], v[136:139]
  v_mfma_f32_16x16x32_bf16 v[120:123], a[64:67], v[72:75], v[120:123]
  v_mfma_f32_16x16x32_bf16 v[140:143], a[64:67], v[76:79], v[140:143]
  buffer_load_dwordx4 v[56:59], v2, s[4:7], s22 offen offset:3072 sc1
  v_mfma_f32_16x16x32_bf16 v[124:127], a[68:71], v[72:75], v[124:127]
  v_mfma_f32_16x16x32_bf16 v[144:147], a[68:71], v[76:79], v[144:147]
  v_mfma_f32_16x16x32_bf16 v[128:131], a[72:75], v[72:75], v[128:131]
  buffer_load_dwordx4 v[60:63], v15, s[4:7], s22 offen offset:3072 sc1
  v_mfma_f32_16x16x32_bf16 v[148:151], a[72:75], v[76:79], v[148:151]
  s_waitcnt vmcnt(10)
  v_mfma_f32_16x16x32_bf16 v[112:115], a[76:79], v[80:83], v[112:115]
  v_mfma_f32_16x16x32_bf16 v[132:135], a[76:79], v[84:87], v[132:135]
  s_add_u32 m0, s42, 49152
  s_add_u32 s21, s44, 49152
  buffer_load_dwordx4 v2, s[4:7], s21 offen offset:0 sc1 lds
  v_mfma_f32_16x16x32_bf16 v[116:119], a[80:83], v[80:83], v[116:119]
  v_mfma_f32_16x16x32_bf16 v[136:139], a[80:83], v[84:87], v[136:139]
  v_mfma_f32_16x16x32_bf16 v[120:123], a[84:87], v[80:83], v[120:123]
  v_mfma_f32_16x16x32_bf16 v[140:143], a[84:87], v[84:87], v[140:143]
  buffer_load_dwordx4 v2, s[4:7], s21 offen offset:1024 sc1 lds
  v_mfma_f32_16x16x32_bf16 v[124:127], a[88:91], v[80:83], v[124:127]
  v_mfma_f32_16x16x32_bf16 v[144:147], a[88:91], v[84:87], v[144:147]
  v_mfma_f32_16x16x32_bf16 v[128:131], a[92:95], v[80:83], v[128:131]
  buffer_load_dwordx4 v2, s[4:7], s21 offen offset:2048 sc1 lds
  v_mfma_f32_16x16x32_bf16 v[148:151], a[92:95], v[84:87], v[148:151]
  s_lshr_b32 s19, s18, 1
  s_cmp_lg_u32 s19, 0
  s_cbranch_scc1 L_rs9
  s_waitcnt vmcnt(9)
  s_mul_i32 s19, s36, 65536
  s_add_u32 s19, s19, 49152
  s_add_u32 s19, s19, s56
  s_and_b32 s20, s18, 1
  s_lshl_b32 s59, s39, 1
  s_add_u32 s59, s59, s20
  s_lshl_b32 s59, s59, 3
  s_add_u32 s19, s19, s59
  v_mov_b32 v20, s14
  v_mov_b32 v21, s15
  s_mov_b64 exec, 1
  buffer_store_dwordx2 v[20:21], v5, s[4:7], s19 offen sc1
  s_mov_b64 exec, -1
L_rs9:
  s_waitcnt vmcnt(11)
  v_mfma_f32_16x16x32_bf16 v[112:115], a[96:99], v[88:91], v[112:115]
  v_mfma_f32_16x16x32_bf16 v[132:135], a[96:99], v[92:95], v[132:135]
  buffer_load_dwordx4 v2, s[4:7], s21 offen offset:3072 sc1 lds
  v_mfma_f32_16x16x32_bf16 v[116:119], a[100:103], v[88:91], v[116:119]
  v_mfma_f32_16x16x32_bf16 v[136:139], a[100:103], v[92:95], v[136:139]
  v_mfma_f32_16x16x32_bf16 v[120:123], a[104:107], v[88:91], v[120:123]
  v_mfma_f32_16x16x32_bf16 v[140:143], a[104:107], v[92:95], v[140:143]
  s_add_u32 m0, s42, 65536
  s_add_u32 s21, s44, 65536
  buffer_load_dwordx4 v2, s[4:7], s21 offen offset:0 sc1 lds
  v_mfma_f32_16x16x32_bf16 v[124:127], a[108:111], v[88:91], v[124:127]
  v_mfma_f32_16x16x32_bf16 v[144:147], a[108:111], v[92:95], v[144:147]
  v_mfma_f32_16x16x32_bf16 v[128:131], a[112:115], v[88:91], v[128:131]
  buffer_load_dwordx4 v2, s[4:7], s21 offen offset:1024 sc1 lds
  v_mfma_f32_16x16x32_bf16 v[148:151], a[112:115], v[92:95], v[148:151]
  s_waitcnt vmcnt(12)
  v_mfma_f32_16x16x32_bf16 v[112:115], a[116:119], v[96:99], v[112:115]
  v_mfma_f32_16x16x32_bf16 v[132:135], a[116:119], v[100:103], v[132:135]
  buffer_load_dwordx4 v2, s[4:7], s21 offen offset:2048 sc1 lds
  v_mfma_f32_16x16x32_bf16 v[116:119], a[120:123], v[96:99], v[116:119]
  v_mfma_f32_16x16x32_bf16 v[136:139], a[120:123], v[100:103], v[136:139]
  v_mfma_f32_16x16x32_bf16 v[120:123], a[124:127], v[96:99], v[120:123]
  v_mfma_f32_16x16x32_bf16 v[140:143], a[124:127], v[100:103], v[140:143]
  buffer_load_dwordx4 v2, s[4:7], s21 offen offset:3072 sc1 lds
  v_mfma_f32_16x16x32_bf16 v[124:127], a[128:131], v[96:99], v[124:127]
  v_mfma_f32_16x16x32_bf16 v[144:147], a[128:131], v[100:103], v[144:147]
  v_mfma_f32_16x16x32_bf16 v[128:131], a[132:135], v[96:99], v[128:131]
  s_add_u32 m0, s40, 81920
  s_add_u32 s21, s45, 81920
  buffer_load_dwordx4 v2, s[4:7], s21 offen offset:0 sc1 lds
  v_mfma_f32_16x16x32_bf16 v[148:151], a[132:135], v[100:103], v[148:151]
  s_waitcnt vmcnt(13)
  v_mfma_f32_16x16x32_bf16 v[112:115], a[136:139], v[104:107], v[112:115]
  v_mfma_f32_16x16x32_bf16 v[132:135], a[136:139], v[108:111], v[132:135]
  s_add_u32 s22, s60, 8192
  buffer_load_dwordx4 v[64:67], v2, s[4:7], s22 offen offset:0 sc1
  v_mfma_f32_16x16x32_bf16 v[116:119], a[140:143], v[104:107], v[116:119]
  v_mfma_f32_16x16x32_bf16 v[136:139], a[140:143], v[108:111], v[136:139]
  v_mfma_f32_16x16x32_bf16 v[120:123], a[144:147], v[104:107], v[120:123]
  v_mfma_f32_16x16x32_bf16 v[140:143], a[144:147], v[108:111], v[140:143]
  buffer_load_dwordx4 v[68:71], v15, s[4:7], s22 offen offset:0 sc1
  v_mfma_f32_16x16x32_bf16 v[124:127], a[148:151], v[104:107], v[124:127]
  v_mfma_f32_16x16x32_bf16 v[144:147], a[148:151], v[108:111], v[144:147]
  v_mfma_f32_16x16x32_bf16 v[128:131], a[152:155], v[104:107], v[128:131]
  buffer_load_dwordx4 v[72:75], v2, s[4:7], s22 offen offset:1024 sc1
  v_mfma_f32_16x16x32_bf16 v[148:151], a[152:155], v[108:111], v[148:151]
  s_waitcnt vmcnt(14)
  v_mfma_f32_16x16x32_bf16 v[112:115], a[156:159], v[48:51], v[112:115]
  v_mfma_f32_16x16x32_bf16 v[132:135], a[156:159], v[52:55], v[132:135]
  buffer_load_dwordx4 v[76:79], v15, s[4:7], s22 offen offset:1024 sc1
  v_mfma_f32_16x16x32_bf16 v[116:119], a[160:163], v[48:51], v[116:119]
  v_mfma_f32_16x16x32_bf16 v[136:139], a[160:163], v[52:55], v[136:139]
  v_mfma_f32_16x16x32_bf16 v[120:123], a[164:167], v[48:51], v[120:123]
  v_mfma_f32_16x16x32_bf16 v[140:143], a[164:167], v[52:55], v[140:143]
  buffer_load_dwordx4 v[80:83], v2, s[4:7], s22 offen offset:2048 sc1
  v_mfma_f32_16x16x32_bf16 v[124:127], a[168:171], v[48:51], v[124:127]
  v_mfma_f32_16x16x32_bf16 v[144:147], a[168:171], v[52:55], v[144:147]
  v_mfma_f32_16x16x32_bf16 v[128:131], a[172:175], v[48:51], v[128:131]
  buffer_load_dwordx4 v[84:87], v15, s[4:7], s22 offen offset:2048 sc1
  v_mfma_f32_16x16x32_bf16 v[148:151], a[172:175], v[52:55], v[148:151]
  s_waitcnt vmcnt(15)
  v_mfma_f32_16x16x32_bf16 v[112:115], a[176:179], v[56:59], v[112:115]
  v_mfma_f32_16x16x32_bf16 v[132:135], a[176:179], v[60:63], v[132:135]
  buffer_load_dwordx4 v[88:91], v2, s[4:7], s22 offen offset:3072 sc1
  v_mfma_f32_16x16x32_bf16 v[116:119], a[180:183], v[56:59], v[116:119]
  v_mfma_f32_16x16x32_bf16 v[136:139], a[180:183], v[60:63], v[136:139]
  v_mfma_f32_16x16x32_bf16 v[120:123], a[184:187], v[56:59], v[120:123]
  v_mfma_f32_16x16x32_bf16 v[140:143], a[184:187], v[60:63], v[140:143]
  buffer_load_dwordx4 v[92:95], v15, s[4:7], s22 offen offset:3072 sc1
  v_mfma_f32_16x16x32_bf16 v[124:127], a[188:191], v[56:59], v[124:127]
  v_mfma_f32_16x16x32_bf16 v[144:147], a[188:191], v[60:63], v[144:147]
  v_mfma_f32_16x16x32_bf16 v[128:131], a[0:3], v[56:59], v[128:131]
  s_add_u32 s22, s60, 12288
  buffer_load_dwordx4 v[96:99], v2, s[4:7], s22 offen offset:0 sc1
  v_mfma_f32_16x16x32_bf16 v[148:151], a[0:3], v[60:63], v[148:151]
  s_waitcnt vmcnt(7)
  v_mfma_f32_16x16x32_bf16 v[112:115], a[4:7], v[64:67], v[112:115]
  v_mfma_f32_16x16x32_bf16 v[132:135], a[4:7], v[68:71], v[132:135]
  buffer_load_dwordx4 v[100:103], v15, s[4:7], s22 offen offset:0 sc1
  v_mfma_f32_16x16x32_bf16 v[116:119], a[8:11], v[64:67], v[116:119]
  v_mfma_f32_16x16x32_bf16 v[136:139], a[8:11], v[68:71], v[136:139]
  v_mfma_f32_16x16x32_bf16 v[120:123], a[12:15], v[64:67], v[120:123]
  v_mfma_f32_16x16x32_bf16 v[140:143], a[12:15], v[68:71], v[140:143]
  s_add_u32 s22, s60, 12288
  s_add_u32 s22, s22, s62
  buffer_load_dwordx4 v[104:107], v2, s[4:7], s22 offen offset:1024 sc1
  v_mfma_f32_16x16x32_bf16 v[124:127], a[16:19], v[64:67], v[124:127]
  v_mfma_f32_16x16x32_bf16 v[144:147], a[16:19], v[68:71], v[144:147]
  v_mfma_f32_16x16x32_bf16 v[128:131], a[20:23], v[64:67], v[128:131]
  buffer_load_dwordx4 v[108:111], v15, s[4:7], s22 offen offset:1024 sc1
  v_mfma_f32_16x16x32_bf16 v[148:151], a[20:23], v[68:71], v[148:151]
  s_waitcnt vmcnt(8)
  v_mfma_f32_16x16x32_bf16 v[112:115], a[24:27], v[72:75], v[112:115]
  v_mfma_f32_16x16x32_bf16 v[132:135], a[24:27], v[76:79], v[132:135]
  v_mfma_f32_16x16x32_bf16 v[116:119], a[28:31], v[72:75], v[116:119]
  v_mfma_f32_16x16x32_bf16 v[136:139], a[28:31], v[76:79], v[136:139]
  v_mfma_f32_16x16x32_bf16 v[120:123], a[32:35], v[72:75], v[120:123]
  v_mfma_f32_16x16x32_bf16 v[140:143], a[32:35], v[76:79], v[140:143]
  s_mul_i32 s19, s36, 5242880
  s_add_u32 s19, s19, 14390272
  s_add_u32 s19, s19, s53
  s_mul_i32 s20, s36, 5242880
  s_add_u32 s20, s20, 14390272
  s_add_u32 s20, s20, s54
  buffer_load_dwordx4 v[152:155], v2, s[4:7], s19 offen sc1
  buffer_load_dwordx4 v[156:159], v2, s[4:7], s19 offen offset:1024 sc1
  buffer_load_dwordx2 v[160:161], v11, s[4:7], s20 offen sc1
  v_mfma_f32_16x16x32_bf16 v[124:127], a[192:195], v[72:75], v[124:127]
  v_mfma_f32_16x16x32_bf16 v[144:147], a[192:195], v[76:79], v[144:147]
  v_mfma_f32_16x16x32_bf16 v[128:131], a[196:199], v[72:75], v[128:131]
  v_mfma_f32_16x16x32_bf16 v[148:151], a[196:199], v[76:79], v[148:151]
  s_waitcnt vmcnt(9)
  v_mfma_f32_16x16x32_bf16 v[112:115], a[200:203], v[80:83], v[112:115]
  v_mfma_f32_16x16x32_bf16 v[132:135], a[200:203], v[84:87], v[132:135]
  v_mfma_f32_16x16x32_bf16 v[116:119], a[204:207], v[80:83], v[116:119]
  v_mfma_f32_16x16x32_bf16 v[136:139], a[204:207], v[84:87], v[136:139]
  v_mfma_f32_16x16x32_bf16 v[120:123], a[208:211], v[80:83], v[120:123]
  v_mfma_f32_16x16x32_bf16 v[140:143], a[208:211], v[84:87], v[140:143]
  v_mfma_f32_16x16x32_bf16 v[124:127], a[212:215], v[80:83], v[124:127]
  v_mfma_f32_16x16x32_bf16 v[144:147], a[212:215], v[84:87], v[144:147]
  v_mfma_f32_16x16x32_bf16 v[128:131], a[216:219], v[80:83], v[128:131]
  v_mfma_f32_16x16x32_bf16 v[148:151], a[216:219], v[84:87], v[148:151]
  s_mul_i32 s19, s36, 65536
  s_add_u32 s19, s19, 49152
  s_add_u32 s19, s19, s55
  buffer_load_dwordx2 v[22:23], v8, s[4:7], s19 offen sc1
  s_mul_i32 s59, s51, 20480
  s_mul_i32 s58, s36, 5242880
  s_add_u32 s58, s58, 15700992
  s_add_u32 s58, s58, s59
  s_waitcnt vmcnt(8)
  v_mfma_f32_16x16x32_bf16 v[112:115], a[220:223], v[88:91], v[112:115]
  v_mfma_f32_16x16x32_bf16 v[132:135], a[220:223], v[92:95], v[132:135]
  v_mfma_f32_16x16x32_bf16 v[116:119], a[224:227], v[88:91], v[116:119]
  v_mfma_f32_16x16x32_bf16 v[136:139], a[224:227], v[92:95], v[136:139]
  v_mfma_f32_16x16x32_bf16 v[120:123], a[228:231], v[88:91], v[120:123]
  v_mfma_f32_16x16x32_bf16 v[140:143], a[228:231], v[92:95], v[140:143]
  v_mfma_f32_16x16x32_bf16 v[124:127], a[232:235], v[88:91], v[124:127]
  v_mfma_f32_16x16x32_bf16 v[144:147], a[232:235], v[92:95], v[144:147]
  v_mfma_f32_16x16x32_bf16 v[128:131], a[236:239], v[88:91], v[128:131]
  v_mfma_f32_16x16x32_bf16 v[148:151], a[236:239], v[92:95], v[148:151]
  s_waitcnt vmcnt(6)
  v_mfma_f32_16x16x32_bf16 v[112:115], a[240:243], v[96:99], v[112:115]
  v_mfma_f32_16x16x32_bf16 v[132:135], a[240:243], v[100:103], v[132:135]
  v_mfma_f32_16x16x32_bf16 v[116:119], a[244:247], v[96:99], v[116:119]
  v_mfma_f32_16x16x32_bf16 v[136:139], a[244:247], v[100:103], v[136:139]
  v_mfma_f32_16x16x32_bf16 v[120:123], a[248:251], v[96:99], v[120:123]
  v_mfma_f32_16x16x32_bf16 v[140:143], a[248:251], v[100:103], v[140:143]
  v_mfma_f32_16x16x32_bf16 v[124:127], a[252:255], v[96:99], v[124:127]
  v_mfma_f32_16x16x32_bf16 v[144:147], a[252:255], v[100:103], v[144:147]
  v_mfma_f32_16x16x32_bf16 v[128:131], v[232:235], v[96:99], v[128:131]
  v_mfma_f32_16x16x32_bf16 v[148:151], v[232:235], v[100:103], v[148:151]
  s_waitcnt vmcnt(4)
  v_mfma_f32_16x16x32_bf16 v[112:115], v[236:239], v[104:107], v[112:115]
  v_mfma_f32_16x16x32_bf16 v[132:135], v[236:239], v[108:111], v[132:135]
  v_mfma_f32_16x16x32_bf16 v[116:119], v[240:243], v[104:107], v[116:119]
  v_mfma_f32_16x16x32_bf16 v[136:139], v[240:243], v[108:111], v[136:139]
  v_mfma_f32_16x16x32_bf16 v[120:123], v[244:247], v[104:107], v[120:123]
  v_mfma_f32_16x16x32_bf16 v[140:143], v[244:247], v[108:111], v[140:143]
  v_mfma_f32_16x16x32_bf16 v[124:127], v[248:251], v[104:107], v[124:127]
  v_mfma_f32_16x16x32_bf16 v[144:147], v[248:251], v[108:111], v[144:147]
  v_mfma_f32_16x16x32_bf16 v[128:131], v[252:255], v[104:107], v[128:131]
  v_mfma_f32_16x16x32_bf16 v[148:151], v[252:255], v[108:111], v[148:151]
  s_cmp_eq_u32 s36, 1
  s_cbranch_scc1 L_ok10
  s_waitcnt vmcnt(0)
  s_mov_b32 s24, 0
L_ct10:
  v_cmp_ne_u64 vcc, s[14:15], v[22:23]
  s_nop 0
  s_and_b32 s20, vcc_lo, 0xffff
  s_cbranch_scc0 L_ok10
  s_mul_i32 s19, s36, 65536
  s_add_u32 s19, s19, 49152
  s_add_u32 s19, s19, s55
  buffer_load_dwordx2 v[22:23], v8, s[4:7], s19 offen sc1
  s_add_u32 s24, s24, 1
  s_waitcnt vmcnt(0)
  s_cmp_lt_u32 s24, 100000
  s_cbranch_scc1 L_ct10
L_ok10:
  s_lshl_b32 s59, s51, 10
  s_mul_i32 s19, s36, 262144
  s_add_u32 s19, s19, 40604672
  s_add_u32 s19, s19, s59
  buffer_load_dwordx2 v[40:41], v10, s[4:7], s19 offen offset:0 sc1
  buffer_load_dwordx2 v[42:43], v10, s[4:7], s19 offen offset:128 sc1
  buffer_load_dwordx2 v[44:45], v10, s[4:7], s19 offen offset:1024 sc1
  buffer_load_dwordx2 v[46:47], v10, s[4:7], s19 offen offset:1152 sc1
  s_add_u32 s22, s58, 0
  buffer_load_dwordx4 v[48:51], v2, s[4:7], s22 offen offset:0 sc1
  buffer_load_dwordx4 v[52:55], v14, s[4:7], s22 offen offset:0 sc1
  buffer_load_dwordx4 v[56:59], v2, s[4:7], s22 offen offset:1024 sc1
  buffer_load_dwordx4 v[60:63], v14, s[4:7], s22 offen offset:1024 sc1
  buffer_load_dwordx4 v[64:67], v2, s[4:7], s22 offen offset:2048 sc1
  buffer_load_dwordx4 v[68:71], v14, s[4:7], s22 offen offset:2048 sc1
  buffer_load_dwordx4 v[72:75], v2, s[4:7], s22 offen offset:3072 sc1
  buffer_load_dwordx4 v[76:79], v14, s[4:7], s22 offen offset:3072 sc1
  s_add_u32 s22, s58, 4096
  buffer_load_dwordx4 v[80:83], v2, s[4:7], s22 offen offset:0 sc1
  s_cmp_gt_u32 s18, 2
  s_cselect_b32 s19, 1, 0
  s_sub_u32 s19, s18, s19
  s_mul_i32 s19, s19, 5120
  s_add_u32 s19, s19, 133120
  v_add_u32 v224, s19, v2
  s_cmp_gt_u32 s18, 3
  s_cselect_b32 s19, 1, 0
  s_sub_u32 s19, s18, s19
  s_mul_i32 s19, s19, 5120
  s_add_u32 s19, s19, 148480
  v_add_u32 v225, s19, v2
  s_barrier
  s_cmp_eq_u32 s18, 2
  s_cbranch_scc1 L_rw11_0
  ds_write_b128 v224, v[112:115] offset:0
  ds_write_b128 v224, v[116:119] offset:1024
  ds_write_b128 v224, v[120:123] offset:2048
  ds_write_b128 v224, v[124:127] offset:3072
  ds_write_b128 v224, v[128:131] offset:4096
L_rw11_0:
  s_cmp_eq_u32 s18, 3
  s_cbranch_scc1 L_rw11_1
  ds_write_b128 v225, v[132:135] offset:0
  ds_write_b128 v225, v[136:139] offset:1024
  ds_write_b128 v225, v[140:143] offset:2048
  ds_write_b128 v225, v[144:147] offset:3072
  ds_write_b128 v225, v[148:151] offset:4096
L_rw11_1:
  s_waitcnt vmcnt(14)
  s_lshr_b32 s19, s18, 1
  s_cmp_lg_u32 s19, 1
  s_cbranch_scc1 L_rp11
  s_and_b32 s19, s18, 1
  s_mul_i32 s20, s19, 15360
  s_add_u32 s20, s20, 133120
  v_add_u32 v224, s20, v2
  v_lshlrev_b32 v164, 16, v152
  v_and_b32 v165, 0xffff0000, v152
  v_lshlrev_b32 v166, 16, v153
  v_and_b32 v167, 0xffff0000, v153
  v_lshlrev_b32 v168, 16, v154
  v_and_b32 v169, 0xffff0000, v154
  v_lshlrev_b32 v170, 16, v155
  v_and_b32 v171, 0xffff0000, v155
  v_lshlrev_b32 v172, 16, v156
  v_and_b32 v173, 0xffff0000, v156
  v_lshlrev_b32 v174, 16, v157
  v_and_b32 v175, 0xffff0000, v157
  v_lshlrev_b32 v176, 16, v158
  v_and_b32 v177, 0xffff0000, v158
  v_lshlrev_b32 v178, 16, v159
  v_and_b32 v179, 0xffff0000, v159
  v_lshlrev_b32 v180, 16, v160
  v_and_b32 v181, 0xffff0000, v160
  v_lshlrev_b32 v182, 16, v161
  v_and_b32 v183, 0xffff0000, v161
  s_waitcnt lgkmcnt(0)
  s_cmp_eq_u32 s19, 0
  s_cbranch_scc1 L_r011
  v_pk_add_f32 v[112:113], v[132:133], v[164:165]
  v_pk_add_f32 v[114:115], v[134:135], v[166:167]
  v_pk_add_f32 v[116:117], v[136:137], v[168:169]
  v_pk_add_f32 v[118:119], v[138:139], v[170:171]
  v_pk_add_f32 v[120:121], v[140:141], v[172:173]
  v_pk_add_f32 v[122:123], v[142:143], v[174:175]
  v_pk_add_f32 v[124:125], v[144:145], v[176:177]
  v_pk_add_f32 v[126:127], v[146:147], v[178:179]
  v_pk_add_f32 v[128:129], v[148:149], v[180:181]
  v_pk_add_f32 v[130:131], v[150:151], v[182:183]
  s_branch L_rp11
L_r011:
  v_pk_add_f32 v[112:113], v[112:113], v[164:165]
  v_pk_add_f32 v[114:115], v[114:115], v[166:167]
  v_pk_add_f32 v[116:117], v[116:117], v[168:169]
  v_pk_add_f32 v[118:119], v[118:119], v[170:171]
  v_pk_add_f32 v[120:121], v[120:121], v[172:173]
  v_pk_add_f32 v[122:123], v[122:123], v[174:175]
  v_pk_add_f32 v[124:125], v[124:125], v[176:177]
  v_pk_add_f32 v[126:127], v[126:127], v[178:179]
  v_pk_add_f32 v[128:129], v[128:129], v[180:181]
  v_pk_add_f32 v[130:131], v[130:131], v[182:183]
L_rp11:
  s_waitcnt lgkmcnt(0)
  s_barrier
  s_lshr_b32 s19, s18, 1
  s_cmp_lg_u32 s19, 1
  s_cbranch_scc1 L_rf11
  ds_read_b128 v[164:167], v224 offset:0
  ds_read_b128 v[168:171], v224 offset:1024
  ds_read_b128 v[172:175], v224 offset:2048
  ds_read_b128 v[176:179], v224 offset:3072
  ds_read_b128 v[180:183], v224 offset:4096
  ds_read_b128 v[184:187], v224 offset:5120
  ds_read_b128 v[188:191], v224 offset:6144
  ds_read_b128 v[192:195], v224 offset:7168
  ds_read_b128 v[196:199], v224 offset:8192
  ds_read_b128 v[200:203], v224 offset:9216
  ds_read_b128 v[204:207], v224 offset:10240
  ds_read_b128 v[208:211], v224 offset:11264
  ds_read_b128 v[212:215], v224 offset:12288
  ds_read_b128 v[216:219], v224 offset:13312
  ds_read_b128 v[220:223], v224 offset:14336
  s_waitcnt lgkmcnt(10)
  v_pk_add_f32 v[112:113], v[112:113], v[164:165]
  v_pk_add_f32 v[114:115], v[114:115], v[166:167]
  v_pk_add_f32 v[116:117], v[116:117], v[168:169]
  v_pk_add_f32 v[118:119], v[118:119], v[170:171]
  v_pk_add_f32 v[120:121], v[120:121], v[172:173]
  v_pk_add_f32 v[122:123], v[122:123], v[174:175]
  v_pk_add_f32 v[124:125], v[124:125], v[176:177]
  v_pk_add_f32 v[126:127], v[126:127], v[178:179]
  v_pk_add_f32 v[128:129], v[128:129], v[180:181]
  v_pk_add_f32 v[130:131], v[130:131], v[182:183]
  s_waitcnt lgkmcnt(5)
  v_pk_add_f32 v[112:113], v[112:113], v[184:185]
  v_pk_add_f32 v[114:115], v[114:115], v[186:187]
  v_pk_add_f32 v[116:117], v[116:117], v[188:189]
  v_pk_add_f32 v[118:119], v[118:119], v[190:191]
  v_pk_add_f32 v[120:121], v[120:121], v[192:193]
  v_pk_add_f32 v[122:123], v[122:123], v[194:195]
  v_pk_add_f32 v[124:125], v[124:125], v[196:197]
  v_pk_add_f32 v[126:127], v[126:127], v[198:199]
  v_pk_add_f32 v[128:129], v[128:129], v[200:201]
  v_pk_add_f32 v[130:131], v[130:131], v[202:203]
  s_waitcnt lgkmcnt(0)
  v_pk_add_f32 v[112:113], v[112:113], v[204:205]
  v_pk_add_f32 v[114:115], v[114:115], v[206:207]
  v_pk_add_f32 v[116:117], v[116:117], v[208:209]
  v_pk_add_f32 v[118:119], v[118:119], v[210:211]
  v_pk_add_f32 v[120:121], v[120:121], v[212:213]
  v_pk_add_f32 v[122:123], v[122:123], v[214:215]
  v_pk_add_f32 v[124:125], v[124:125], v[216:217]
  v_pk_add_f32 v[126:127], v[126:127], v[218:219]
  v_pk_add_f32 v[128:129], v[128:129], v[220:221]
  v_pk_add_f32 v[130:131], v[130:131], v[222:223]
  v_cvt_pk_bf16_f32 v164, v112, v113
  v_cvt_pk_bf16_f32 v165, v114, v115
  v_cvt_pk_bf16_f32 v166, v116, v117
  v_cvt_pk_bf16_f32 v167, v118, v119
  v_cvt_pk_bf16_f32 v168, v120, v121
  v_cvt_pk_bf16_f32 v169, v122, v123
  v_cvt_pk_bf16_f32 v170, v124, v125
  v_cvt_pk_bf16_f32 v171, v126, v127
  v_cvt_pk_bf16_f32 v172, v128, v129
  v_cvt_pk_bf16_f32 v173, v130, v131
  s_cmp_lg_u32 s36, 0
  s_cbranch_scc1 L_fin1
  s_mul_i32 s19, s36, 5242880
  s_add_u32 s19, s19, 17011712
  s_add_u32 s19, s19, s53
  s_mul_i32 s20, s36, 5242880
  s_add_u32 s20, s20, 17011712
  s_add_u32 s20, s20, s54
  buffer_store_dwordx4 v[164:167], v2, s[4:7], s19 offen sc1
  buffer_store_dwordx4 v[168:171], v2, s[4:7], s19 offen offset:1024 sc1
  v_mov_b32 v174, v172
  v_mov_b32 v175, v173
  v_mov_b32 v6, v172
  v_mov_b32 v7, v173
  s_nop 0
  v_permlane16_swap_b32 v6, v174
  v_permlane16_swap_b32 v7, v175
  s_mov_b64 exec, s[34:35]
  buffer_store_dwordx4 v[172:175], v11, s[4:7], s20 offen sc1
  s_mov_b64 exec, -1
  s_and_b32 s19, s18, 1
  s_add_u32 s19, s19, s52
  s_lshl_b32 s59, s19, 10
  s_lshl_b32 s20, s39, 7
  s_add_u32 s59, s59, s20
  s_mul_i32 s19, s36, 262144
  s_add_u32 s19, s19, 40670208
  s_add_u32 s19, s19, s59
  v_mov_b32 v132, 0
  v_mov_b32 v133, 0
  v_dot2c_f32_bf16 v132, s23, v164
  v_dot2c_f32_bf16 v133, v164, v164
  v_dot2c_f32_bf16 v132, s23, v165
  v_dot2c_f32_bf16 v133, v165, v165
  v_dot2c_f32_bf16 v132, s23, v166
  v_dot2c_f32_bf16 v133, v166, v166
  v_dot2c_f32_bf16 v132, s23, v167
  v_dot2c_f32_bf16 v133, v167, v167
  v_dot2c_f32_bf16 v132, s23, v168
  v_dot2c_f32_bf16 v133, v168, v168
  v_dot2c_f32_bf16 v132, s23, v169
  v_dot2c_f32_bf16 v133, v169, v169
  v_dot2c_f32_bf16 v132, s23, v170
  v_dot2c_f32_bf16 v133, v170, v170
  v_dot2c_f32_bf16 v132, s23, v171
  v_dot2c_f32_bf16 v133, v171, v171
  v_dot2c_f32_bf16 v132, s23, v172
  v_dot2c_f32_bf16 v133, v172, v172
  v_dot2c_f32_bf16 v132, s23, v173
  v_dot2c_f32_bf16 v133, v173, v173
  s_nop 2
  v_permlane32_swap_b32 v132, v133
  v_add_f32 v132, v132, v133
  v_mov_b32 v134, v132
  s_nop 1
  v_permlane16_swap_b32 v132, v134
  v_add_f32 v132, v132, v134
  v_mov_b32 v133, v132
  s_nop 1
  v_permlane32_swap_b32 v132, v133
  s_mov_b64 exec, 0xffff
  buffer_store_dwordx2 v[132:133], v9, s[4:7], s19 offen sc1
  s_mov_b64 exec, -1
  s_branch L_rf11
L_fin1:
  v_mul_u32_u24 v132, 1280, v3
  v_lshl_add_u32 v133, v4, 3, v132
  v_lshl_add_u32 v132, v4, 4, v132
  s_and_b32 s19, s18, 1
  s_add_u32 s19, s19, s52
  s_add_u32 s19, s19, 64
  s_mul_i32 s20, s19, 20480
  s_lshr_b32 s19, s39, 1
  s_mul_i32 s19, s19, 320
  s_add_u32 s19, s19, s20
  s_and_b32 s20, s39, 1
  s_mul_i32 s59, s20, 192
  s_add_u32 s59, s59, s19
  s_lshl_b32 s20, s20, 5
  s_add_u32 s20, s20, s19
  buffer_store_dwordx4 v[164:167], v132, s[8:11], s59 offen
  buffer_store_dwordx4 v[168:171], v132, s[8:11], s59 offen offset:64
  buffer_store_dwordx2 v[172:173], v133, s[8:11], s20 offen offset:128
L_rf11:
  s_cmp_lg_u32 s36, 0
  s_cbranch_scc1 L_done
  buffer_load_dwordx4 v[84:87], v14, s[4:7], s22 offen offset:0 sc1
  s_lshr_b32 s19, s18, 1
  s_cmp_lg_u32 s19, 1
  s_cbranch_scc1 L_rs11
  s_waitcnt vmcnt(1)
  s_mul_i32 s19, s36, 65536
  s_add_u32 s19, s19, 57344
  s_add_u32 s19, s19, s56
  s_and_b32 s20, s18, 1
  s_lshl_b32 s59, s39, 1
  s_add_u32 s59, s59, s20
  s_lshl_b32 s59, s59, 3
  s_add_u32 s19, s19, s59
  v_mov_b32 v20, s14
  v_mov_b32 v21, s15
  s_mov_b64 exec, 1
  buffer_store_dwordx2 v[20:21], v5, s[4:7], s19 offen sc1
  s_mov_b64 exec, -1
L_rs11:
  s_mov_b32 s36, 1
  s_branch L_loop
L_done:
  s_or_b32 s24, s2, s18
  s_cmp_lg_u32 s24, 0
  s_cbranch_scc1 L_nclr
  v_mov_b32 v20, 0
  v_mov_b32 v21, 0
  s_mov_b64 exec, 1
  global_store_dwordx2 v5, v[20:21], s[12:13] sc1
  s_mov_b64 exec, -1
L_nclr:
  s_waitcnt vmcnt(0)
L_end:
  s_endpgm
.section .rodata,"a"
.p2align 6
.amdhsa_kernel interleave_layers__linear_attn_block__glu_gated_bilinear__prompt_kernel
  .amdhsa_next_free_vgpr 512
  .amdhsa_next_free_sgpr 80
  .amdhsa_accum_offset 256
  .amdhsa_group_segment_fixed_size 0
  .amdhsa_kernarg_size 80
  .amdhsa_user_sgpr_count 2
  .amdhsa_user_sgpr_kernarg_segment_ptr 1
  .amdhsa_system_sgpr_workgroup_id_x 1
  .amdhsa_float_denorm_mode_32 3
.end_amdhsa_kernel
```
